```python
import torch

def _softmax(x, axis=-1):
    return torch.softmax(x, dim=axis)
def _gelu(x):
    return torch.nn.functional.gelu(x, approximate="tanh")
def _silu(x):
    return torch.nn.functional.silu(x)
def _sigmoid(x):
    return torch.sigmoid(x)
def _layernorm(x, axis=-1, eps=1e-5):
    m = x.mean(dim=axis, keepdim=True)
    v = x.var(dim=axis, keepdim=True, unbiased=False)
    return (x - m) / torch.sqrt(v + eps)
def _scatter_add(tgt, idx, src, axis=0):
    return tgt.clone().index_add_(axis, idx, src)
def _segment_sum(src, seg, n):
    out = torch.zeros((n,) + src.shape[1:], dtype=src.dtype)
    return out.index_add_(0, seg, src)
def _pad(x, pw):
    flat = tuple(v for pair in reversed(pw) for v in pair)
    return torch.nn.functional.pad(x, flat)

kernel_name = 'recurrent_scan__ssm_conv_s4__geglu_ffn__prompt'

def setup_inputs():

    _w = (lambda a: (lambda t: t.to(torch.bfloat16) if t.is_floating_point() else t)(torch.as_tensor(a)))
    def _A_setup():
        B, L, D, N = 1, 2048, 640, 192
        A_re = -(lambda _x: torch.exp(torch.as_tensor(_x)))((lambda *s: torch.randn(*s, dtype=torch.bfloat16) * 6.4)(D, N))
        A_im = torch.pi * (lambda *s: torch.randn(*s, dtype=torch.bfloat16) * 0.05)(D, N)
        B_re = (lambda *s: torch.randn(*s, dtype=torch.bfloat16) * 0.05)(D, N)
        B_im = (lambda *s: torch.randn(*s, dtype=torch.bfloat16) * 0.05)(D, N)
        C_re = (lambda *s: torch.randn(*s, dtype=torch.bfloat16) * 0.05)(D, N)
        C_im = (lambda *s: torch.randn(*s, dtype=torch.bfloat16) * 0.05)(D, N)
        log_dt = (lambda *s: torch.randn(*s, dtype=torch.bfloat16) * 0.05)(D) * 0.5 - 4.0
        Dskip = (lambda *s: torch.randn(*s, dtype=torch.bfloat16) * 0.05)(D)
        return {
            "u": _w((lambda *s: torch.randn(*s, dtype=torch.bfloat16) * 0.05)(B, L, D)),
            "A_re": _w(A_re),
            "A_im": _w(A_im),
            "B_re": _w(B_re),
            "B_im": _w(B_im),
            "C_re": _w(C_re),
            "C_im": _w(C_im),
            "log_dt": _w(log_dt),
            "Dskip": _w(Dskip),
        }
    _A_in = _A_setup()

    def _B_setup():
        B, S, D, F = 1, 2048, 640, 1536
        return {
            "x": _w((lambda *s: torch.randn(*s, dtype=torch.bfloat16) * 0.05)(B, S, D)),
            "w_gate": _w((lambda *s: torch.randn(*s, dtype=torch.bfloat16) * 0.05)(D, F)),
            "w_up": _w((lambda *s: torch.randn(*s, dtype=torch.bfloat16) * 0.05)(D, F)),
            "w_down": _w((lambda *s: torch.randn(*s, dtype=torch.bfloat16) * 0.05)(F, D)),
        }
    _B_in = _B_setup()

    return {
        "A_u": _A_in["u"],
        "A_A_re": _A_in["A_re"],
        "A_A_im": _A_in["A_im"],
        "A_B_re": _A_in["B_re"],
        "A_B_im": _A_in["B_im"],
        "A_C_re": _A_in["C_re"],
        "A_C_im": _A_in["C_im"],
        "A_log_dt": _A_in["log_dt"],
        "A_Dskip": _A_in["Dskip"],
        "B_x": _B_in["x"],
        "B_w_gate": _B_in["w_gate"],
        "B_w_up": _B_in["w_up"],
        "B_w_down": _B_in["w_down"],
    }

def reference(A_u, A_A_re, A_A_im, A_B_re, A_B_im, A_C_re, A_C_im, A_log_dt, A_Dskip, B_x, B_w_gate, B_w_up, B_w_down):
    def _A_ref(u, A_re, A_im, B_re, B_im, C_re, C_im, log_dt, Dskip):
        Bsz, L, D = u.shape
        dt = torch.exp(log_dt)[:, None]
        A = A_re + 1j * A_im
        Bc = B_re + 1j * B_im
        Cc = C_re + 1j * C_im
        logdA = dt * A
        dB = dt * Bc
        l = (lambda x, dt: x.to(dt))(torch.arange(L), A_re.dtype)
        P = torch.exp(logdA[:, :, None] * l[None, None, :])
        K = torch.einsum("dn,dnl,dn->dl", Cc, P, dB).real
        L2 = 2 * L
        Kp = _pad(K, ((0, 0), (0, L)))
        up = (lambda x, *d: x.permute(*d))(u, 0, 2, 1)
        up = _pad(up, ((0, 0), (0, 0), (0, L)))
        Kf = (lambda x, axes=(-2,-1): torch.fft.rfft2(x.float(), dim=axes))(Kp[:, None, :], axes=(-2, -1))
        Uf = (lambda x, axes=(-2,-1): torch.fft.rfft2(x.float(), dim=axes))(up[:, :, None, :], axes=(-2, -1))
        Yf = Uf * Kf[None, :, :, :]
        y = (lambda x, s, axes=(-2,-1): torch.fft.irfft2(x, s=s, dim=axes).to(torch.bfloat16))(Yf, (1, L2), axes=(-2, -1))[:, :, 0, :L]
        y = (lambda x, *d: x.permute(*d))(y, 0, 2, 1) + u * Dskip[None, None, :]
        return y

    def _B_ref(x, w_gate, w_up, w_down):
        return (_gelu(x @ w_gate) * (x @ w_up)) @ w_down

    x = A_u
    xn = _layernorm(x, axis=-1)
    s = _A_ref(xn, A_A_re, A_A_im, A_B_re, A_B_im, A_C_re, A_C_im, A_log_dt, A_Dskip)
    g = _silu(_B_ref(xn, B_w_gate, B_w_up, B_w_down))
    return x + s * g
```

```asm
; @launch grid=(256,1,1) block=(256,1,1) lds=163840
.amdgcn_target "amdgcn-amd-amdhsa--gfx950"
.set CODE_LEFT, L_code_end - L_pc
.text
.globl recurrent_scan__ssm_conv_s4__geglu_ffn__prompt_kernel
.p2align 8
.type recurrent_scan__ssm_conv_s4__geglu_ffn__prompt_kernel,@function
recurrent_scan__ssm_conv_s4__geglu_ffn__prompt_kernel:
    s_cmp_ge_u32 s2, 256
    s_cbranch_scc1 L_end
    s_load_dwordx16 s[4:19], s[0:1], 0
    s_load_dwordx16 s[20:35], s[0:1], 64
    s_getpc_b64 s[82:83]
    s_lshr_b32 s56, s2, 3
    v_lshrrev_b32_e64 v244, 4, v0
    s_lshl_b32 s57, s56, 11
    v_lshl_add_u32 v245, v244, 7, s57
    v_min_u32 v245, CODE_LEFT, v245
    global_load_dword v2, v245, s[82:83]
L_pc:
    v_lshrrev_b32 v244, 6, v0
    v_and_b32 v255, 63, v0
    v_readfirstlane_b32 s54, v244
    s_and_b32 s55, s2, 7
    s_and_b32 s59, s55, 1
    s_lshr_b32 s60, s55, 1
    v_and_b32 v254, 15, v255
    v_lshrrev_b32 v253, 4, v255
    v_lshlrev_b32 v252, 4, v255
    v_mov_b32 v243, 0
    s_mul_i32 s63, s55, 80
    s_mov_b32 s38, 2621440
    s_mov_b32 s39, 0x20000
    s_mov_b32 s42, 33554432
    s_mov_b32 s43, 0x20000
    s_mul_i32 s70, s54, 8704
    s_add_u32 s70, s70, 0
    s_mov_b32 s3, 0
    s_cmp_ge_u32 s56, 24
    s_cbranch_scc1 L_helper
    s_lshl_b32 s57, s56, 1
    s_add_u32 s63, s63, s57
    s_and_b32 s92, s54, 1
    s_lshr_b32 s93, s54, 1
    s_add_u32 s57, s63, s93
    s_mul_i32 s58, s57, 384
    s_lshl_b32 s61, s92, 7
    s_add_u32 s58, s58, s61
    s_mul_i32 s61, s92, 63
    v_xor_b32 v250, s61, v255
    v_lshl_add_u32 v250, v250, 2, s58
    s_lshl_b32 s57, s57, 1
    v_mov_b32 v251, s57
    v_mov_b32 v24, 0
    v_mov_b32 v3, 0
    s_and_b32 s61, s56, 7
    s_lshr_b32 s62, s56, 3
    s_lshl_b32 s82, s59, 3
    s_add_u32 s82, s82, s61
    s_mul_i32 s81, s60, 3
    s_add_u32 s81, s81, s62
    s_lshl_b32 s88, s81, 8
    s_mul_i32 s58, s92, 98304
    s_add_u32 s88, s88, s58
    s_add_u32 s89, s88, 49152
    s_lshl_b32 s83, s82, 2
    s_add_u32 s83, s83, s54
    s_mul_i32 s83, s83, 40960
    s_lshl_b32 s90, s54, 13
    s_lshl_b32 s91, s54, 12
    v_lshlrev_b32 v244, 1, v253
    v_xor_b32_e64 v244, v244, v254
    v_mul_u32_u24 v245, 3072, v253
    v_lshl_add_u32 v204, v244, 4, v245
    v_add_u32 v205, 11264, v204
    v_xor_b32 v244, 128, v204
    v_add_u32 v206, 22528, v244
    v_add_u32 v207, 33792, v244
    v_lshrrev_b32 v246, 3, v255
    v_mul_u32_u24 v246, 1280, v246
    v_and_b32 v247, 7, v255
    v_xor_b32 v247, v247, v253
    v_lshl_add_u32 v208, v247, 4, v246
    v_xor_b32 v247, 64, v208
    v_add_u32 v209, 9216, v247
    v_add_u32 v210, 18432, v208
    v_add_u32 v211, 27648, v247
    s_mov_b32 s86, 1966080
    s_mov_b32 s87, 0x20000
    s_cmp_lt_u32 s54, 2
    s_waitcnt lgkmcnt(0)
    s_cselect_b32 s84, s24, s26
    s_cselect_b32 s85, s25, s27
    s_mov_b32 s36, s4
    s_mov_b32 s37, s5
    global_load_short_d16_hi v24, v251, s[18:19]
    global_load_dword v4, v250, s[6:7] nt
    global_load_dword v5, v250, s[8:9] nt
    global_load_dword v6, v250, s[10:11] nt
    global_load_dword v7, v250, s[12:13] nt
    global_load_dword v8, v250, s[14:15] nt
    global_load_dword v9, v250, s[16:17] nt
    s_add_u32 m0, s91, 98304
    s_nop 0
    buffer_load_dwordx4 v208, s[36:39], s83 offen offset:0 lds
    buffer_load_dwordx4 v209, s[36:39], s83 offen offset:1024 lds
    buffer_load_dwordx4 v210, s[36:39], s83 offen offset:2048 lds
    buffer_load_dwordx4 v211, s[36:39], s83 offen offset:3072 lds
    s_add_u32 m0, s90, 65536
    s_nop 0
    buffer_load_dwordx4 v204, s[84:87], s88 offen offset:0 lds
    buffer_load_dwordx4 v205, s[84:87], s88 offen offset:1024 lds
    s_mov_b32 s40, s34
    s_mov_b32 s41, s35
    buffer_load_dwordx2 v[10:11], v243, s[40:43], 0 offen sc1
    global_load_short_d16_hi v3, v251, s[20:21]
    s_mov_b32 s44, s30
    s_mov_b32 s45, s31
    s_mov_b32 s46, 2621440
    s_mov_b32 s47, 0x20000
    v_and_b32 v244, 31, v255
    v_lshrrev_b32 v245, 5, v255
    v_mul_u32_u24 v1, 272, v244
    v_lshl_add_u32 v1, v245, 4, v1
    v_add_u32_e64 v1, s70, v1
    s_mov_b32 s50, 0
    s_mov_b32 s51, -1
    v_lshl_add_u32 v249, v245, 4, s70
    v_mul_u32_u24 v246, 272, v254
    v_bfe_u32 v247, v255, 4, 1
    v_lshl_add_u32 v246, v247, 7, v246
    v_add_u32 v63, v249, v246
    v_lshlrev_b32 v246, 2, v244
    v_mov_b32 v247, 0xa392ba91
    v_bfe_u32 v246, v247, v246, 4
    v_cmp_gt_u32 vcc, 8, v244
    v_subrev_u32 v247, 12, v244
    v_mov_b32 v248, 0xfffff100
    v_cndmask_b32 v246, v246, v244, vcc
    v_cmp_lt_u32 vcc, 15, v244
    v_bfe_u32 v248, v248, v244, 1
    v_mov_b32 v60, 0x43000000
    v_cndmask_b32 v246, v246, v247, vcc
    v_mul_u32_u24 v246, 272, v246
    v_lshl_add_u32 v246, v248, 7, v246
    v_add_u32 v64, v249, v246
    v_mov_b32 v62, 0x43800000
    v_cndmask_b32 v60, 0, v60, s[50:51]
    v_cndmask_b32 v61, 1.0, v62, s[50:51]
    v_cndmask_b32 v62, v62, 4.0, s[50:51]
    s_mul_i32 s57, s92, 0x02020000
    s_add_u32 s52, s57, 0x01000c0c
    s_sub_u32 s53, 0x03020c0c, s57
    v_lshrrev_b32 v244, 2, v254
    v_and_b32 v245, 3, v255
    v_lshl_add_u32 v246, v253, 3, v244
    v_lshlrev_b32 v246, 8, v246
    v_lshl_add_u32 v246, v245, 3, v246
    v_add_u32 v246, 65536, v246
    v_and_b32 v247, 1, v253
    v_xor_b32 v247, s93, v247
    v_lshl_add_u32 v247, v247, 2, v244
    v_xor_b32 v248, 0, v247
    v_lshl_add_u32 v235, v248, 5, v246
    v_xor_b32 v248, 1, v247
    v_lshl_add_u32 v236, v248, 5, v246
    v_xor_b32 v248, 2, v247
    v_lshl_add_u32 v237, v248, 5, v246
    v_xor_b32 v248, 3, v247
    v_lshl_add_u32 v238, v248, 5, v246
    v_lshrrev_b32 v247, 1, v254
    v_xor_b32 v247, v247, v253
    v_lshlrev_b32 v247, 4, v247
    v_lshl_add_u32 v247, v254, 7, v247
    s_lshl_b32 s57, s92, 13
    s_add_u32 s57, s57, 98304
    v_add_u32 v239, s57, v247
    v_xor_b32 v247, 64, v247
    v_add_u32 v240, s57, v247
    s_mov_b32 s3, 1
    s_cmp_eq_u32 s54, 0
    s_cbranch_scc1 L_padG3
    s_cmp_eq_u32 s54, 1
    s_cbranch_scc1 L_padG2
    s_cmp_eq_u32 s54, 2
    s_cbranch_scc1 L_padG1
    s_branch L_padG0
L_wdone:
    s_cmp_eq_u32 s3, 2
    s_cbranch_scc1 L_wdoneH
    s_mov_b32 s3, 0
    s_waitcnt vmcnt(14)
    v_mul_f32 v24, 0x3fb8aa3b, v24
    v_exp_f32 v24, v24
    s_nop 0
    v_cvt_pk_bf16_f32 v24, v24, v24
    v_lshlrev_b32 v24, 16, v24
    v_mul_f32 v25, 0x3fb8aa3b, v24
    v_mul_f32 v26, 0x3e22f983, v24
    s_waitcnt vmcnt(13)
    v_perm_b32 v12, v4, v4, s52
    s_waitcnt vmcnt(12)
    v_perm_b32 v13, v5, v5, s52
    s_waitcnt vmcnt(11)
    v_perm_b32 v14, v6, v6, s52
    s_waitcnt vmcnt(10)
    v_perm_b32 v15, v7, v7, s52
    s_waitcnt vmcnt(9)
    v_perm_b32 v16, v8, v8, s52
    s_waitcnt vmcnt(8)
    v_perm_b32 v17, v9, v9, s52
    v_mul_f32 v12, v12, v25
    v_mul_f32 v13, v13, v26
    v_mul_f32 v56, 0x41000000, v12
    v_mul_f32 v57, 0x41000000, v13
    buffer_load_dwordx4 v206, s[84:87], s88 offen offset:2048 lds
    v_exp_f32 v56, v56
    v_fract_f32 v57, v57
    v_cos_f32 v58, v57
    v_sin_f32 v59, v57
    v_mul_f32 v14, v14, v24
    v_mul_f32 v30, v56, v58
    v_mul_f32 v31, v56, v59
    v_exp_f32 v56, v12
    v_fract_f32 v57, v13
    v_cos_f32 v58, v57
    v_sin_f32 v59, v57
    v_mul_f32 v15, v15, v24
    v_mul_f32 v28, v56, v58
    v_mul_f32 v29, v56, v59
    v_mul_f32 v56, 0x43800000, v12
    v_mul_f32 v57, 0x43800000, v13
    buffer_load_dwordx4 v207, s[84:87], s88 offen offset:3072 lds
    v_exp_f32 v56, v56
    v_fract_f32 v57, v57
    v_cos_f32 v58, v57
    v_sin_f32 v59, v57
    v_mul_f32 v34, v16, v14
    v_mul_f32 v32, v56, v58
    v_mul_f32 v33, v56, v59
    v_mul_f32 v35, v16, v15
    v_fma_f32 v34, -v17, v15, v34
    v_fma_f32 v35, v17, v14, v35
    v_mov_b32 v48, 0x3f80
    v_cvt_pk_bf16_f32 v49, v30, v31
    v_pk_mul_f32 v[36:37], v[30:31], v[30:31] op_sel_hi:[1,0]
    v_pk_fma_f32 v[36:37], v[30:31], v[30:31], v[36:37] op_sel:[1,1,0] op_sel_hi:[0,1,1] neg_lo:[1,0,0]
    v_cvt_pk_bf16_f32 v50, v36, v37
    s_add_u32 m0, s90, 69632
    v_pk_mul_f32 v[38:39], v[36:37], v[30:31] op_sel_hi:[1,0]
    buffer_load_dwordx4 v204, s[84:87], s89 offen offset:0 lds
    v_pk_fma_f32 v[38:39], v[36:37], v[30:31], v[38:39] op_sel:[1,1,0] op_sel_hi:[0,1,1] neg_lo:[1,0,0]
    v_cvt_pk_bf16_f32 v51, v38, v39
    v_pk_mul_f32 v[36:37], v[38:39], v[30:31] op_sel_hi:[1,0]
    v_pk_fma_f32 v[36:37], v[38:39], v[30:31], v[36:37] op_sel:[1,1,0] op_sel_hi:[0,1,1] neg_lo:[1,0,0]
    v_cvt_pk_bf16_f32 v52, v36, v37
    v_pk_mul_f32 v[38:39], v[36:37], v[30:31] op_sel_hi:[1,0]
    v_pk_fma_f32 v[38:39], v[36:37], v[30:31], v[38:39] op_sel:[1,1,0] op_sel_hi:[0,1,1] neg_lo:[1,0,0]
    v_cvt_pk_bf16_f32 v53, v38, v39
    v_pk_mul_f32 v[36:37], v[38:39], v[30:31] op_sel_hi:[1,0]
    v_pk_fma_f32 v[36:37], v[38:39], v[30:31], v[36:37] op_sel:[1,1,0] op_sel_hi:[0,1,1] neg_lo:[1,0,0]
    v_cvt_pk_bf16_f32 v54, v36, v37
    v_pk_mul_f32 v[38:39], v[36:37], v[30:31] op_sel_hi:[1,0]
    v_pk_fma_f32 v[38:39], v[36:37], v[30:31], v[38:39] op_sel:[1,1,0] op_sel_hi:[0,1,1] neg_lo:[1,0,0]
    s_and_b32 m0, s70, 0xffff
    v_cvt_pk_bf16_f32 v55, v38, v39
    ds_write_addtid_b32 v48 offset:0
    ds_write_addtid_b32 v49 offset:272
    ds_write_addtid_b32 v50 offset:544
    ds_write_addtid_b32 v51 offset:816
    ds_write_addtid_b32 v52 offset:1088
    ds_write_addtid_b32 v53 offset:1360
    ds_write_addtid_b32 v54 offset:1632
    ds_write_addtid_b32 v55 offset:1904
    v_pk_mul_f32 v[36:37], v[38:39], v[30:31] op_sel_hi:[1,0]
    s_add_u32 m0, s90, 69632
    v_pk_fma_f32 v[36:37], v[38:39], v[30:31], v[36:37] op_sel:[1,1,0] op_sel_hi:[0,1,1] neg_lo:[1,0,0]
    buffer_load_dwordx4 v205, s[84:87], s89 offen offset:1024 lds
    v_cvt_pk_bf16_f32 v48, v36, v37
    v_pk_mul_f32 v[38:39], v[36:37], v[30:31] op_sel_hi:[1,0]
    v_pk_fma_f32 v[38:39], v[36:37], v[30:31], v[38:39] op_sel:[1,1,0] op_sel_hi:[0,1,1] neg_lo:[1,0,0]
    v_cvt_pk_bf16_f32 v49, v38, v39
    v_pk_mul_f32 v[36:37], v[38:39], v[30:31] op_sel_hi:[1,0]
    v_pk_fma_f32 v[36:37], v[38:39], v[30:31], v[36:37] op_sel:[1,1,0] op_sel_hi:[0,1,1] neg_lo:[1,0,0]
    v_cvt_pk_bf16_f32 v50, v36, v37
    v_pk_mul_f32 v[38:39], v[36:37], v[30:31] op_sel_hi:[1,0]
    v_pk_fma_f32 v[38:39], v[36:37], v[30:31], v[38:39] op_sel:[1,1,0] op_sel_hi:[0,1,1] neg_lo:[1,0,0]
    v_cvt_pk_bf16_f32 v51, v38, v39
    v_pk_mul_f32 v[36:37], v[38:39], v[30:31] op_sel_hi:[1,0]
    v_pk_fma_f32 v[36:37], v[38:39], v[30:31], v[36:37] op_sel:[1,1,0] op_sel_hi:[0,1,1] neg_lo:[1,0,0]
    v_cvt_pk_bf16_f32 v52, v36, v37
    v_pk_mul_f32 v[38:39], v[36:37], v[30:31] op_sel_hi:[1,0]
    v_pk_fma_f32 v[38:39], v[36:37], v[30:31], v[38:39] op_sel:[1,1,0] op_sel_hi:[0,1,1] neg_lo:[1,0,0]
    v_cvt_pk_bf16_f32 v53, v38, v39
    buffer_load_dwordx4 v206, s[84:87], s89 offen offset:2048 lds
    v_pk_mul_f32 v[36:37], v[38:39], v[30:31] op_sel_hi:[1,0]
    v_pk_fma_f32 v[36:37], v[38:39], v[30:31], v[36:37] op_sel:[1,1,0] op_sel_hi:[0,1,1] neg_lo:[1,0,0]
    v_cvt_pk_bf16_f32 v54, v36, v37
    v_pk_mul_f32 v[38:39], v[36:37], v[30:31] op_sel_hi:[1,0]
    v_pk_fma_f32 v[38:39], v[36:37], v[30:31], v[38:39] op_sel:[1,1,0] op_sel_hi:[0,1,1] neg_lo:[1,0,0]
    s_and_b32 m0, s70, 0xffff
    v_cvt_pk_bf16_f32 v55, v38, v39
    ds_write_addtid_b32 v48 offset:2176
    ds_write_addtid_b32 v49 offset:2448
    ds_write_addtid_b32 v50 offset:2720
    ds_write_addtid_b32 v51 offset:2992
    ds_write_addtid_b32 v52 offset:3264
    ds_write_addtid_b32 v53 offset:3536
    ds_write_addtid_b32 v54 offset:3808
    ds_write_addtid_b32 v55 offset:4080
    v_pk_mul_f32 v[36:37], v[38:39], v[30:31] op_sel_hi:[1,0]
    v_pk_fma_f32 v[36:37], v[38:39], v[30:31], v[36:37] op_sel:[1,1,0] op_sel_hi:[0,1,1] neg_lo:[1,0,0]
    v_cvt_pk_bf16_f32 v48, v36, v37
    v_pk_mul_f32 v[38:39], v[36:37], v[30:31] op_sel_hi:[1,0]
    v_pk_fma_f32 v[38:39], v[36:37], v[30:31], v[38:39] op_sel:[1,1,0] op_sel_hi:[0,1,1] neg_lo:[1,0,0]
    v_cvt_pk_bf16_f32 v49, v38, v39
    v_pk_mul_f32 v[36:37], v[38:39], v[30:31] op_sel_hi:[1,0]
    v_pk_fma_f32 v[36:37], v[38:39], v[30:31], v[36:37] op_sel:[1,1,0] op_sel_hi:[0,1,1] neg_lo:[1,0,0]
    v_cvt_pk_bf16_f32 v50, v36, v37
    s_add_u32 m0, s90, 69632
    v_pk_mul_f32 v[38:39], v[36:37], v[30:31] op_sel_hi:[1,0]
    buffer_load_dwordx4 v207, s[84:87], s89 offen offset:3072 lds
    v_pk_fma_f32 v[38:39], v[36:37], v[30:31], v[38:39] op_sel:[1,1,0] op_sel_hi:[0,1,1] neg_lo:[1,0,0]
    v_cvt_pk_bf16_f32 v51, v38, v39
    v_pk_mul_f32 v[36:37], v[38:39], v[30:31] op_sel_hi:[1,0]
    v_pk_fma_f32 v[36:37], v[38:39], v[30:31], v[36:37] op_sel:[1,1,0] op_sel_hi:[0,1,1] neg_lo:[1,0,0]
    v_cvt_pk_bf16_f32 v52, v36, v37
    v_pk_mul_f32 v[38:39], v[36:37], v[30:31] op_sel_hi:[1,0]
    v_pk_fma_f32 v[38:39], v[36:37], v[30:31], v[38:39] op_sel:[1,1,0] op_sel_hi:[0,1,1] neg_lo:[1,0,0]
    v_cvt_pk_bf16_f32 v53, v38, v39
    v_pk_mul_f32 v[36:37], v[38:39], v[30:31] op_sel_hi:[1,0]
    v_pk_fma_f32 v[36:37], v[38:39], v[30:31], v[36:37] op_sel:[1,1,0] op_sel_hi:[0,1,1] neg_lo:[1,0,0]
    v_cvt_pk_bf16_f32 v54, v36, v37
    v_pk_mul_f32 v[38:39], v[36:37], v[30:31] op_sel_hi:[1,0]
    v_pk_fma_f32 v[38:39], v[36:37], v[30:31], v[38:39] op_sel:[1,1,0] op_sel_hi:[0,1,1] neg_lo:[1,0,0]
    s_and_b32 m0, s70, 0xffff
    v_cvt_pk_bf16_f32 v55, v38, v39
    ds_write_addtid_b32 v48 offset:4352
    ds_write_addtid_b32 v49 offset:4624
    ds_write_addtid_b32 v50 offset:4896
    ds_write_addtid_b32 v51 offset:5168
    ds_write_addtid_b32 v52 offset:5440
    ds_write_addtid_b32 v53 offset:5712
    ds_write_addtid_b32 v54 offset:5984
    ds_write_addtid_b32 v55 offset:6256
    v_pk_mul_f32 v[36:37], v[38:39], v[30:31] op_sel_hi:[1,0]
    s_add_u32 s83, s83, 128
    s_add_u32 m0, s91, 147456
    v_pk_fma_f32 v[36:37], v[38:39], v[30:31], v[36:37] op_sel:[1,1,0] op_sel_hi:[0,1,1] neg_lo:[1,0,0]
    buffer_load_dwordx4 v208, s[36:39], s83 offen offset:0 lds
    v_cvt_pk_bf16_f32 v48, v36, v37
    v_pk_mul_f32 v[38:39], v[36:37], v[30:31] op_sel_hi:[1,0]
    v_pk_fma_f32 v[38:39], v[36:37], v[30:31], v[38:39] op_sel:[1,1,0] op_sel_hi:[0,1,1] neg_lo:[1,0,0]
    v_cvt_pk_bf16_f32 v49, v38, v39
    v_pk_mul_f32 v[36:37], v[38:39], v[30:31] op_sel_hi:[1,0]
    v_pk_fma_f32 v[36:37], v[38:39], v[30:31], v[36:37] op_sel:[1,1,0] op_sel_hi:[0,1,1] neg_lo:[1,0,0]
    v_cvt_pk_bf16_f32 v50, v36, v37
    v_pk_mul_f32 v[38:39], v[36:37], v[30:31] op_sel_hi:[1,0]
    v_pk_fma_f32 v[38:39], v[36:37], v[30:31], v[38:39] op_sel:[1,1,0] op_sel_hi:[0,1,1] neg_lo:[1,0,0]
    v_cvt_pk_bf16_f32 v51, v38, v39
    v_pk_mul_f32 v[36:37], v[38:39], v[30:31] op_sel_hi:[1,0]
    v_pk_fma_f32 v[36:37], v[38:39], v[30:31], v[36:37] op_sel:[1,1,0] op_sel_hi:[0,1,1] neg_lo:[1,0,0]
    v_cvt_pk_bf16_f32 v52, v36, v37
    v_pk_mul_f32 v[38:39], v[36:37], v[30:31] op_sel_hi:[1,0]
    v_pk_fma_f32 v[38:39], v[36:37], v[30:31], v[38:39] op_sel:[1,1,0] op_sel_hi:[0,1,1] neg_lo:[1,0,0]
    v_cvt_pk_bf16_f32 v53, v38, v39
    buffer_load_dwordx4 v209, s[36:39], s83 offen offset:1024 lds
    v_pk_mul_f32 v[36:37], v[38:39], v[30:31] op_sel_hi:[1,0]
    v_pk_fma_f32 v[36:37], v[38:39], v[30:31], v[36:37] op_sel:[1,1,0] op_sel_hi:[0,1,1] neg_lo:[1,0,0]
    v_cvt_pk_bf16_f32 v54, v36, v37
    v_pk_mul_f32 v[38:39], v[36:37], v[30:31] op_sel_hi:[1,0]
    v_pk_fma_f32 v[38:39], v[36:37], v[30:31], v[38:39] op_sel:[1,1,0] op_sel_hi:[0,1,1] neg_lo:[1,0,0]
    s_and_b32 m0, s70, 0xffff
    v_cvt_pk_bf16_f32 v55, v38, v39
    ds_write_addtid_b32 v48 offset:6528
    ds_write_addtid_b32 v49 offset:6800
    ds_write_addtid_b32 v50 offset:7072
    ds_write_addtid_b32 v51 offset:7344
    ds_write_addtid_b32 v52 offset:7616
    ds_write_addtid_b32 v53 offset:7888
    ds_write_addtid_b32 v54 offset:8160
    ds_write_addtid_b32 v55 offset:8432
    ds_read_b128 a[64:67], v1 offset:0
    ds_read_b128 a[68:71], v1 offset:32
    ds_read_b128 a[72:75], v1 offset:64
    ds_read_b128 a[76:79], v1 offset:96
    ds_read_b128 a[80:83], v1 offset:128
    ds_read_b128 a[84:87], v1 offset:160
    ds_read_b128 a[88:91], v1 offset:192
    ds_read_b128 a[92:95], v1 offset:224
    v_cvt_pk_bf16_f32 v48, v34, -v35
    v_pk_mul_f32 v[36:37], v[34:35], v[28:29] op_sel_hi:[1,0]
    v_pk_fma_f32 v[36:37], v[34:35], v[28:29], v[36:37] op_sel:[1,1,0] op_sel_hi:[0,1,1] neg_lo:[1,0,0]
    v_cvt_pk_bf16_f32 v49, v36, -v37
    v_pk_mul_f32 v[42:43], v[36:37], v[28:29] op_sel_hi:[1,0]
    v_pk_fma_f32 v[42:43], v[36:37], v[28:29], v[42:43] op_sel:[1,1,0] op_sel_hi:[0,1,1] neg_lo:[1,0,0]
    v_cvt_pk_bf16_f32 v50, v42, -v43
    v_pk_mul_f32 v[36:37], v[42:43], v[28:29] op_sel_hi:[1,0]
    v_pk_fma_f32 v[36:37], v[42:43], v[28:29], v[36:37] op_sel:[1,1,0] op_sel_hi:[0,1,1] neg_lo:[1,0,0]
    s_add_u32 m0, s91, 147456
    v_cvt_pk_bf16_f32 v51, v36, -v37
    buffer_load_dwordx4 v210, s[36:39], s83 offen offset:2048 lds
    v_pk_mul_f32 v[44:45], v[36:37], v[28:29] op_sel_hi:[1,0]
    v_pk_fma_f32 v[44:45], v[36:37], v[28:29], v[44:45] op_sel:[1,1,0] op_sel_hi:[0,1,1] neg_lo:[1,0,0]
    v_cvt_pk_bf16_f32 v52, v44, -v45
    v_pk_mul_f32 v[36:37], v[44:45], v[28:29] op_sel_hi:[1,0]
    v_pk_fma_f32 v[36:37], v[44:45], v[28:29], v[36:37] op_sel:[1,1,0] op_sel_hi:[0,1,1] neg_lo:[1,0,0]
    v_cvt_pk_bf16_f32 v53, v36, -v37
    v_pk_mul_f32 v[46:47], v[36:37], v[28:29] op_sel_hi:[1,0]
    v_pk_fma_f32 v[46:47], v[36:37], v[28:29], v[46:47] op_sel:[1,1,0] op_sel_hi:[0,1,1] neg_lo:[1,0,0]
    v_cvt_pk_bf16_f32 v54, v46, -v47
    v_pk_mul_f32 v[36:37], v[46:47], v[28:29] op_sel_hi:[1,0]
    v_pk_fma_f32 v[36:37], v[46:47], v[28:29], v[36:37] op_sel:[1,1,0] op_sel_hi:[0,1,1] neg_lo:[1,0,0]
    s_and_b32 m0, s70, 0xffff
    v_cvt_pk_bf16_f32 v55, v36, -v37
    ds_write_addtid_b32 v48 offset:0
    ds_write_addtid_b32 v49 offset:272
    ds_write_addtid_b32 v50 offset:544
    ds_write_addtid_b32 v51 offset:816
    ds_write_addtid_b32 v52 offset:1088
    ds_write_addtid_b32 v53 offset:1360
    ds_write_addtid_b32 v54 offset:1632
    ds_write_addtid_b32 v55 offset:1904
    v_pk_mul_f32 v[40:41], v[34:35], v[32:33] op_sel_hi:[1,0]
    v_pk_fma_f32 v[40:41], v[34:35], v[32:33], v[40:41] op_sel:[1,1,0] op_sel_hi:[0,1,1] neg_lo:[1,0,0]
    v_cvt_pk_bf16_f32 v48, v40, -v41
    s_add_u32 m0, s91, 147456
    v_pk_mul_f32 v[36:37], v[42:43], v[32:33] op_sel_hi:[1,0]
    buffer_load_dwordx4 v211, s[36:39], s83 offen offset:3072 lds
    v_pk_fma_f32 v[36:37], v[42:43], v[32:33], v[36:37] op_sel:[1,1,0] op_sel_hi:[0,1,1] neg_lo:[1,0,0]
    v_cvt_pk_bf16_f32 v49, v36, -v37
    v_pk_mul_f32 v[42:43], v[44:45], v[32:33] op_sel_hi:[1,0]
    v_pk_fma_f32 v[42:43], v[44:45], v[32:33], v[42:43] op_sel:[1,1,0] op_sel_hi:[0,1,1] neg_lo:[1,0,0]
    v_cvt_pk_bf16_f32 v50, v42, -v43
    v_pk_mul_f32 v[36:37], v[46:47], v[32:33] op_sel_hi:[1,0]
    v_pk_fma_f32 v[36:37], v[46:47], v[32:33], v[36:37] op_sel:[1,1,0] op_sel_hi:[0,1,1] neg_lo:[1,0,0]
    v_cvt_pk_bf16_f32 v51, v36, -v37
    v_pk_mul_f32 v[44:45], v[40:41], v[32:33] op_sel_hi:[1,0]
    v_pk_fma_f32 v[44:45], v[40:41], v[32:33], v[44:45] op_sel:[1,1,0] op_sel_hi:[0,1,1] neg_lo:[1,0,0]
    v_cvt_pk_bf16_f32 v52, v44, -v45
    v_pk_mul_f32 v[46:47], v[42:43], v[32:33] op_sel_hi:[1,0]
    v_pk_fma_f32 v[46:47], v[42:43], v[32:33], v[46:47] op_sel:[1,1,0] op_sel_hi:[0,1,1] neg_lo:[1,0,0]
    v_cvt_pk_bf16_f32 v53, v46, -v47
    v_pk_mul_f32 v[40:41], v[44:45], v[32:33] op_sel_hi:[1,0]
    s_add_u32 s88, s88, 196608
    s_add_u32 m0, s90, 114688
    v_pk_fma_f32 v[40:41], v[44:45], v[32:33], v[40:41] op_sel:[1,1,0] op_sel_hi:[0,1,1] neg_lo:[1,0,0]
    buffer_load_dwordx4 v204, s[84:87], s88 offen offset:0 lds
    v_cvt_pk_bf16_f32 v54, v40, -v41
    v_pk_mul_f32 v[36:37], v[46:47], v[32:33] op_sel_hi:[1,0]
    v_pk_fma_f32 v[36:37], v[46:47], v[32:33], v[36:37] op_sel:[1,1,0] op_sel_hi:[0,1,1] neg_lo:[1,0,0]
    s_and_b32 m0, s70, 0xffff
    v_cvt_pk_bf16_f32 v55, v36, -v37
    ds_write_addtid_b32 v48 offset:2176
    ds_write_addtid_b32 v49 offset:2448
    ds_write_addtid_b32 v50 offset:2720
    ds_write_addtid_b32 v51 offset:2992
    ds_write_addtid_b32 v52 offset:3264
    ds_write_addtid_b32 v53 offset:3536
    ds_write_addtid_b32 v54 offset:3808
    ds_write_addtid_b32 v55 offset:4080
    v_pk_mul_f32 v[36:37], v[40:41], v[32:33] op_sel_hi:[1,0]
    v_pk_fma_f32 v[36:37], v[40:41], v[32:33], v[36:37] op_sel:[1,1,0] op_sel_hi:[0,1,1] neg_lo:[1,0,0]
    v_cvt_pk_bf16_f32 v48, v36, -v37
    v_pk_mul_f32 v[38:39], v[36:37], v[32:33] op_sel_hi:[1,0]
    v_pk_fma_f32 v[38:39], v[36:37], v[32:33], v[38:39] op_sel:[1,1,0] op_sel_hi:[0,1,1] neg_lo:[1,0,0]
    v_cvt_pk_bf16_f32 v49, v38, -v39
    v_pk_mul_f32 v[36:37], v[38:39], v[32:33] op_sel_hi:[1,0]
    v_pk_fma_f32 v[36:37], v[38:39], v[32:33], v[36:37] op_sel:[1,1,0] op_sel_hi:[0,1,1] neg_lo:[1,0,0]
    v_cvt_pk_bf16_f32 v50, v36, -v37
    v_pk_mul_f32 v[38:39], v[36:37], v[32:33] op_sel_hi:[1,0]
    v_pk_fma_f32 v[38:39], v[36:37], v[32:33], v[38:39] op_sel:[1,1,0] op_sel_hi:[0,1,1] neg_lo:[1,0,0]
    s_add_u32 m0, s90, 114688
    v_cvt_pk_bf16_f32 v51, v38, -v39
    buffer_load_dwordx4 v205, s[84:87], s88 offen offset:1024 lds
    v_pk_mul_f32 v[36:37], v[38:39], v[32:33] op_sel_hi:[1,0]
    v_pk_fma_f32 v[36:37], v[38:39], v[32:33], v[36:37] op_sel:[1,1,0] op_sel_hi:[0,1,1] neg_lo:[1,0,0]
    s_and_b32 m0, s70, 0xffff
    v_cvt_pk_bf16_f32 v52, v36, -v37
    ds_write_addtid_b32 v48 offset:4352
    ds_write_addtid_b32 v49 offset:4624
    ds_write_addtid_b32 v50 offset:4896
    ds_write_addtid_b32 v51 offset:5168
    ds_write_addtid_b32 v52 offset:5440
    ds_read_b128 a[96:99], v1 offset:0
    ds_read_b128 a[100:103], v1 offset:32
    ds_read_b128 a[104:107], v1 offset:64
    ds_read_b128 a[108:111], v1 offset:96
    ds_read_b128 a[112:115], v1 offset:128
    s_branch L_G
.p2align 12
L_G:
L_padG0:
    s_cmp_lg_u32 s3, 0
    s_cbranch_scc1 L_padG4
    ds_read_b128 a[116:119], v1 offset:160
    ds_read_b128 a[120:123], v1 offset:192
    ds_read_b128 a[124:127], v1 offset:224
    v_perm_b32 v18, v4, v4, s53
    v_perm_b32 v12, v4, v4, s53
    v_perm_b32 v19, v5, v5, s53
    v_perm_b32 v13, v5, v5, s53
    v_perm_b32 v20, v6, v6, s53
    v_perm_b32 v14, v6, v6, s53
    v_perm_b32 v21, v7, v7, s53
    v_perm_b32 v15, v7, v7, s53
    v_perm_b32 v22, v8, v8, s53
    v_perm_b32 v16, v8, v8, s53
    v_perm_b32 v23, v9, v9, s53
    v_perm_b32 v17, v9, v9, s53
    v_permlane32_swap_b32 v18, v12
    v_permlane32_swap_b32 v19, v13
    v_permlane32_swap_b32 v20, v14
    v_permlane32_swap_b32 v21, v15
    v_permlane32_swap_b32 v22, v16
    v_permlane32_swap_b32 v23, v17
    v_mul_f32 v18, v18, v25
    v_mul_f32 v19, v19, v26
    s_waitcnt lgkmcnt(7)
    v_mfma_f32_32x32x16_bf16 v[132:147], a[96:99], a[64:67], 0
    v_mul_f32 v56, 0x41000000, v18
    v_mul_f32 v57, 0x41000000, v19
    v_exp_f32 v56, v56
    v_fract_f32 v57, v57
    v_cos_f32 v58, v57
    s_waitcnt lgkmcnt(6)
    v_mfma_f32_32x32x16_bf16 v[132:147], a[100:103], a[68:71], v[132:147]
    v_sin_f32 v59, v57
    v_mul_f32 v20, v20, v24
    v_mul_f32 v30, v56, v58
    v_mul_f32 v31, v56, v59
    v_mul_f32 v56, v60, v18
    s_waitcnt lgkmcnt(5)
    v_mfma_f32_32x32x16_bf16 v[132:147], a[104:107], a[72:75], v[132:147]
    v_mul_f32 v57, v60, v19
    v_exp_f32 v56, v56
    v_fract_f32 v57, v57
    v_cos_f32 v58, v57
    v_sin_f32 v59, v57
    s_waitcnt lgkmcnt(4)
    v_mfma_f32_32x32x16_bf16 v[132:147], a[108:111], a[76:79], v[132:147]
    v_mul_f32 v21, v21, v24
    v_mul_f32 v38, v56, v58
    v_mul_f32 v39, v56, v59
    v_mul_f32 v56, v61, v18
    v_mul_f32 v57, v61, v19
    s_waitcnt lgkmcnt(3)
    v_mfma_f32_32x32x16_bf16 v[132:147], a[112:115], a[80:83], v[132:147]
    v_exp_f32 v56, v56
    v_fract_f32 v57, v57
    v_cos_f32 v58, v57
    v_sin_f32 v59, v57
    v_mul_f32 v34, v22, v20
    s_waitcnt lgkmcnt(2)
    v_mfma_f32_32x32x16_bf16 v[132:147], a[116:119], a[84:87], v[132:147]
    v_mul_f32 v28, v56, v58
    v_mul_f32 v29, v56, v59
    v_mul_f32 v56, v62, v18
    v_mul_f32 v57, v62, v19
    v_exp_f32 v56, v56
    s_waitcnt lgkmcnt(1)
    v_mfma_f32_32x32x16_bf16 v[132:147], a[120:123], a[88:91], v[132:147]
    v_fract_f32 v57, v57
    v_cos_f32 v58, v57
    v_sin_f32 v59, v57
    v_mul_f32 v35, v22, v21
    v_mul_f32 v32, v56, v58
    s_waitcnt lgkmcnt(0)
    v_mfma_f32_32x32x16_bf16 v[132:147], a[124:127], a[92:95], v[132:147]
    v_mul_f32 v33, v56, v59
    v_fma_f32 v34, -v23, v21, v34
    v_fma_f32 v35, v23, v20, v35
    v_cvt_pk_bf16_f32 v48, v38, v39
    v_pk_mul_f32 v[36:37], v[38:39], v[30:31] op_sel_hi:[1,0]
    v_pk_fma_f32 v[36:37], v[38:39], v[30:31], v[36:37] op_sel:[1,1,0] op_sel_hi:[0,1,1] neg_lo:[1,0,0]
    v_cvt_pk_bf16_f32 v49, v36, v37
    v_pk_mul_f32 v[38:39], v[36:37], v[30:31] op_sel_hi:[1,0]
    v_pk_fma_f32 v[38:39], v[36:37], v[30:31], v[38:39] op_sel:[1,1,0] op_sel_hi:[0,1,1] neg_lo:[1,0,0]
    v_cvt_pk_bf16_f32 v50, v38, v39
    v_pk_mul_f32 v[36:37], v[38:39], v[30:31] op_sel_hi:[1,0]
    s_add_u32 m0, s90, 114688
    v_pk_fma_f32 v[36:37], v[38:39], v[30:31], v[36:37] op_sel:[1,1,0] op_sel_hi:[0,1,1] neg_lo:[1,0,0]
    buffer_load_dwordx4 v206, s[84:87], s88 offen offset:2048 lds
    v_cvt_pk_bf16_f32 v51, v36, v37
    v_pk_mul_f32 v[38:39], v[36:37], v[30:31] op_sel_hi:[1,0]
    v_pk_fma_f32 v[38:39], v[36:37], v[30:31], v[38:39] op_sel:[1,1,0] op_sel_hi:[0,1,1] neg_lo:[1,0,0]
    v_cvt_pk_bf16_f32 v52, v38, v39
    v_pk_mul_f32 v[36:37], v[38:39], v[30:31] op_sel_hi:[1,0]
    v_pk_fma_f32 v[36:37], v[38:39], v[30:31], v[36:37] op_sel:[1,1,0] op_sel_hi:[0,1,1] neg_lo:[1,0,0]
    v_cvt_pk_bf16_f32 v53, v36, v37
    v_pk_mul_f32 v[38:39], v[36:37], v[30:31] op_sel_hi:[1,0]
    v_pk_fma_f32 v[38:39], v[36:37], v[30:31], v[38:39] op_sel:[1,1,0] op_sel_hi:[0,1,1] neg_lo:[1,0,0]
    buffer_load_dwordx4 v207, s[84:87], s88 offen offset:3072 lds
    v_cvt_pk_bf16_f32 v54, v38, v39
    v_pk_mul_f32 v[36:37], v[38:39], v[30:31] op_sel_hi:[1,0]
    v_pk_fma_f32 v[36:37], v[38:39], v[30:31], v[36:37] op_sel:[1,1,0] op_sel_hi:[0,1,1] neg_lo:[1,0,0]
    s_and_b32 m0, s70, 0xffff
    v_cvt_pk_bf16_f32 v55, v36, v37
    ds_write_addtid_b32 v48 offset:0
    ds_write_addtid_b32 v49 offset:272
    ds_write_addtid_b32 v50 offset:544
    ds_write_addtid_b32 v51 offset:816
    ds_write_addtid_b32 v52 offset:1088
    ds_write_addtid_b32 v53 offset:1360
    ds_write_addtid_b32 v54 offset:1632
    ds_write_addtid_b32 v55 offset:1904
    v_pk_mul_f32 v[38:39], v[36:37], v[30:31] op_sel_hi:[1,0]
    v_pk_fma_f32 v[38:39], v[36:37], v[30:31], v[38:39] op_sel:[1,1,0] op_sel_hi:[0,1,1] neg_lo:[1,0,0]
    v_cvt_pk_bf16_f32 v48, v38, v39
    v_pk_mul_f32 v[36:37], v[38:39], v[30:31] op_sel_hi:[1,0]
    s_add_u32 s89, s89, 196608
    s_add_u32 m0, s90, 118784
    v_pk_fma_f32 v[36:37], v[38:39], v[30:31], v[36:37] op_sel:[1,1,0] op_sel_hi:[0,1,1] neg_lo:[1,0,0]
    buffer_load_dwordx4 v204, s[84:87], s89 offen offset:0 lds
    v_cvt_pk_bf16_f32 v49, v36, v37
    v_pk_mul_f32 v[38:39], v[36:37], v[30:31] op_sel_hi:[1,0]
    v_pk_fma_f32 v[38:39], v[36:37], v[30:31], v[38:39] op_sel:[1,1,0] op_sel_hi:[0,1,1] neg_lo:[1,0,0]
    v_cvt_pk_bf16_f32 v50, v38, v39
    v_pk_mul_f32 v[36:37], v[38:39], v[30:31] op_sel_hi:[1,0]
    v_pk_fma_f32 v[36:37], v[38:39], v[30:31], v[36:37] op_sel:[1,1,0] op_sel_hi:[0,1,1] neg_lo:[1,0,0]
    v_cvt_pk_bf16_f32 v51, v36, v37
    v_pk_mul_f32 v[38:39], v[36:37], v[30:31] op_sel_hi:[1,0]
    v_pk_fma_f32 v[38:39], v[36:37], v[30:31], v[38:39] op_sel:[1,1,0] op_sel_hi:[0,1,1] neg_lo:[1,0,0]
    buffer_load_dwordx4 v205, s[84:87], s89 offen offset:1024 lds
    v_cvt_pk_bf16_f32 v52, v38, v39
    v_pk_mul_f32 v[36:37], v[38:39], v[30:31] op_sel_hi:[1,0]
    v_pk_fma_f32 v[36:37], v[38:39], v[30:31], v[36:37] op_sel:[1,1,0] op_sel_hi:[0,1,1] neg_lo:[1,0,0]
    v_cvt_pk_bf16_f32 v53, v36, v37
    v_pk_mul_f32 v[38:39], v[36:37], v[30:31] op_sel_hi:[1,0]
    v_pk_fma_f32 v[38:39], v[36:37], v[30:31], v[38:39] op_sel:[1,1,0] op_sel_hi:[0,1,1] neg_lo:[1,0,0]
    v_cvt_pk_bf16_f32 v54, v38, v39
    v_pk_mul_f32 v[36:37], v[38:39], v[30:31] op_sel_hi:[1,0]
    v_pk_fma_f32 v[36:37], v[38:39], v[30:31], v[36:37] op_sel:[1,1,0] op_sel_hi:[0,1,1] neg_lo:[1,0,0]
    s_and_b32 m0, s70, 0xffff
    v_cvt_pk_bf16_f32 v55, v36, v37
    ds_write_addtid_b32 v48 offset:2176
    ds_write_addtid_b32 v49 offset:2448
    ds_write_addtid_b32 v50 offset:2720
    ds_write_addtid_b32 v51 offset:2992
    ds_write_addtid_b32 v52 offset:3264
    ds_write_addtid_b32 v53 offset:3536
    ds_write_addtid_b32 v54 offset:3808
    ds_write_addtid_b32 v55 offset:4080
    ds_read_b128 a[64:67], v63 offset:0
    ds_read_b128 a[68:71], v63 offset:32
    ds_read_b128 a[72:75], v63 offset:64
    ds_read_b128 a[76:79], v63 offset:96
    v_cvt_pk_bf16_f32 v48, v34, -v35
    s_add_u32 m0, s90, 118784
    v_pk_mul_f32 v[36:37], v[34:35], v[28:29] op_sel_hi:[1,0]
    buffer_load_dwordx4 v206, s[84:87], s89 offen offset:2048 lds
    v_pk_fma_f32 v[36:37], v[34:35], v[28:29], v[36:37] op_sel:[1,1,0] op_sel_hi:[0,1,1] neg_lo:[1,0,0]
    v_cvt_pk_bf16_f32 v49, v36, -v37
    v_pk_mul_f32 v[40:41], v[36:37], v[28:29] op_sel_hi:[1,0]
    v_pk_fma_f32 v[40:41], v[36:37], v[28:29], v[40:41] op_sel:[1,1,0] op_sel_hi:[0,1,1] neg_lo:[1,0,0]
    v_cvt_pk_bf16_f32 v50, v40, -v41
    v_pk_mul_f32 v[42:43], v[40:41], v[28:29] op_sel_hi:[1,0]
    v_pk_fma_f32 v[42:43], v[40:41], v[28:29], v[42:43] op_sel:[1,1,0] op_sel_hi:[0,1,1] neg_lo:[1,0,0]
    v_cvt_pk_bf16_f32 v51, v42, -v43
    v_pk_mul_f32 v[44:45], v[42:43], v[28:29] op_sel_hi:[1,0]
    buffer_load_dwordx4 v207, s[84:87], s89 offen offset:3072 lds
    v_pk_fma_f32 v[44:45], v[42:43], v[28:29], v[44:45] op_sel:[1,1,0] op_sel_hi:[0,1,1] neg_lo:[1,0,0]
    v_cvt_pk_bf16_f32 v52, v44, -v45
    v_pk_mul_f32 v[36:37], v[44:45], v[28:29] op_sel_hi:[1,0]
    v_pk_fma_f32 v[36:37], v[44:45], v[28:29], v[36:37] op_sel:[1,1,0] op_sel_hi:[0,1,1] neg_lo:[1,0,0]
    s_and_b32 m0, s70, 0xffff
    v_cvt_pk_bf16_f32 v53, v36, -v37
    ds_write_addtid_b32 v48 offset:0
    ds_write_addtid_b32 v49 offset:272
    ds_write_addtid_b32 v50 offset:544
    ds_write_addtid_b32 v51 offset:816
    ds_write_addtid_b32 v52 offset:1088
    ds_write_addtid_b32 v53 offset:1360
    v_pk_mul_f32 v[46:47], v[36:37], v[28:29] op_sel_hi:[1,0]
    v_pk_fma_f32 v[46:47], v[36:37], v[28:29], v[46:47] op_sel:[1,1,0] op_sel_hi:[0,1,1] neg_lo:[1,0,0]
    v_cvt_pk_bf16_f32 v48, v46, -v47
    s_add_u32 s83, s83, 128
    s_add_u32 m0, s91, 49152
    v_pk_mul_f32 v[36:37], v[46:47], v[28:29] op_sel_hi:[1,0]
    buffer_load_dwordx4 v208, s[36:39], s83 offen offset:0 lds
    v_pk_fma_f32 v[36:37], v[46:47], v[28:29], v[36:37] op_sel:[1,1,0] op_sel_hi:[0,1,1] neg_lo:[1,0,0]
    v_cvt_pk_bf16_f32 v49, v36, -v37
    v_pk_mul_f32 v[38:39], v[36:37], v[28:29] op_sel_hi:[1,0]
    v_pk_fma_f32 v[38:39], v[36:37], v[28:29], v[38:39] op_sel:[1,1,0] op_sel_hi:[0,1,1] neg_lo:[1,0,0]
    v_cvt_pk_bf16_f32 v50, v38, -v39
    v_cndmask_b32 v44, v44, v42, s[50:51]
    v_cndmask_b32 v45, v45, v43, s[50:51]
    v_pk_mul_f32 v[36:37], v[40:41], v[32:33] op_sel_hi:[1,0]
    v_pk_fma_f32 v[36:37], v[40:41], v[32:33], v[36:37] op_sel:[1,1,0] op_sel_hi:[0,1,1] neg_lo:[1,0,0]
    buffer_load_dwordx4 v209, s[36:39], s83 offen offset:1024 lds
    v_cvt_pk_bf16_f32 v51, v36, -v37
    v_pk_mul_f32 v[36:37], v[44:45], v[32:33] op_sel_hi:[1,0]
    v_pk_fma_f32 v[36:37], v[44:45], v[32:33], v[36:37] op_sel:[1,1,0] op_sel_hi:[0,1,1] neg_lo:[1,0,0]
    v_cvt_pk_bf16_f32 v52, v36, -v37
    v_pk_mul_f32 v[36:37], v[46:47], v[32:33] op_sel_hi:[1,0]
    v_pk_fma_f32 v[36:37], v[46:47], v[32:33], v[36:37] op_sel:[1,1,0] op_sel_hi:[0,1,1] neg_lo:[1,0,0]
    s_and_b32 m0, s70, 0xffff
    v_cvt_pk_bf16_f32 v53, v36, -v37
    ds_write_addtid_b32 v48 offset:1632
    ds_write_addtid_b32 v49 offset:1904
    ds_write_addtid_b32 v50 offset:2176
    ds_write_addtid_b32 v51 offset:2448
    ds_write_addtid_b32 v52 offset:2720
    ds_write_addtid_b32 v53 offset:2992
    ds_read_b128 a[96:99], v64 offset:0
    ds_read_b128 a[100:103], v64 offset:32
    ds_read_b128 a[104:107], v64 offset:64
    ds_read_b128 a[108:111], v64 offset:96
    s_add_u32 m0, s91, 49152
    s_nop 0
    buffer_load_dwordx4 v210, s[36:39], s83 offen offset:2048 lds
    buffer_load_dwordx4 v211, s[36:39], s83 offen offset:3072 lds
    s_waitcnt vmcnt(23)
    v_readfirstlane_b32 s57, v10
    v_readfirstlane_b32 s58, v11
    s_mul_i32 s57, s57, 0x9E3779B1
    s_add_u32 s48, s57, 0x7F4A7C15
    s_mul_i32 s58, s58, 0x85EBCA6B
    s_xor_b32 s49, s58, s48
    s_waitcnt vmcnt(16) lgkmcnt(0)
    s_barrier
    ds_read_b64_tr_b16 a[176:177], v235 offset:0
    ds_read_b64_tr_b16 a[178:179], v235 offset:1024
    ds_read_b128 a[160:163], v239 offset:0
    ds_read_b128 a[164:167], v239 offset:2048
    v_mfma_f32_32x32x16_bf16 v[132:147], a[96:99], a[64:67], v[132:147]
    ds_read_b128 a[168:171], v239 offset:4096
    ds_read_b128 a[172:175], v239 offset:6144
    ds_read_b64_tr_b16 a[180:181], v235 offset:16384
    ds_read_b64_tr_b16 a[182:183], v235 offset:17408
    v_mfma_f32_32x32x16_bf16 v[132:147], a[100:103], a[68:71], v[132:147]
    ds_read_b64_tr_b16 a[184:185], v236 offset:0
    ds_read_b64_tr_b16 a[186:187], v236 offset:1024
    ds_read_b64_tr_b16 a[188:189], v236 offset:16384
    ds_read_b64_tr_b16 a[190:191], v236 offset:17408
    v_mfma_f32_32x32x16_bf16 v[132:147], a[104:107], a[72:75], v[132:147]
    ds_read_b64_tr_b16 a[192:193], v237 offset:0
    ds_read_b64_tr_b16 a[194:195], v237 offset:1024
    ds_read_b64_tr_b16 a[196:197], v237 offset:16384
    ds_read_b64_tr_b16 a[198:199], v237 offset:17408
    v_mfma_f32_32x32x16_bf16 v[132:147], a[108:111], a[76:79], v[132:147]
    ds_read_b64_tr_b16 a[200:201], v238 offset:0
    ds_read_b64_tr_b16 a[202:203], v238 offset:1024
    ds_read_b64_tr_b16 a[204:205], v238 offset:16384
    ds_read_b64_tr_b16 a[206:207], v238 offset:17408
    s_waitcnt lgkmcnt(15)
    v_mfma_f32_16x16x32_bf16 v[4:7], a[176:179], a[160:163], 0
    ds_read_b64_tr_b16 a[208:209], v235 offset:8192
    v_add_u32 v239, 49152, v239
    v_mfma_f32_16x16x32_bf16 v[36:39], a[176:179], a[164:167], 0
    ds_read_b64_tr_b16 a[210:211], v235 offset:9216
    s_add_u32 s88, s88, 196608
    v_mfma_f32_16x16x32_bf16 v[68:71], a[176:179], a[168:171], 0
    ds_read_b128 a[144:147], v240 offset:0
    s_add_u32 m0, s90, 16384
    s_waitcnt lgkmcnt(15)
    v_mfma_f32_16x16x32_bf16 v[100:103], a[176:179], a[172:175], 0
    buffer_load_dwordx4 v204, s[84:87], s88 offen offset:0 lds
    v_mfma_f32_16x16x32_bf16 v[104:107], a[180:183], a[172:175], 0
    ds_read_b128 a[148:151], v240 offset:2048
    s_and_b32 s61, s56, 3
    v_mfma_f32_16x16x32_bf16 v[72:75], a[180:183], a[168:171], 0
    ds_read_b128 a[152:155], v240 offset:4096
    s_lshl_b32 s65, s55, 2
    v_mfma_f32_16x16x32_bf16 v[40:43], a[180:183], a[164:167], 0
    ds_read_b128 a[156:159], v240 offset:6144
    buffer_load_dwordx4 v205, s[84:87], s88 offen offset:1024 lds
    v_mfma_f32_16x16x32_bf16 v[8:11], a[180:183], a[160:163], 0
    ds_read_b64_tr_b16 a[212:213], v235 offset:24576
    v_add_u32 v240, 49152, v240
    s_waitcnt lgkmcnt(15)
    v_mfma_f32_16x16x32_bf16 v[12:15], a[184:187], a[160:163], 0
    s_add_u32 s65, s65, s61
    s_lshr_b32 s66, s56, 2
    v_mfma_f32_16x16x32_bf16 v[44:47], a[184:187], a[164:167], 0
    ds_read_b64_tr_b16 a[214:215], v235 offset:25600
    buffer_load_dwordx4 v206, s[84:87], s88 offen offset:2048 lds
    v_mfma_f32_16x16x32_bf16 v[76:79], a[184:187], a[168:171], 0
    ds_read_b64_tr_b16 a[216:217], v236 offset:8192
    v_add_u32 v235, 49152, v235
    v_mfma_f32_16x16x32_bf16 v[108:111], a[184:187], a[172:175], 0
    ds_read_b64_tr_b16 a[218:219], v236 offset:9216
    s_lshl_b32 s62, s66, 2
    v_mfma_f32_16x16x32_bf16 v[112:115], a[188:191], a[172:175], 0
    ds_read_b64_tr_b16 a[220:221], v236 offset:24576
    buffer_load_dwordx4 v207, s[84:87], s88 offen offset:3072 lds
    v_mfma_f32_16x16x32_bf16 v[80:83], a[188:191], a[168:171], 0
    s_add_u32 s89, s89, 196608
    s_add_u32 m0, s90, 20480
    v_mfma_f32_16x16x32_bf16 v[48:51], a[188:191], a[164:167], 0
    ds_read_b64_tr_b16 a[222:223], v236 offset:25600
    v_add_u32 v236, 49152, v236
    v_mfma_f32_16x16x32_bf16 v[16:19], a[188:191], a[160:163], 0
    s_add_u32 s62, s62, s54
    s_waitcnt lgkmcnt(12)
    v_mfma_f32_16x16x32_bf16 v[20:23], a[192:195], a[160:163], 0
    ds_read_b64_tr_b16 a[224:225], v237 offset:8192
    buffer_load_dwordx4 v204, s[84:87], s89 offen offset:0 lds
    v_mfma_f32_16x16x32_bf16 v[52:55], a[192:195], a[164:167], 0
    ds_read_b64_tr_b16 a[226:227], v237 offset:9216
    s_mul_i32 s67, s62, 61440
    v_mfma_f32_16x16x32_bf16 v[84:87], a[192:195], a[168:171], 0
    s_add_u32 s67, s67, 4194304
    s_and_b32 s69, s54, 1
    v_mfma_f32_16x16x32_bf16 v[116:119], a[192:195], a[172:175], 0
    ds_read_b64_tr_b16 a[228:229], v237 offset:24576
    s_lshl_b32 s69, s69, 8
    v_mfma_f32_16x16x32_bf16 v[120:123], a[196:199], a[172:175], 0
    ds_read_b64_tr_b16 a[230:231], v237 offset:25600
    buffer_load_dwordx4 v205, s[84:87], s89 offen offset:1024 lds
    v_mfma_f32_16x16x32_bf16 v[88:91], a[196:199], a[168:171], 0
    ds_read_b64_tr_b16 a[232:233], v238 offset:8192
    v_add_u32 v237, 49152, v237
    v_mfma_f32_16x16x32_bf16 v[56:59], a[196:199], a[164:167], 0
    ds_read_b64_tr_b16 a[234:235], v238 offset:9216
    s_min_u32 s64, s54, 1
    v_mfma_f32_16x16x32_bf16 v[24:27], a[196:199], a[160:163], 0
    s_lshl_b32 s64, s64, 30
    v_lshrrev_b32 v244, 2, v254
    v_mfma_f32_16x16x32_bf16 v[28:31], a[200:203], a[160:163], 0
    ds_read_b64_tr_b16 a[236:237], v238 offset:24576
    buffer_load_dwordx4 v206, s[84:87], s89 offen offset:2048 lds
    v_mfma_f32_16x16x32_bf16 v[60:63], a[200:203], a[164:167], 0
    ds_read_b64_tr_b16 a[238:239], v238 offset:25600
    v_add_u32 v238, 49152, v238
    v_mfma_f32_16x16x32_bf16 v[92:95], a[200:203], a[168:171], 0
    v_and_b32 v245, 3, v255
    v_sub_u32 v246, v245, v244
    v_mfma_f32_16x16x32_bf16 v[124:127], a[200:203], a[172:175], 0
    v_lshlrev_b32 v246, 3, v246
    v_bfrev_b32 v245, v253
    v_mfma_f32_16x16x32_bf16 v[128:131], a[204:207], a[172:175], 0
    buffer_load_dwordx4 v207, s[84:87], s89 offen offset:3072 lds
    v_mfma_f32_16x16x32_bf16 v[96:99], a[204:207], a[168:171], 0
    s_add_u32 s83, s83, 128
    s_add_u32 m0, s91, 98304
    v_mfma_f32_16x16x32_bf16 v[64:67], a[204:207], a[164:167], 0
    v_lshrrev_b32 v245, 30, v245
    v_lshl_add_u32 v246, v245, 6, v246
    v_mfma_f32_16x16x32_bf16 v[32:35], a[204:207], a[160:163], 0
    v_add_u32 v242, 114816, v246
    s_waitcnt vmcnt(12) lgkmcnt(0)
    s_barrier
    v_mfma_f32_16x16x32_bf16 v[4:7], a[208:211], a[144:147], v[4:7]
    buffer_load_dwordx4 v208, s[36:39], s83 offen offset:0 lds
    v_mfma_f32_16x16x32_bf16 v[36:39], a[208:211], a[148:151], v[36:39]
    ds_read_b64_tr_b16 a[176:177], v235 offset:0
    s_add_u32 s61, s69, 123520
    v_mfma_f32_16x16x32_bf16 v[68:71], a[208:211], a[152:155], v[68:71]
    ds_read_b64_tr_b16 a[178:179], v235 offset:1024
    v_lshlrev_b32 v244, 7, v245
    v_mfma_f32_16x16x32_bf16 v[100:103], a[208:211], a[156:159], v[100:103]
    ds_read_b128 a[160:163], v239 offset:0
    v_lshlrev_b32 v246, 4, v254
    v_mfma_f32_16x16x32_bf16 v[104:107], a[212:215], a[156:159], v[104:107]
    ds_read_b128 a[164:167], v239 offset:2048
    v_sub_u32 v246, v246, v244
    v_mfma_f32_16x16x32_bf16 v[72:75], a[212:215], a[152:155], v[72:75]
    buffer_load_dwordx4 v209, s[36:39], s83 offen offset:1024 lds
    v_mfma_f32_16x16x32_bf16 v[40:43], a[212:215], a[148:151], v[40:43]
    ds_read_b128 a[168:171], v239 offset:4096
    v_add_u32 v241, s61, v246
    v_mfma_f32_16x16x32_bf16 v[8:11], a[212:215], a[144:147], v[8:11]
    ds_read_b128 a[172:175], v239 offset:6144
    s_lshl_b32 s71, s65, 2
    v_mfma_f32_16x16x32_bf16 v[12:15], a[216:219], a[144:147], v[12:15]
    ds_read_b64_tr_b16 a[180:181], v235 offset:16384
    s_add_u32 s71, s71, s54
    v_mfma_f32_16x16x32_bf16 v[44:47], a[216:219], a[148:151], v[44:47]
    ds_read_b64_tr_b16 a[182:183], v235 offset:17408
    s_lshl_b32 s71, s71, 10
    v_mfma_f32_16x16x32_bf16 v[76:79], a[216:219], a[152:155], v[76:79]
    buffer_load_dwordx4 v210, s[36:39], s83 offen offset:2048 lds
    v_mfma_f32_16x16x32_bf16 v[108:111], a[216:219], a[156:159], v[108:111]
    ds_read_b64_tr_b16 a[184:185], v236 offset:0
    s_add_u32 s71, s71, 262144
    v_mfma_f32_16x16x32_bf16 v[112:115], a[220:223], a[156:159], v[112:115]
    ds_read_b64_tr_b16 a[186:187], v236 offset:1024
    s_mul_i32 s72, s65, 196608
    v_mfma_f32_16x16x32_bf16 v[80:83], a[220:223], a[152:155], v[80:83]
    ds_read_b64_tr_b16 a[188:189], v236 offset:16384
    s_mul_i32 s61, s54, 12288
    v_mfma_f32_16x16x32_bf16 v[48:51], a[220:223], a[148:151], v[48:51]
    ds_read_b64_tr_b16 a[190:191], v236 offset:17408
    s_add_u32 s72, s72, s61
    v_mfma_f32_16x16x32_bf16 v[16:19], a[220:223], a[144:147], v[16:19]
    buffer_load_dwordx4 v211, s[36:39], s83 offen offset:3072 lds
    v_mfma_f32_16x16x32_bf16 v[20:23], a[224:227], a[144:147], v[20:23]
    ds_read_b64_tr_b16 a[192:193], v237 offset:0
    s_add_u32 s88, s88, 196608
    v_mfma_f32_16x16x32_bf16 v[52:55], a[224:227], a[148:151], v[52:55]
    ds_read_b64_tr_b16 a[194:195], v237 offset:1024
    s_add_u32 m0, s90, 65536
    v_mfma_f32_16x16x32_bf16 v[84:87], a[224:227], a[152:155], v[84:87]
    ds_read_b64_tr_b16 a[196:197], v237 offset:16384
    s_add_u32 s72, s72, 9437184
    v_mfma_f32_16x16x32_bf16 v[116:119], a[224:227], a[156:159], v[116:119]
    ds_read_b64_tr_b16 a[198:199], v237 offset:17408
    s_movk_i32 s73, 4096
    v_mfma_f32_16x16x32_bf16 v[120:123], a[228:231], a[156:159], v[120:123]
    buffer_load_dwordx4 v204, s[84:87], s88 offen offset:0 lds
    v_mfma_f32_16x16x32_bf16 v[88:91], a[228:231], a[152:155], v[88:91]
    ds_read_b64_tr_b16 a[200:201], v238 offset:0
    s_movk_i32 s74, 8192
    v_mfma_f32_16x16x32_bf16 v[56:59], a[228:231], a[148:151], v[56:59]
    ds_read_b64_tr_b16 a[202:203], v238 offset:1024
    s_add_u32 s61, s54, s66
    v_mfma_f32_16x16x32_bf16 v[24:27], a[228:231], a[144:147], v[24:27]
    ds_read_b64_tr_b16 a[204:205], v238 offset:16384
    s_lshl_b32 s61, s61, 3
    v_mfma_f32_16x16x32_bf16 v[28:31], a[232:235], a[144:147], v[28:31]
    ds_read_b64_tr_b16 a[206:207], v238 offset:17408
    s_lshr_b32 s61, 0xe4b47239, s61
    v_mfma_f32_16x16x32_bf16 v[60:63], a[232:235], a[148:151], v[60:63]
    buffer_load_dwordx4 v205, s[84:87], s88 offen offset:1024 lds
    v_mfma_f32_16x16x32_bf16 v[92:95], a[232:235], a[152:155], v[92:95]
    s_bfe_u32 s75, s61, 0x20000
    s_bfe_u32 s76, s61, 0x20002
    v_mfma_f32_16x16x32_bf16 v[124:127], a[232:235], a[156:159], v[124:127]
    s_bfe_u32 s77, s61, 0x20004
    s_bfe_u32 s78, s61, 0x20006
    v_mfma_f32_16x16x32_bf16 v[128:131], a[236:239], a[156:159], v[128:131]
    s_mul_i32 s62, s54, 3072
    v_add_u32 v227, s62, v252
    v_mfma_f32_16x16x32_bf16 v[96:99], a[236:239], a[152:155], v[96:99]
    s_xor_b32 s62, s54, 1
    s_mul_i32 s62, s62, 3072
    v_mfma_f32_16x16x32_bf16 v[64:67], a[236:239], a[148:151], v[64:67]
    buffer_load_dwordx4 v206, s[84:87], s88 offen offset:2048 lds
    v_mfma_f32_16x16x32_bf16 v[32:35], a[236:239], a[144:147], v[32:35]
    v_add_u32 v228, s62, v252
    s_waitcnt lgkmcnt(8)
    v_mfma_f32_16x16x32_bf16 v[4:7], a[176:179], a[160:163], v[4:7]
    ds_read_b64_tr_b16 a[208:209], v235 offset:8192
    v_subrev_u32 v239, 98304, v239
    v_mfma_f32_16x16x32_bf16 v[36:39], a[176:179], a[164:167], v[36:39]
    ds_read_b64_tr_b16 a[210:211], v235 offset:9216
    s_mul_i32 s57, s55, 24
    v_mfma_f32_16x16x32_bf16 v[68:71], a[176:179], a[168:171], v[68:71]
    ds_read_b128 a[144:147], v240 offset:0
    s_add_u32 s57, s57, s56
    v_mfma_f32_16x16x32_bf16 v[100:103], a[176:179], a[172:175], v[100:103]
    buffer_load_dwordx4 v207, s[84:87], s88 offen offset:3072 lds
    v_mfma_f32_16x16x32_bf16 v[104:107], a[180:183], a[172:175], v[104:107]
    ds_read_b128 a[148:151], v240 offset:2048
    s_add_u32 s89, s89, 196608
    v_mfma_f32_16x16x32_bf16 v[72:75], a[180:183], a[168:171], v[72:75]
    ds_read_b128 a[152:155], v240 offset:4096
    s_add_u32 m0, s90, 69632
    v_mfma_f32_16x16x32_bf16 v[40:43], a[180:183], a[164:167], v[40:43]
    ds_read_b128 a[156:159], v240 offset:6144
    v_subrev_u32 v240, 98304, v240
    v_mfma_f32_16x16x32_bf16 v[8:11], a[180:183], a[160:163], v[8:11]
    ds_read_b64_tr_b16 a[212:213], v235 offset:24576
    s_lshl_b32 s57, s57, 3
    v_mfma_f32_16x16x32_bf16 v[12:15], a[184:187], a[160:163], v[12:15]
    buffer_load_dwordx4 v204, s[84:87], s89 offen offset:0 lds
    v_mfma_f32_16x16x32_bf16 v[44:47], a[184:187], a[164:167], v[44:47]
    ds_read_b64_tr_b16 a[214:215], v235 offset:25600
    v_subrev_u32 v235, 98304, v235
    v_mfma_f32_16x16x32_bf16 v[76:79], a[184:187], a[168:171], v[76:79]
    ds_read_b64_tr_b16 a[216:217], v236 offset:8192
    s_add_u32 s57, s57, 4096
    v_mfma_f32_16x16x32_bf16 v[108:111], a[184:187], a[172:175], v[108:111]
    ds_read_b64_tr_b16 a[218:219], v236 offset:9216
    s_or_b32 s57, s57, s64
    v_mfma_f32_16x16x32_bf16 v[112:115], a[188:191], a[172:175], v[112:115]
    ds_read_b64_tr_b16 a[220:221], v236 offset:24576
    s_mul_i32 s62, s93, 1536
    v_mfma_f32_16x16x32_bf16 v[80:83], a[188:191], a[168:171], v[80:83]
    buffer_load_dwordx4 v205, s[84:87], s89 offen offset:1024 lds
    v_mfma_f32_16x16x32_bf16 v[48:51], a[188:191], a[164:167], v[48:51]
    ds_read_b64_tr_b16 a[222:223], v236 offset:25600
    v_subrev_u32 v236, 98304, v236
    v_mfma_f32_16x16x32_bf16 v[16:19], a[188:191], a[160:163], v[16:19]
    s_add_u32 s62, s62, 12288
    s_waitcnt lgkmcnt(12)
    v_mfma_f32_16x16x32_bf16 v[20:23], a[192:195], a[160:163], v[20:23]
    ds_read_b64_tr_b16 a[224:225], v237 offset:8192
    s_lshl_b32 s61, s92, 18
    v_mfma_f32_16x16x32_bf16 v[52:55], a[192:195], a[164:167], v[52:55]
    ds_read_b64_tr_b16 a[226:227], v237 offset:9216
    s_add_u32 s62, s62, s61
    v_mfma_f32_16x16x32_bf16 v[84:87], a[192:195], a[168:171], v[84:87]
    buffer_load_dwordx4 v206, s[84:87], s89 offen offset:2048 lds
    v_mfma_f32_16x16x32_bf16 v[116:119], a[192:195], a[172:175], v[116:119]
    ds_read_b64_tr_b16 a[228:229], v237 offset:24576
    v_and_b32 v244, 31, v255
    v_mfma_f32_16x16x32_bf16 v[120:123], a[196:199], a[172:175], v[120:123]
    ds_read_b64_tr_b16 a[230:231], v237 offset:25600
    v_subrev_u32 v237, 98304, v237
    v_mfma_f32_16x16x32_bf16 v[88:91], a[196:199], a[168:171], v[88:91]
    ds_read_b64_tr_b16 a[232:233], v238 offset:8192
    v_lshrrev_b32 v245, 5, v255
    v_mfma_f32_16x16x32_bf16 v[56:59], a[196:199], a[164:167], v[56:59]
    ds_read_b64_tr_b16 a[234:235], v238 offset:9216
    v_lshlrev_b32 v168, 4, v244
    v_mfma_f32_16x16x32_bf16 v[24:27], a[196:199], a[160:163], v[24:27]
    buffer_load_dwordx4 v207, s[84:87], s89 offen offset:3072 lds
    v_mfma_f32_16x16x32_bf16 v[28:31], a[200:203], a[160:163], v[28:31]
    ds_read_b64_tr_b16 a[236:237], v238 offset:24576
    s_add_u32 s83, s83, 128
    v_mfma_f32_16x16x32_bf16 v[60:63], a[200:203], a[164:167], v[60:63]
    ds_read_b64_tr_b16 a[238:239], v238 offset:25600
    v_subrev_u32 v238, 98304, v238
    v_mfma_f32_16x16x32_bf16 v[92:95], a[200:203], a[168:171], v[92:95]
    s_add_u32 m0, s91, 147456
    v_lshl_add_u32 v168, v245, 3, v168
    v_mfma_f32_16x16x32_bf16 v[124:127], a[200:203], a[172:175], v[124:127]
    v_add_u32 v168, s62, v168
    v_cmp_eq_u32 vcc, 0, v245
    v_mfma_f32_16x16x32_bf16 v[128:131], a[204:207], a[172:175], v[128:131]
    v_lshlrev_b32 v169, 3, v244
    v_add_u32 v169, 512, v169
    v_mfma_f32_16x16x32_bf16 v[96:99], a[204:207], a[168:171], v[96:99]
    v_lshlrev_b32 v170, 2, v244
    v_add_u32 v170, 768, v170
    v_mfma_f32_16x16x32_bf16 v[64:67], a[204:207], a[164:167], v[64:67]
    v_cndmask_b32 v169, v170, v169, vcc
    v_add_u32 v169, s62, v169
    v_mfma_f32_16x16x32_bf16 v[32:35], a[204:207], a[160:163], v[32:35]
    v_mul_u32_u24 v170, 124, v245
    s_waitcnt vmcnt(12) lgkmcnt(0)
    s_barrier
    v_mfma_f32_16x16x32_bf16 v[4:7], a[208:211], a[144:147], v[4:7]
    buffer_load_dwordx4 v208, s[36:39], s83 offen offset:0 lds
    v_mfma_f32_16x16x32_bf16 v[36:39], a[208:211], a[148:151], v[36:39]
    ds_read_b64_tr_b16 a[176:177], v235 offset:0
    v_add3_u32 v170, v169, v170, 4
    v_mfma_f32_16x16x32_bf16 v[68:71], a[208:211], a[152:155], v[68:71]
    ds_read_b64_tr_b16 a[178:179], v235 offset:1024
    v_lshlrev_b32 v171, 1, v244
    v_mfma_f32_16x16x32_bf16 v[100:103], a[208:211], a[156:159], v[100:103]
    ds_read_b128 a[160:163], v239 offset:0
    v_lshl_add_u32 v171, v245, 8, v171
    v_mfma_f32_16x16x32_bf16 v[104:107], a[212:215], a[156:159], v[104:107]
    ds_read_b128 a[164:167], v239 offset:2048
    v_add_u32 v171, s62, v171
    v_mfma_f32_16x16x32_bf16 v[72:75], a[212:215], a[152:155], v[72:75]
    buffer_load_dwordx4 v209, s[36:39], s83 offen offset:1024 lds
    v_mfma_f32_16x16x32_bf16 v[40:43], a[212:215], a[148:151], v[40:43]
    ds_read_b128 a[168:171], v239 offset:4096
    s_lshl_b32 s61, s82, 1
    v_mfma_f32_16x16x32_bf16 v[8:11], a[212:215], a[144:147], v[8:11]
    ds_read_b128 a[172:175], v239 offset:6144
    s_add_u32 s61, s61, s92
    v_mfma_f32_16x16x32_bf16 v[12:15], a[216:219], a[144:147], v[12:15]
    ds_read_b64_tr_b16 a[180:181], v235 offset:16384
    s_lshl_b32 s5, s61, 9
    v_mfma_f32_16x16x32_bf16 v[44:47], a[216:219], a[148:151], v[44:47]
    ds_read_b64_tr_b16 a[182:183], v235 offset:17408
    s_add_u32 s5, s5, 16384
    v_mfma_f32_16x16x32_bf16 v[76:79], a[216:219], a[152:155], v[76:79]
    buffer_load_dwordx4 v210, s[36:39], s83 offen offset:2048 lds
    v_mfma_f32_16x16x32_bf16 v[108:111], a[216:219], a[156:159], v[108:111]
    ds_read_b64_tr_b16 a[184:185], v236 offset:0
    s_lshr_b32 s7, s63, 2
    v_mfma_f32_16x16x32_bf16 v[112:115], a[220:223], a[156:159], v[112:115]
    ds_read_b64_tr_b16 a[186:187], v236 offset:1024
    s_lshl_b32 s7, s7, 2
    v_mfma_f32_16x16x32_bf16 v[80:83], a[220:223], a[152:155], v[80:83]
    ds_read_b64_tr_b16 a[188:189], v236 offset:16384
    s_add_u32 s7, s7, s54
    v_mfma_f32_16x16x32_bf16 v[48:51], a[220:223], a[148:151], v[48:51]
    ds_read_b64_tr_b16 a[190:191], v236 offset:17408
    s_lshl_b32 s7, s7, 12
    v_mfma_f32_16x16x32_bf16 v[16:19], a[220:223], a[144:147], v[16:19]
L_padG1:
    s_cmp_lg_u32 s3, 0
    s_cbranch_scc1 L_padT2
    buffer_load_dwordx4 v211, s[36:39], s83 offen offset:3072 lds
    v_mfma_f32_16x16x32_bf16 v[20:23], a[224:227], a[144:147], v[20:23]
    ds_read_b64_tr_b16 a[192:193], v237 offset:0
    s_add_u32 s88, s88, 196608
    v_mfma_f32_16x16x32_bf16 v[52:55], a[224:227], a[148:151], v[52:55]
    ds_read_b64_tr_b16 a[194:195], v237 offset:1024
    s_add_u32 m0, s90, 114688
    v_mfma_f32_16x16x32_bf16 v[84:87], a[224:227], a[152:155], v[84:87]
    ds_read_b64_tr_b16 a[196:197], v237 offset:16384
    s_and_b32 s62, s63, 2
    v_mfma_f32_16x16x32_bf16 v[116:119], a[224:227], a[156:159], v[116:119]
    ds_read_b64_tr_b16 a[198:199], v237 offset:17408
    s_lshl_b32 s62, s62, 4
    v_mfma_f32_16x16x32_bf16 v[120:123], a[228:231], a[156:159], v[120:123]
    buffer_load_dwordx4 v204, s[84:87], s88 offen offset:0 lds
    v_mfma_f32_16x16x32_bf16 v[88:91], a[228:231], a[152:155], v[88:91]
    ds_read_b64_tr_b16 a[200:201], v238 offset:0
    s_add_u32 s7, s7, s62
    v_mfma_f32_16x16x32_bf16 v[56:59], a[228:231], a[148:151], v[56:59]
    ds_read_b64_tr_b16 a[202:203], v238 offset:1024
    s_add_u32 s7, s7, 1048576
    v_mfma_f32_16x16x32_bf16 v[24:27], a[228:231], a[144:147], v[24:27]
    ds_read_b64_tr_b16 a[204:205], v238 offset:16384
    s_lshl_b32 s8, s54, 11
    v_mfma_f32_16x16x32_bf16 v[28:31], a[232:235], a[144:147], v[28:31]
    ds_read_b64_tr_b16 a[206:207], v238 offset:17408
    s_add_u32 s8, s8, 131072
    v_mfma_f32_16x16x32_bf16 v[60:63], a[232:235], a[148:151], v[60:63]
    buffer_load_dwordx4 v205, s[84:87], s88 offen offset:1024 lds
    v_mfma_f32_16x16x32_bf16 v[92:95], a[232:235], a[152:155], v[92:95]
    v_lshrrev_b32 v226, 2, v255
    v_lshlrev_b32 v226, 7, v226
    v_mfma_f32_16x16x32_bf16 v[124:127], a[232:235], a[156:159], v[124:127]
    v_lshlrev_b32 v220, 3, v254
    v_lshrrev_b32 v244, 1, v255
    v_mfma_f32_16x16x32_bf16 v[128:131], a[236:239], a[156:159], v[128:131]
    v_and_b32 v245, 1, v255
    v_lshlrev_b32 v223, 6, v244
    v_mfma_f32_16x16x32_bf16 v[96:99], a[236:239], a[152:155], v[96:99]
    v_lshl_add_u32 v223, v245, 4, v223
    v_mul_u32_u24 v245, 8656, v245
    v_mfma_f32_16x16x32_bf16 v[64:67], a[236:239], a[148:151], v[64:67]
    buffer_load_dwordx4 v206, s[84:87], s88 offen offset:2048 lds
    v_mfma_f32_16x16x32_bf16 v[32:35], a[236:239], a[144:147], v[32:35]
    v_lshl_add_u32 v224, v244, 5, v245
    s_waitcnt lgkmcnt(8)
    v_mfma_f32_16x16x32_bf16 v[4:7], a[176:179], a[160:163], v[4:7]
    ds_read_b64_tr_b16 a[208:209], v235 offset:8192
    v_add_u32 v239, 49152, v239
    v_mfma_f32_16x16x32_bf16 v[36:39], a[176:179], a[164:167], v[36:39]
    ds_read_b64_tr_b16 a[210:211], v235 offset:9216
    s_lshl_b32 s62, s54, 11
    v_mfma_f32_16x16x32_bf16 v[68:71], a[176:179], a[168:171], v[68:71]
    ds_read_b128 a[144:147], v240 offset:0
    s_add_u32 s62, s62, 123520
    v_mfma_f32_16x16x32_bf16 v[100:103], a[176:179], a[172:175], v[100:103]
    buffer_load_dwordx4 v207, s[84:87], s88 offen offset:3072 lds
    v_mfma_f32_16x16x32_bf16 v[104:107], a[180:183], a[172:175], v[104:107]
    ds_read_b128 a[148:151], v240 offset:2048
    s_add_u32 s89, s89, 196608
    v_mfma_f32_16x16x32_bf16 v[72:75], a[180:183], a[168:171], v[72:75]
    ds_read_b128 a[152:155], v240 offset:4096
    s_add_u32 m0, s90, 118784
    v_mfma_f32_16x16x32_bf16 v[40:43], a[180:183], a[164:167], v[40:43]
    ds_read_b128 a[156:159], v240 offset:6144
    v_add_u32 v240, 49152, v240
    v_mfma_f32_16x16x32_bf16 v[8:11], a[180:183], a[160:163], v[8:11]
    ds_read_b64_tr_b16 a[212:213], v235 offset:24576
    v_add_u32 v224, s62, v224
    v_mfma_f32_16x16x32_bf16 v[12:15], a[184:187], a[160:163], v[12:15]
    buffer_load_dwordx4 v204, s[84:87], s89 offen offset:0 lds
    v_mfma_f32_16x16x32_bf16 v[44:47], a[184:187], a[164:167], v[44:47]
    ds_read_b64_tr_b16 a[214:215], v235 offset:25600
    v_add_u32 v235, 49152, v235
    v_mfma_f32_16x16x32_bf16 v[76:79], a[184:187], a[168:171], v[76:79]
    ds_read_b64_tr_b16 a[216:217], v236 offset:8192
    s_lshr_b32 s62, s55, 1
    v_mfma_f32_16x16x32_bf16 v[108:111], a[184:187], a[172:175], v[108:111]
    ds_read_b64_tr_b16 a[218:219], v236 offset:9216
    s_lshl_b32 s68, s61, 2
    v_mfma_f32_16x16x32_bf16 v[112:115], a[188:191], a[172:175], v[112:115]
    ds_read_b64_tr_b16 a[220:221], v236 offset:24576
    s_add_u32 s68, s68, s62
    v_mfma_f32_16x16x32_bf16 v[80:83], a[188:191], a[168:171], v[80:83]
    buffer_load_dwordx4 v205, s[84:87], s89 offen offset:1024 lds
    v_mfma_f32_16x16x32_bf16 v[48:51], a[188:191], a[164:167], v[48:51]
    ds_read_b64_tr_b16 a[222:223], v236 offset:25600
    v_add_u32 v236, 49152, v236
    v_mfma_f32_16x16x32_bf16 v[16:19], a[188:191], a[160:163], v[16:19]
    s_lshl_b32 s68, s68, 2
    s_waitcnt lgkmcnt(12)
    v_mfma_f32_16x16x32_bf16 v[20:23], a[192:195], a[160:163], v[20:23]
    ds_read_b64_tr_b16 a[224:225], v237 offset:8192
    s_lshr_b32 s62, s56, 3
    v_mfma_f32_16x16x32_bf16 v[52:55], a[192:195], a[164:167], v[52:55]
    ds_read_b64_tr_b16 a[226:227], v237 offset:9216
    s_add_u32 s68, s68, s62
    v_mfma_f32_16x16x32_bf16 v[84:87], a[192:195], a[168:171], v[84:87]
    buffer_load_dwordx4 v206, s[84:87], s89 offen offset:2048 lds
    v_mfma_f32_16x16x32_bf16 v[116:119], a[192:195], a[172:175], v[116:119]
    ds_read_b64_tr_b16 a[228:229], v237 offset:24576
    s_lshl_b32 s68, s68, 1
    v_mfma_f32_16x16x32_bf16 v[120:123], a[196:199], a[172:175], v[120:123]
    ds_read_b64_tr_b16 a[230:231], v237 offset:25600
    v_add_u32 v237, 49152, v237
    v_mfma_f32_16x16x32_bf16 v[88:91], a[196:199], a[168:171], v[88:91]
    ds_read_b64_tr_b16 a[232:233], v238 offset:8192
    s_add_u32 s68, s68, s93
    v_mfma_f32_16x16x32_bf16 v[56:59], a[196:199], a[164:167], v[56:59]
    ds_read_b64_tr_b16 a[234:235], v238 offset:9216
    s_lshl_b32 s68, s68, 7
    v_mfma_f32_16x16x32_bf16 v[24:27], a[196:199], a[160:163], v[24:27]
    buffer_load_dwordx4 v207, s[84:87], s89 offen offset:3072 lds
    v_mfma_f32_16x16x32_bf16 v[28:31], a[200:203], a[160:163], v[28:31]
    ds_read_b64_tr_b16 a[236:237], v238 offset:24576
    s_add_u32 s83, s83, 128
    v_mfma_f32_16x16x32_bf16 v[60:63], a[200:203], a[164:167], v[60:63]
    ds_read_b64_tr_b16 a[238:239], v238 offset:25600
    v_add_u32 v238, 49152, v238
    v_mfma_f32_16x16x32_bf16 v[92:95], a[200:203], a[168:171], v[92:95]
    s_add_u32 m0, s91, 49152
    s_add_u32 s68, s68, 262144
    v_mfma_f32_16x16x32_bf16 v[124:127], a[200:203], a[172:175], v[124:127]
    s_mul_i32 s4, s61, 96
    s_lshl_b32 s62, s81, 1
    v_mfma_f32_16x16x32_bf16 v[128:131], a[204:207], a[172:175], v[128:131]
    s_add_u32 s62, s62, s93
    s_add_u32 s4, s4, s62
    v_mfma_f32_16x16x32_bf16 v[96:99], a[204:207], a[168:171], v[96:99]
    s_lshl_b32 s4, s4, 11
    s_add_u32 s4, s4, 9437184
    v_mfma_f32_16x16x32_bf16 v[64:67], a[204:207], a[164:167], v[64:67]
    s_lshl_b32 s6, s62, 8
    s_add_u32 s6, s6, 65536
    v_mfma_f32_16x16x32_bf16 v[32:35], a[204:207], a[160:163], v[32:35]
    s_lshl_b32 s9, s62, 11
    s_waitcnt vmcnt(12) lgkmcnt(0)
    s_barrier
    v_mfma_f32_16x16x32_bf16 v[4:7], a[208:211], a[144:147], v[4:7]
    buffer_load_dwordx4 v208, s[36:39], s83 offen offset:0 lds
    v_mfma_f32_16x16x32_bf16 v[36:39], a[208:211], a[148:151], v[36:39]
    ds_read_b64_tr_b16 a[176:177], v235 offset:0
    s_add_u32 s9, s9, 196608
    v_mfma_f32_16x16x32_bf16 v[68:71], a[208:211], a[152:155], v[68:71]
    ds_read_b64_tr_b16 a[178:179], v235 offset:1024
    v_and_b32 v221, 1, v253
    v_mfma_f32_16x16x32_bf16 v[100:103], a[208:211], a[156:159], v[100:103]
    ds_read_b128 a[160:163], v239 offset:0
    v_mul_u32_u24 v221, 30720, v221
    v_mfma_f32_16x16x32_bf16 v[104:107], a[212:215], a[156:159], v[104:107]
    ds_read_b128 a[164:167], v239 offset:2048
    v_lshl_add_u32 v221, v254, 2, v221
    v_mfma_f32_16x16x32_bf16 v[72:75], a[212:215], a[152:155], v[72:75]
    buffer_load_dwordx4 v209, s[36:39], s83 offen offset:1024 lds
    v_mfma_f32_16x16x32_bf16 v[40:43], a[212:215], a[148:151], v[40:43]
    ds_read_b128 a[168:171], v239 offset:4096
    v_lshrrev_b32 v222, 1, v253
    v_mfma_f32_16x16x32_bf16 v[8:11], a[212:215], a[144:147], v[8:11]
    ds_read_b128 a[172:175], v239 offset:6144
    v_lshl_add_u32 v221, v222, 6, v221
    v_mfma_f32_16x16x32_bf16 v[12:15], a[216:219], a[144:147], v[12:15]
    ds_read_b64_tr_b16 a[180:181], v235 offset:16384
    s_mul_i32 s61, s54, 8656
    v_mfma_f32_16x16x32_bf16 v[44:47], a[216:219], a[148:151], v[44:47]
    ds_read_b64_tr_b16 a[182:183], v235 offset:17408
    s_add_u32 s61, s61, 123520
    v_mfma_f32_16x16x32_bf16 v[76:79], a[216:219], a[152:155], v[76:79]
    buffer_load_dwordx4 v210, s[36:39], s83 offen offset:2048 lds
    v_mfma_f32_16x16x32_bf16 v[108:111], a[216:219], a[156:159], v[108:111]
    ds_read_b64_tr_b16 a[184:185], v236 offset:0
    s_lshl_b32 s58, s93, 18
    v_mfma_f32_16x16x32_bf16 v[112:115], a[220:223], a[156:159], v[112:115]
    ds_read_b64_tr_b16 a[186:187], v236 offset:1024
    s_add_u32 s61, s61, s58
    v_mfma_f32_16x16x32_bf16 v[80:83], a[220:223], a[152:155], v[80:83]
    ds_read_b64_tr_b16 a[188:189], v236 offset:16384
    s_mul_i32 s62, s54, 4224
    v_mfma_f32_16x16x32_bf16 v[48:51], a[220:223], a[148:151], v[48:51]
    ds_read_b64_tr_b16 a[190:191], v236 offset:17408
    s_add_u32 s62, s62, 114816
    v_mfma_f32_16x16x32_bf16 v[16:19], a[220:223], a[144:147], v[16:19]
    buffer_load_dwordx4 v211, s[36:39], s83 offen offset:3072 lds
    v_mfma_f32_16x16x32_bf16 v[20:23], a[224:227], a[144:147], v[20:23]
    ds_read_b64_tr_b16 a[192:193], v237 offset:0
    s_add_u32 s88, s88, 196608
    v_mfma_f32_16x16x32_bf16 v[52:55], a[224:227], a[148:151], v[52:55]
    ds_read_b64_tr_b16 a[194:195], v237 offset:1024
    s_add_u32 m0, s90, 16384
    v_mfma_f32_16x16x32_bf16 v[84:87], a[224:227], a[152:155], v[84:87]
    ds_read_b64_tr_b16 a[196:197], v237 offset:16384
    s_add_u32 s62, s62, s58
    v_mfma_f32_16x16x32_bf16 v[116:119], a[224:227], a[156:159], v[116:119]
    ds_read_b64_tr_b16 a[198:199], v237 offset:17408
    s_sub_u32 s61, s61, 384
    v_mfma_f32_16x16x32_bf16 v[120:123], a[228:231], a[156:159], v[120:123]
    buffer_load_dwordx4 v204, s[84:87], s88 offen offset:0 lds
    v_mfma_f32_16x16x32_bf16 v[88:91], a[228:231], a[152:155], v[88:91]
    ds_read_b64_tr_b16 a[200:201], v238 offset:0
    v_lshl_add_u32 v225, v255, 3, s61
    v_mfma_f32_16x16x32_bf16 v[56:59], a[228:231], a[148:151], v[56:59]
    ds_read_b64_tr_b16 a[202:203], v238 offset:1024
    s_sub_u32 s61, s61, 384
    v_mfma_f32_16x16x32_bf16 v[24:27], a[228:231], a[144:147], v[24:27]
    ds_read_b64_tr_b16 a[204:205], v238 offset:16384
    v_lshl_add_u32 v244, v255, 4, s61
    v_mfma_f32_16x16x32_bf16 v[28:31], a[232:235], a[144:147], v[28:31]
    ds_read_b64_tr_b16 a[206:207], v238 offset:17408
    v_cmp_lt_u32 vcc, 47, v255
    v_mfma_f32_16x16x32_bf16 v[60:63], a[232:235], a[148:151], v[60:63]
    buffer_load_dwordx4 v205, s[84:87], s88 offen offset:1024 lds
    v_mfma_f32_16x16x32_bf16 v[92:95], a[232:235], a[152:155], v[92:95]
    s_sub_u32 s62, s62, 448
    v_mov_b32 v246, 262144
    v_mfma_f32_16x16x32_bf16 v[124:127], a[232:235], a[156:159], v[124:127]
    v_cndmask_b32 v225, v225, v244, vcc
    v_lshl_add_u32 v244, v255, 3, s62
    v_mfma_f32_16x16x32_bf16 v[128:131], a[236:239], a[156:159], v[128:131]
    v_cmp_lt_u32 vcc, 51, v255
    s_nop 0
    v_mfma_f32_16x16x32_bf16 v[96:99], a[236:239], a[152:155], v[96:99]
    s_nop 0
    v_cndmask_b32 v225, v225, v244, vcc
    v_mfma_f32_16x16x32_bf16 v[64:67], a[236:239], a[148:151], v[64:67]
    buffer_load_dwordx4 v206, s[84:87], s88 offen offset:2048 lds
    v_mfma_f32_16x16x32_bf16 v[32:35], a[236:239], a[144:147], v[32:35]
    v_cmp_lt_u32 vcc, 55, v255
    s_waitcnt lgkmcnt(8)
    v_mfma_f32_16x16x32_bf16 v[4:7], a[176:179], a[160:163], v[4:7]
    ds_read_b64_tr_b16 a[208:209], v235 offset:8192
    v_add_u32 v239, 49152, v239
    v_mfma_f32_16x16x32_bf16 v[36:39], a[176:179], a[164:167], v[36:39]
    ds_read_b64_tr_b16 a[210:211], v235 offset:9216
    s_nop 0
    v_mfma_f32_16x16x32_bf16 v[68:71], a[176:179], a[168:171], v[68:71]
    ds_read_b128 a[144:147], v240 offset:0
    s_nop 0
    v_mfma_f32_16x16x32_bf16 v[100:103], a[176:179], a[172:175], v[100:103]
    buffer_load_dwordx4 v207, s[84:87], s88 offen offset:3072 lds
    v_mfma_f32_16x16x32_bf16 v[104:107], a[180:183], a[172:175], v[104:107]
    ds_read_b128 a[148:151], v240 offset:2048
    s_add_u32 s89, s89, 196608
    v_mfma_f32_16x16x32_bf16 v[72:75], a[180:183], a[168:171], v[72:75]
    ds_read_b128 a[152:155], v240 offset:4096
    s_add_u32 m0, s90, 20480
    v_mfma_f32_16x16x32_bf16 v[40:43], a[180:183], a[164:167], v[40:43]
    ds_read_b128 a[156:159], v240 offset:6144
    v_add_u32 v240, 49152, v240
    v_mfma_f32_16x16x32_bf16 v[8:11], a[180:183], a[160:163], v[8:11]
    ds_read_b64_tr_b16 a[212:213], v235 offset:24576
    v_cndmask_b32 v225, v225, v246, vcc
    v_mfma_f32_16x16x32_bf16 v[12:15], a[184:187], a[160:163], v[12:15]
    buffer_load_dwordx4 v204, s[84:87], s89 offen offset:0 lds
    v_mfma_f32_16x16x32_bf16 v[44:47], a[184:187], a[164:167], v[44:47]
    ds_read_b64_tr_b16 a[214:215], v235 offset:25600
    v_add_u32 v235, 49152, v235
    v_mfma_f32_16x16x32_bf16 v[76:79], a[184:187], a[168:171], v[76:79]
    ds_read_b64_tr_b16 a[216:217], v236 offset:8192
    v_cmp_gt_u32 vcc, 32, v0
    v_mfma_f32_16x16x32_bf16 v[108:111], a[184:187], a[172:175], v[108:111]
    ds_read_b64_tr_b16 a[218:219], v236 offset:9216
    s_movk_i32 s61, 0x202
    v_mfma_f32_16x16x32_bf16 v[112:115], a[188:191], a[172:175], v[112:115]
    ds_read_b64_tr_b16 a[220:221], v236 offset:24576
    v_lshl_add_u32 v244, v0, 3, 0
    v_mfma_f32_16x16x32_bf16 v[80:83], a[188:191], a[168:171], v[80:83]
    buffer_load_dwordx4 v205, s[84:87], s89 offen offset:1024 lds
    v_mfma_f32_16x16x32_bf16 v[48:51], a[188:191], a[164:167], v[48:51]
    ds_read_b64_tr_b16 a[222:223], v236 offset:25600
    v_add_u32 v236, 49152, v236
    v_mfma_f32_16x16x32_bf16 v[16:19], a[188:191], a[160:163], v[16:19]
    v_lshl_add_u32 v245, v0, 3, 1
    s_waitcnt lgkmcnt(12)
    v_mfma_f32_16x16x32_bf16 v[20:23], a[192:195], a[160:163], v[20:23]
    ds_read_b64_tr_b16 a[224:225], v237 offset:8192
    v_cvt_f32_u32 v246, v244
    v_mfma_f32_16x16x32_bf16 v[52:55], a[192:195], a[164:167], v[52:55]
    ds_read_b64_tr_b16 a[226:227], v237 offset:9216
    v_cvt_f32_u32 v247, v245
    v_mfma_f32_16x16x32_bf16 v[84:87], a[192:195], a[168:171], v[84:87]
    buffer_load_dwordx4 v206, s[84:87], s89 offen offset:2048 lds
    v_mfma_f32_16x16x32_bf16 v[116:119], a[192:195], a[172:175], v[116:119]
    ds_read_b64_tr_b16 a[228:229], v237 offset:24576
    v_cvt_pk_bf16_f32 v246, v246, v247
    v_mfma_f32_16x16x32_bf16 v[120:123], a[196:199], a[172:175], v[120:123]
    ds_read_b64_tr_b16 a[230:231], v237 offset:25600
    v_add_u32 v237, 49152, v237
    v_mfma_f32_16x16x32_bf16 v[88:91], a[196:199], a[168:171], v[88:91]
    ds_read_b64_tr_b16 a[232:233], v238 offset:8192
    v_lshrrev_b32 v247, 16, v246
    v_mfma_f32_16x16x32_bf16 v[56:59], a[196:199], a[164:167], v[56:59]
    ds_read_b64_tr_b16 a[234:235], v238 offset:9216
    v_and_b32 v246, 0xffff, v246
    v_mfma_f32_16x16x32_bf16 v[24:27], a[196:199], a[160:163], v[24:27]
    buffer_load_dwordx4 v207, s[84:87], s89 offen offset:3072 lds
    v_mfma_f32_16x16x32_bf16 v[28:31], a[200:203], a[160:163], v[28:31]
    ds_read_b64_tr_b16 a[236:237], v238 offset:24576
    s_add_u32 s83, s83, 128
    v_mfma_f32_16x16x32_bf16 v[60:63], a[200:203], a[164:167], v[60:63]
    ds_read_b64_tr_b16 a[238:239], v238 offset:25600
    v_add_u32 v238, 49152, v238
    v_mfma_f32_16x16x32_bf16 v[92:95], a[200:203], a[168:171], v[92:95]
    s_add_u32 m0, s91, 98304
    v_subrev_u32 v246, 17024, v246
    v_mfma_f32_16x16x32_bf16 v[124:127], a[200:203], a[172:175], v[124:127]
    v_subrev_u32 v247, 17024, v247
    v_cndmask_b32 v244, v246, v244, vcc
    v_mfma_f32_16x16x32_bf16 v[128:131], a[204:207], a[172:175], v[128:131]
    v_cndmask_b32 v245, v247, v245, vcc
    v_and_b32 v248, -2, v244
    v_mfma_f32_16x16x32_bf16 v[96:99], a[204:207], a[168:171], v[96:99]
    v_lshlrev_b32 v172, 1, v248
    v_add_u32 v172, 12288, v172
    v_mfma_f32_16x16x32_bf16 v[64:67], a[204:207], a[164:167], v[64:67]
    v_sub_u32 v244, v244, v248
    v_sub_u32 v245, v245, v248
    v_mfma_f32_16x16x32_bf16 v[32:35], a[204:207], a[160:163], v[32:35]
    v_lshl_add_u32 v244, v245, 16, v244
    s_waitcnt vmcnt(12) lgkmcnt(0)
    s_barrier
    v_mfma_f32_16x16x32_bf16 v[4:7], a[208:211], a[144:147], v[4:7]
    buffer_load_dwordx4 v208, s[36:39], s83 offen offset:0 lds
    v_mfma_f32_16x16x32_bf16 v[36:39], a[208:211], a[148:151], v[36:39]
    ds_read_b64_tr_b16 a[176:177], v235 offset:0
    v_mul_lo_u32 v244, v244, s61
    v_mfma_f32_16x16x32_bf16 v[68:71], a[208:211], a[152:155], v[68:71]
    ds_read_b64_tr_b16 a[178:179], v235 offset:1024
    v_add_u32 v229, 0x01000100, v244
    v_mfma_f32_16x16x32_bf16 v[100:103], a[208:211], a[156:159], v[100:103]
    ds_read_b128 a[160:163], v239 offset:0
    v_lshl_add_u32 v244, v0, 3, 2
    v_mfma_f32_16x16x32_bf16 v[104:107], a[212:215], a[156:159], v[104:107]
    ds_read_b128 a[164:167], v239 offset:2048
    v_lshl_add_u32 v245, v0, 3, 3
    v_mfma_f32_16x16x32_bf16 v[72:75], a[212:215], a[152:155], v[72:75]
    buffer_load_dwordx4 v209, s[36:39], s83 offen offset:1024 lds
    v_mfma_f32_16x16x32_bf16 v[40:43], a[212:215], a[148:151], v[40:43]
    ds_read_b128 a[168:171], v239 offset:4096
    v_cvt_f32_u32 v246, v244
    v_mfma_f32_16x16x32_bf16 v[8:11], a[212:215], a[144:147], v[8:11]
    ds_read_b128 a[172:175], v239 offset:6144
    v_cvt_f32_u32 v247, v245
    v_mfma_f32_16x16x32_bf16 v[12:15], a[216:219], a[144:147], v[12:15]
    ds_read_b64_tr_b16 a[180:181], v235 offset:16384
    v_cvt_pk_bf16_f32 v246, v246, v247
    v_mfma_f32_16x16x32_bf16 v[44:47], a[216:219], a[148:151], v[44:47]
    ds_read_b64_tr_b16 a[182:183], v235 offset:17408
    v_lshrrev_b32 v247, 16, v246
    v_mfma_f32_16x16x32_bf16 v[76:79], a[216:219], a[152:155], v[76:79]
    buffer_load_dwordx4 v210, s[36:39], s83 offen offset:2048 lds
    v_mfma_f32_16x16x32_bf16 v[108:111], a[216:219], a[156:159], v[108:111]
    ds_read_b64_tr_b16 a[184:185], v236 offset:0
    v_and_b32 v246, 0xffff, v246
    v_mfma_f32_16x16x32_bf16 v[112:115], a[220:223], a[156:159], v[112:115]
    ds_read_b64_tr_b16 a[186:187], v236 offset:1024
    v_subrev_u32 v246, 17024, v246
    v_mfma_f32_16x16x32_bf16 v[80:83], a[220:223], a[152:155], v[80:83]
    ds_read_b64_tr_b16 a[188:189], v236 offset:16384
    v_subrev_u32 v247, 17024, v247
    v_mfma_f32_16x16x32_bf16 v[48:51], a[220:223], a[148:151], v[48:51]
    ds_read_b64_tr_b16 a[190:191], v236 offset:17408
    v_cndmask_b32 v244, v246, v244, vcc
    v_mfma_f32_16x16x32_bf16 v[16:19], a[220:223], a[144:147], v[16:19]
    buffer_load_dwordx4 v211, s[36:39], s83 offen offset:3072 lds
    v_mfma_f32_16x16x32_bf16 v[20:23], a[224:227], a[144:147], v[20:23]
    ds_read_b64_tr_b16 a[192:193], v237 offset:0
    s_add_u32 s88, s88, 196608
    v_mfma_f32_16x16x32_bf16 v[52:55], a[224:227], a[148:151], v[52:55]
    ds_read_b64_tr_b16 a[194:195], v237 offset:1024
    s_add_u32 m0, s90, 65536
    v_mfma_f32_16x16x32_bf16 v[84:87], a[224:227], a[152:155], v[84:87]
    ds_read_b64_tr_b16 a[196:197], v237 offset:16384
    v_cndmask_b32 v245, v247, v245, vcc
    v_mfma_f32_16x16x32_bf16 v[116:119], a[224:227], a[156:159], v[116:119]
    ds_read_b64_tr_b16 a[198:199], v237 offset:17408
    v_sub_u32 v244, v244, v248
    v_mfma_f32_16x16x32_bf16 v[120:123], a[228:231], a[156:159], v[120:123]
    buffer_load_dwordx4 v204, s[84:87], s88 offen offset:0 lds
    v_mfma_f32_16x16x32_bf16 v[88:91], a[228:231], a[152:155], v[88:91]
    ds_read_b64_tr_b16 a[200:201], v238 offset:0
    v_sub_u32 v245, v245, v248
    v_mfma_f32_16x16x32_bf16 v[56:59], a[228:231], a[148:151], v[56:59]
    ds_read_b64_tr_b16 a[202:203], v238 offset:1024
    v_lshl_add_u32 v244, v245, 16, v244
    v_mfma_f32_16x16x32_bf16 v[24:27], a[228:231], a[144:147], v[24:27]
    ds_read_b64_tr_b16 a[204:205], v238 offset:16384
    v_mul_lo_u32 v244, v244, s61
    v_mfma_f32_16x16x32_bf16 v[28:31], a[232:235], a[144:147], v[28:31]
    ds_read_b64_tr_b16 a[206:207], v238 offset:17408
    v_add_u32 v230, 0x01000100, v244
    v_mfma_f32_16x16x32_bf16 v[60:63], a[232:235], a[148:151], v[60:63]
    buffer_load_dwordx4 v205, s[84:87], s88 offen offset:1024 lds
    v_mfma_f32_16x16x32_bf16 v[92:95], a[232:235], a[152:155], v[92:95]
    v_lshl_add_u32 v244, v0, 3, 4
    v_lshl_add_u32 v245, v0, 3, 5
    v_mfma_f32_16x16x32_bf16 v[124:127], a[232:235], a[156:159], v[124:127]
    v_cvt_f32_u32 v246, v244
    v_cvt_f32_u32 v247, v245
    v_mfma_f32_16x16x32_bf16 v[128:131], a[236:239], a[156:159], v[128:131]
    v_cvt_pk_bf16_f32 v246, v246, v247
    v_lshrrev_b32 v247, 16, v246
    v_mfma_f32_16x16x32_bf16 v[96:99], a[236:239], a[152:155], v[96:99]
    v_and_b32 v246, 0xffff, v246
    v_subrev_u32 v246, 17024, v246
    v_mfma_f32_16x16x32_bf16 v[64:67], a[236:239], a[148:151], v[64:67]
    buffer_load_dwordx4 v206, s[84:87], s88 offen offset:2048 lds
    v_mfma_f32_16x16x32_bf16 v[32:35], a[236:239], a[144:147], v[32:35]
    v_subrev_u32 v247, 17024, v247
    s_waitcnt lgkmcnt(8)
    v_mfma_f32_16x16x32_bf16 v[4:7], a[176:179], a[160:163], v[4:7]
    ds_read_b64_tr_b16 a[208:209], v235 offset:8192
    v_subrev_u32 v239, 98304, v239
    v_mfma_f32_16x16x32_bf16 v[36:39], a[176:179], a[164:167], v[36:39]
    ds_read_b64_tr_b16 a[210:211], v235 offset:9216
    v_cndmask_b32 v244, v246, v244, vcc
    v_mfma_f32_16x16x32_bf16 v[68:71], a[176:179], a[168:171], v[68:71]
    ds_read_b128 a[144:147], v240 offset:0
    v_cndmask_b32 v245, v247, v245, vcc
    v_mfma_f32_16x16x32_bf16 v[100:103], a[176:179], a[172:175], v[100:103]
    buffer_load_dwordx4 v207, s[84:87], s88 offen offset:3072 lds
    v_mfma_f32_16x16x32_bf16 v[104:107], a[180:183], a[172:175], v[104:107]
    ds_read_b128 a[148:151], v240 offset:2048
    s_add_u32 s89, s89, 196608
    v_mfma_f32_16x16x32_bf16 v[72:75], a[180:183], a[168:171], v[72:75]
    ds_read_b128 a[152:155], v240 offset:4096
    s_add_u32 m0, s90, 69632
    v_mfma_f32_16x16x32_bf16 v[40:43], a[180:183], a[164:167], v[40:43]
    ds_read_b128 a[156:159], v240 offset:6144
    v_subrev_u32 v240, 98304, v240
    v_mfma_f32_16x16x32_bf16 v[8:11], a[180:183], a[160:163], v[8:11]
    ds_read_b64_tr_b16 a[212:213], v235 offset:24576
    v_and_b32 v248, -2, v244
    v_mfma_f32_16x16x32_bf16 v[12:15], a[184:187], a[160:163], v[12:15]
    buffer_load_dwordx4 v204, s[84:87], s89 offen offset:0 lds
    v_mfma_f32_16x16x32_bf16 v[44:47], a[184:187], a[164:167], v[44:47]
    ds_read_b64_tr_b16 a[214:215], v235 offset:25600
    v_subrev_u32 v235, 98304, v235
    v_mfma_f32_16x16x32_bf16 v[76:79], a[184:187], a[168:171], v[76:79]
    ds_read_b64_tr_b16 a[216:217], v236 offset:8192
    v_lshlrev_b32 v173, 1, v248
    v_mfma_f32_16x16x32_bf16 v[108:111], a[184:187], a[172:175], v[108:111]
    ds_read_b64_tr_b16 a[218:219], v236 offset:9216
    v_add_u32 v173, 12288, v173
    v_mfma_f32_16x16x32_bf16 v[112:115], a[188:191], a[172:175], v[112:115]
    ds_read_b64_tr_b16 a[220:221], v236 offset:24576
    v_sub_u32 v244, v244, v248
    v_mfma_f32_16x16x32_bf16 v[80:83], a[188:191], a[168:171], v[80:83]
    buffer_load_dwordx4 v205, s[84:87], s89 offen offset:1024 lds
    v_mfma_f32_16x16x32_bf16 v[48:51], a[188:191], a[164:167], v[48:51]
    ds_read_b64_tr_b16 a[222:223], v236 offset:25600
    v_subrev_u32 v236, 98304, v236
    v_mfma_f32_16x16x32_bf16 v[16:19], a[188:191], a[160:163], v[16:19]
    v_sub_u32 v245, v245, v248
    s_waitcnt lgkmcnt(12)
    v_mfma_f32_16x16x32_bf16 v[20:23], a[192:195], a[160:163], v[20:23]
    ds_read_b64_tr_b16 a[224:225], v237 offset:8192
    v_lshl_add_u32 v244, v245, 16, v244
    v_mfma_f32_16x16x32_bf16 v[52:55], a[192:195], a[164:167], v[52:55]
    ds_read_b64_tr_b16 a[226:227], v237 offset:9216
    v_mul_lo_u32 v244, v244, s61
    v_mfma_f32_16x16x32_bf16 v[84:87], a[192:195], a[168:171], v[84:87]
    buffer_load_dwordx4 v206, s[84:87], s89 offen offset:2048 lds
    v_mfma_f32_16x16x32_bf16 v[116:119], a[192:195], a[172:175], v[116:119]
    ds_read_b64_tr_b16 a[228:229], v237 offset:24576
    v_add_u32 v231, 0x01000100, v244
    v_mfma_f32_16x16x32_bf16 v[120:123], a[196:199], a[172:175], v[120:123]
    ds_read_b64_tr_b16 a[230:231], v237 offset:25600
    v_subrev_u32 v237, 98304, v237
    v_mfma_f32_16x16x32_bf16 v[88:91], a[196:199], a[168:171], v[88:91]
    ds_read_b64_tr_b16 a[232:233], v238 offset:8192
    v_lshl_add_u32 v244, v0, 3, 6
    v_mfma_f32_16x16x32_bf16 v[56:59], a[196:199], a[164:167], v[56:59]
    ds_read_b64_tr_b16 a[234:235], v238 offset:9216
    v_lshl_add_u32 v245, v0, 3, 7
    v_mfma_f32_16x16x32_bf16 v[24:27], a[196:199], a[160:163], v[24:27]
    buffer_load_dwordx4 v207, s[84:87], s89 offen offset:3072 lds
    v_mfma_f32_16x16x32_bf16 v[28:31], a[200:203], a[160:163], v[28:31]
    ds_read_b64_tr_b16 a[236:237], v238 offset:24576
    s_add_u32 s83, s83, 128
    v_mfma_f32_16x16x32_bf16 v[60:63], a[200:203], a[164:167], v[60:63]
    ds_read_b64_tr_b16 a[238:239], v238 offset:25600
    v_subrev_u32 v238, 98304, v238
    v_mfma_f32_16x16x32_bf16 v[92:95], a[200:203], a[168:171], v[92:95]
    s_add_u32 m0, s91, 147456
    v_cvt_f32_u32 v246, v244
    v_mfma_f32_16x16x32_bf16 v[124:127], a[200:203], a[172:175], v[124:127]
    v_cvt_f32_u32 v247, v245
    v_cvt_pk_bf16_f32 v246, v246, v247
    v_mfma_f32_16x16x32_bf16 v[128:131], a[204:207], a[172:175], v[128:131]
    v_lshrrev_b32 v247, 16, v246
    v_and_b32 v246, 0xffff, v246
    v_mfma_f32_16x16x32_bf16 v[96:99], a[204:207], a[168:171], v[96:99]
    v_subrev_u32 v246, 17024, v246
    v_subrev_u32 v247, 17024, v247
    v_mfma_f32_16x16x32_bf16 v[64:67], a[204:207], a[164:167], v[64:67]
    v_cndmask_b32 v244, v246, v244, vcc
    v_cndmask_b32 v245, v247, v245, vcc
    v_mfma_f32_16x16x32_bf16 v[32:35], a[204:207], a[160:163], v[32:35]
    v_sub_u32 v244, v244, v248
    s_waitcnt vmcnt(12) lgkmcnt(0)
    s_barrier
    v_mfma_f32_16x16x32_bf16 v[4:7], a[208:211], a[144:147], v[4:7]
    buffer_load_dwordx4 v208, s[36:39], s83 offen offset:0 lds
    v_mfma_f32_16x16x32_bf16 v[36:39], a[208:211], a[148:151], v[36:39]
    ds_read_b64_tr_b16 a[176:177], v235 offset:0
    v_sub_u32 v245, v245, v248
    v_mfma_f32_16x16x32_bf16 v[68:71], a[208:211], a[152:155], v[68:71]
    ds_read_b64_tr_b16 a[178:179], v235 offset:1024
    v_lshl_add_u32 v244, v245, 16, v244
    v_mfma_f32_16x16x32_bf16 v[100:103], a[208:211], a[156:159], v[100:103]
    ds_read_b128 a[160:163], v239 offset:0
    v_mul_lo_u32 v244, v244, s61
    v_mfma_f32_16x16x32_bf16 v[104:107], a[212:215], a[156:159], v[104:107]
    ds_read_b128 a[164:167], v239 offset:2048
    v_add_u32 v232, 0x01000100, v244
    v_mfma_f32_16x16x32_bf16 v[72:75], a[212:215], a[152:155], v[72:75]
    buffer_load_dwordx4 v209, s[36:39], s83 offen offset:1024 lds
    v_mfma_f32_16x16x32_bf16 v[40:43], a[212:215], a[148:151], v[40:43]
    ds_read_b128 a[168:171], v239 offset:4096
    v_add_u32 v174, 1536, v172
    v_mfma_f32_16x16x32_bf16 v[8:11], a[212:215], a[144:147], v[8:11]
    ds_read_b128 a[172:175], v239 offset:6144
    v_add_u32 v175, 1536, v173
    v_mfma_f32_16x16x32_bf16 v[12:15], a[216:219], a[144:147], v[12:15]
    ds_read_b64_tr_b16 a[180:181], v235 offset:16384
    v_mov_b32 v194, 0
    v_mfma_f32_16x16x32_bf16 v[44:47], a[216:219], a[148:151], v[44:47]
    ds_read_b64_tr_b16 a[182:183], v235 offset:17408
    v_mov_b32 v195, 0
    v_mfma_f32_16x16x32_bf16 v[76:79], a[216:219], a[152:155], v[76:79]
    buffer_load_dwordx4 v210, s[36:39], s83 offen offset:2048 lds
    v_mfma_f32_16x16x32_bf16 v[108:111], a[216:219], a[156:159], v[108:111]
    ds_read_b64_tr_b16 a[184:185], v236 offset:0
    v_lshlrev_b32 v233, 4, v0
    v_mfma_f32_16x16x32_bf16 v[112:115], a[220:223], a[156:159], v[112:115]
    ds_read_b64_tr_b16 a[186:187], v236 offset:1024
    v_add_u32 v233, 114816, v233
    v_mfma_f32_16x16x32_bf16 v[80:83], a[220:223], a[152:155], v[80:83]
    ds_read_b64_tr_b16 a[188:189], v236 offset:16384
    v_lshrrev_b32 v234, 2, v255
    v_mfma_f32_16x16x32_bf16 v[48:51], a[220:223], a[148:151], v[48:51]
    ds_read_b64_tr_b16 a[190:191], v236 offset:17408
    v_min_u32 v234, 9, v234
    v_mfma_f32_16x16x32_bf16 v[16:19], a[220:223], a[144:147], v[16:19]
    buffer_load_dwordx4 v211, s[36:39], s83 offen offset:3072 lds
    v_mfma_f32_16x16x32_bf16 v[20:23], a[224:227], a[144:147], v[20:23]
    ds_read_b64_tr_b16 a[192:193], v237 offset:0
    s_add_u32 s88, s88, 196608
    v_mfma_f32_16x16x32_bf16 v[52:55], a[224:227], a[148:151], v[52:55]
    ds_read_b64_tr_b16 a[194:195], v237 offset:1024
    s_add_u32 m0, s90, 114688
    v_mfma_f32_16x16x32_bf16 v[84:87], a[224:227], a[152:155], v[84:87]
    ds_read_b64_tr_b16 a[196:197], v237 offset:16384
    v_lshlrev_b32 v234, 7, v234
    v_mfma_f32_16x16x32_bf16 v[116:119], a[224:227], a[156:159], v[116:119]
    ds_read_b64_tr_b16 a[198:199], v237 offset:17408
    s_lshl_b32 s61, s92, 8
    v_mfma_f32_16x16x32_bf16 v[120:123], a[228:231], a[156:159], v[120:123]
    buffer_load_dwordx4 v204, s[84:87], s88 offen offset:0 lds
    v_mfma_f32_16x16x32_bf16 v[88:91], a[228:231], a[152:155], v[88:91]
L_padG2:
    s_cmp_lg_u32 s3, 0
    s_cbranch_scc1 L_padT1
    ds_read_b64_tr_b16 a[200:201], v238 offset:0
    v_cmp_eq_u32 s[52:53], s61, v255
    v_mfma_f32_16x16x32_bf16 v[56:59], a[228:231], a[148:151], v[56:59]
    ds_read_b64_tr_b16 a[202:203], v238 offset:1024
    s_nop 0
    v_mfma_f32_16x16x32_bf16 v[24:27], a[228:231], a[144:147], v[24:27]
    ds_read_b64_tr_b16 a[204:205], v238 offset:16384
    s_nop 0
    v_mfma_f32_16x16x32_bf16 v[28:31], a[232:235], a[144:147], v[28:31]
    ds_read_b64_tr_b16 a[206:207], v238 offset:17408
    v_cndmask_b32 v3, 0, v3, s[52:53]
    v_mfma_f32_16x16x32_bf16 v[60:63], a[232:235], a[148:151], v[60:63]
    buffer_load_dwordx4 v205, s[84:87], s88 offen offset:1024 lds
    v_mfma_f32_16x16x32_bf16 v[92:95], a[232:235], a[152:155], v[92:95]
    v_add_f32 v132, v132, v3
    v_add_u32 v244, 0, v255
    v_mfma_f32_16x16x32_bf16 v[124:127], a[232:235], a[156:159], v[124:127]
    v_mul_u32_u24 v245, 6554, v244
    v_lshrrev_b32 v245, 16, v245
    v_mfma_f32_16x16x32_bf16 v[128:131], a[236:239], a[156:159], v[128:131]
    v_mul_u32_u24 v245, 1120, v245
    v_add_u32 v249, v245, v252
    v_mfma_f32_16x16x32_bf16 v[96:99], a[236:239], a[152:155], v[96:99]
    v_add_u32 v244, 64, v255
    v_mul_u32_u24 v245, 6554, v244
    v_mfma_f32_16x16x32_bf16 v[64:67], a[236:239], a[148:151], v[64:67]
    buffer_load_dwordx4 v206, s[84:87], s88 offen offset:2048 lds
    v_mfma_f32_16x16x32_bf16 v[32:35], a[236:239], a[144:147], v[32:35]
    v_lshrrev_b32 v245, 16, v245
    s_waitcnt lgkmcnt(8)
    v_mfma_f32_16x16x32_bf16 v[4:7], a[176:179], a[160:163], v[4:7]
    ds_read_b64_tr_b16 a[208:209], v235 offset:8192
    v_add_u32 v239, 49152, v239
    v_mfma_f32_16x16x32_bf16 v[36:39], a[176:179], a[164:167], v[36:39]
    ds_read_b64_tr_b16 a[210:211], v235 offset:9216
    v_mul_u32_u24 v245, 1120, v245
    v_mfma_f32_16x16x32_bf16 v[68:71], a[176:179], a[168:171], v[68:71]
    ds_read_b128 a[144:147], v240 offset:0
    v_add_u32 v2, v245, v252
    v_mfma_f32_16x16x32_bf16 v[100:103], a[176:179], a[172:175], v[100:103]
    buffer_load_dwordx4 v207, s[84:87], s88 offen offset:3072 lds
    v_mfma_f32_16x16x32_bf16 v[104:107], a[180:183], a[172:175], v[104:107]
    ds_read_b128 a[148:151], v240 offset:2048
    s_add_u32 s89, s89, 196608
    v_mfma_f32_16x16x32_bf16 v[72:75], a[180:183], a[168:171], v[72:75]
    ds_read_b128 a[152:155], v240 offset:4096
    s_add_u32 m0, s90, 118784
    v_mfma_f32_16x16x32_bf16 v[40:43], a[180:183], a[164:167], v[40:43]
    ds_read_b128 a[156:159], v240 offset:6144
    v_add_u32 v240, 49152, v240
    v_mfma_f32_16x16x32_bf16 v[8:11], a[180:183], a[160:163], v[8:11]
    ds_read_b64_tr_b16 a[212:213], v235 offset:24576
    v_add_u32 v244, 128, v255
    v_mfma_f32_16x16x32_bf16 v[12:15], a[184:187], a[160:163], v[12:15]
    buffer_load_dwordx4 v204, s[84:87], s89 offen offset:0 lds
    v_mfma_f32_16x16x32_bf16 v[44:47], a[184:187], a[164:167], v[44:47]
    ds_read_b64_tr_b16 a[214:215], v235 offset:25600
    v_add_u32 v235, 49152, v235
    v_mfma_f32_16x16x32_bf16 v[76:79], a[184:187], a[168:171], v[76:79]
    ds_read_b64_tr_b16 a[216:217], v236 offset:8192
    v_mul_u32_u24 v245, 6554, v244
    v_mfma_f32_16x16x32_bf16 v[108:111], a[184:187], a[172:175], v[108:111]
    ds_read_b64_tr_b16 a[218:219], v236 offset:9216
    v_lshrrev_b32 v245, 16, v245
    v_mfma_f32_16x16x32_bf16 v[112:115], a[188:191], a[172:175], v[112:115]
    ds_read_b64_tr_b16 a[220:221], v236 offset:24576
    v_mul_u32_u24 v245, 1120, v245
    v_mfma_f32_16x16x32_bf16 v[80:83], a[188:191], a[168:171], v[80:83]
    buffer_load_dwordx4 v205, s[84:87], s89 offen offset:1024 lds
    v_mfma_f32_16x16x32_bf16 v[48:51], a[188:191], a[164:167], v[48:51]
    ds_read_b64_tr_b16 a[222:223], v236 offset:25600
    v_add_u32 v236, 49152, v236
    v_mfma_f32_16x16x32_bf16 v[16:19], a[188:191], a[160:163], v[16:19]
    v_add_u32 v3, v245, v252
    s_waitcnt lgkmcnt(12)
    v_mfma_f32_16x16x32_bf16 v[20:23], a[192:195], a[160:163], v[20:23]
    ds_read_b64_tr_b16 a[224:225], v237 offset:8192
    v_lshlrev_b32 v244, 25, v255
    v_mfma_f32_16x16x32_bf16 v[52:55], a[192:195], a[164:167], v[52:55]
    ds_read_b64_tr_b16 a[226:227], v237 offset:9216
    v_and_b32 v244, 1073741824, v244
    v_mfma_f32_16x16x32_bf16 v[84:87], a[192:195], a[168:171], v[84:87]
    buffer_load_dwordx4 v206, s[84:87], s89 offen offset:2048 lds
    v_mfma_f32_16x16x32_bf16 v[116:119], a[192:195], a[172:175], v[116:119]
    ds_read_b64_tr_b16 a[228:229], v237 offset:24576
    v_or_b32 v3, v3, v244
    v_mfma_f32_16x16x32_bf16 v[120:123], a[196:199], a[172:175], v[120:123]
    ds_read_b64_tr_b16 a[230:231], v237 offset:25600
    v_add_u32 v237, 49152, v237
    v_mfma_f32_16x16x32_bf16 v[88:91], a[196:199], a[168:171], v[88:91]
    ds_read_b64_tr_b16 a[232:233], v238 offset:8192
    s_lshl_b32 s79, s65, 2
    v_mfma_f32_16x16x32_bf16 v[56:59], a[196:199], a[164:167], v[56:59]
    ds_read_b64_tr_b16 a[234:235], v238 offset:9216
    s_add_u32 s79, s79, s78
    v_mfma_f32_16x16x32_bf16 v[24:27], a[196:199], a[160:163], v[24:27]
    buffer_load_dwordx4 v207, s[84:87], s89 offen offset:3072 lds
    v_mfma_f32_16x16x32_bf16 v[28:31], a[200:203], a[160:163], v[28:31]
    ds_read_b64_tr_b16 a[236:237], v238 offset:24576
    s_add_u32 s83, s83, 128
    v_mfma_f32_16x16x32_bf16 v[60:63], a[200:203], a[164:167], v[60:63]
    ds_read_b64_tr_b16 a[238:239], v238 offset:25600
    v_add_u32 v238, 49152, v238
    v_mfma_f32_16x16x32_bf16 v[92:95], a[200:203], a[168:171], v[92:95]
    s_add_u32 m0, s91, 49152
    s_mul_i32 s79, s79, 20480
    v_mfma_f32_16x16x32_bf16 v[124:127], a[200:203], a[172:175], v[124:127]
    s_mul_i32 s61, s66, 160
    s_add_u32 s79, s79, s61
    v_mfma_f32_16x16x32_bf16 v[128:131], a[204:207], a[172:175], v[128:131]
    s_xor_b32 s80, s2, 192
    s_or_b32 s80, s80, s54
    v_mfma_f32_16x16x32_bf16 v[96:99], a[204:207], a[168:171], v[96:99]
    v_mfma_f32_16x16x32_bf16 v[64:67], a[204:207], a[164:167], v[64:67]
    v_mfma_f32_16x16x32_bf16 v[32:35], a[204:207], a[160:163], v[32:35]
    s_waitcnt vmcnt(12) lgkmcnt(0)
    s_barrier
    v_mfma_f32_16x16x32_bf16 v[4:7], a[208:211], a[144:147], v[4:7]
    buffer_load_dwordx4 v208, s[36:39], s83 offen offset:0 lds
    v_mfma_f32_16x16x32_bf16 v[36:39], a[208:211], a[148:151], v[36:39]
    ds_read_b64_tr_b16 a[176:177], v235 offset:0
    v_mfma_f32_16x16x32_bf16 v[68:71], a[208:211], a[152:155], v[68:71]
    ds_read_b64_tr_b16 a[178:179], v235 offset:1024
    v_mfma_f32_16x16x32_bf16 v[100:103], a[208:211], a[156:159], v[100:103]
    ds_read_b128 a[160:163], v239 offset:0
    v_mfma_f32_16x16x32_bf16 v[104:107], a[212:215], a[156:159], v[104:107]
    ds_read_b128 a[164:167], v239 offset:2048
    buffer_load_dwordx2 v[192:193], v226, s[40:43], s8 offen sc1
    v_mfma_f32_16x16x32_bf16 v[72:75], a[212:215], a[152:155], v[72:75]
    v_mfma_f32_16x16x32_bf16 v[40:43], a[212:215], a[148:151], v[40:43]
    ds_read_b128 a[168:171], v239 offset:4096
    v_mfma_f32_16x16x32_bf16 v[8:11], a[212:215], a[144:147], v[8:11]
    ds_read_b128 a[172:175], v239 offset:6144
    buffer_load_dwordx4 v209, s[36:39], s83 offen offset:1024 lds
    v_mfma_f32_16x16x32_bf16 v[12:15], a[216:219], a[144:147], v[12:15]
    ds_read_b64_tr_b16 a[180:181], v235 offset:16384
    v_mfma_f32_16x16x32_bf16 v[44:47], a[216:219], a[148:151], v[44:47]
    ds_read_b64_tr_b16 a[182:183], v235 offset:17408
    v_mfma_f32_16x16x32_bf16 v[76:79], a[216:219], a[152:155], v[76:79]
    buffer_load_dwordx4 v210, s[36:39], s83 offen offset:2048 lds
    v_mfma_f32_16x16x32_bf16 v[108:111], a[216:219], a[156:159], v[108:111]
    ds_read_b64_tr_b16 a[184:185], v236 offset:0
    v_mfma_f32_16x16x32_bf16 v[112:115], a[220:223], a[156:159], v[112:115]
    ds_read_b64_tr_b16 a[186:187], v236 offset:1024
    v_mfma_f32_16x16x32_bf16 v[80:83], a[220:223], a[152:155], v[80:83]
    ds_read_b64_tr_b16 a[188:189], v236 offset:16384
    v_mfma_f32_16x16x32_bf16 v[48:51], a[220:223], a[148:151], v[48:51]
    ds_read_b64_tr_b16 a[190:191], v236 offset:17408
    v_mfma_f32_16x16x32_bf16 v[16:19], a[220:223], a[144:147], v[16:19]
    buffer_load_dwordx4 v211, s[36:39], s83 offen offset:3072 lds
    v_mfma_f32_16x16x32_bf16 v[20:23], a[224:227], a[144:147], v[20:23]
    ds_read_b64_tr_b16 a[192:193], v237 offset:0
    s_add_u32 s88, s88, 196608
    v_mfma_f32_16x16x32_bf16 v[52:55], a[224:227], a[148:151], v[52:55]
    ds_read_b64_tr_b16 a[194:195], v237 offset:1024
    s_add_u32 m0, s90, 16384
    v_mfma_f32_16x16x32_bf16 v[84:87], a[224:227], a[152:155], v[84:87]
    ds_read_b64_tr_b16 a[196:197], v237 offset:16384
    v_mfma_f32_16x16x32_bf16 v[116:119], a[224:227], a[156:159], v[116:119]
    ds_read_b64_tr_b16 a[198:199], v237 offset:17408
    v_mfma_f32_16x16x32_bf16 v[120:123], a[228:231], a[156:159], v[120:123]
    buffer_load_dwordx4 v204, s[84:87], s88 offen offset:0 lds
    v_mfma_f32_16x16x32_bf16 v[88:91], a[228:231], a[152:155], v[88:91]
    ds_read_b64_tr_b16 a[200:201], v238 offset:0
    v_mfma_f32_16x16x32_bf16 v[56:59], a[228:231], a[148:151], v[56:59]
    ds_read_b64_tr_b16 a[202:203], v238 offset:1024
    v_mfma_f32_16x16x32_bf16 v[24:27], a[228:231], a[144:147], v[24:27]
    ds_read_b64_tr_b16 a[204:205], v238 offset:16384
    v_mfma_f32_16x16x32_bf16 v[28:31], a[232:235], a[144:147], v[28:31]
    ds_read_b64_tr_b16 a[206:207], v238 offset:17408
    v_mfma_f32_16x16x32_bf16 v[60:63], a[232:235], a[148:151], v[60:63]
    buffer_load_dwordx4 v205, s[84:87], s88 offen offset:1024 lds
    v_mfma_f32_16x16x32_bf16 v[92:95], a[232:235], a[152:155], v[92:95]
    v_mfma_f32_16x16x32_bf16 v[124:127], a[232:235], a[156:159], v[124:127]
    v_mfma_f32_16x16x32_bf16 v[128:131], a[236:239], a[156:159], v[128:131]
    v_mfma_f32_16x16x32_bf16 v[96:99], a[236:239], a[152:155], v[96:99]
    v_mfma_f32_16x16x32_bf16 v[64:67], a[236:239], a[148:151], v[64:67]
    buffer_load_dwordx4 v206, s[84:87], s88 offen offset:2048 lds
    v_mfma_f32_16x16x32_bf16 v[32:35], a[236:239], a[144:147], v[32:35]
    s_waitcnt lgkmcnt(8)
    v_mfma_f32_16x16x32_bf16 v[4:7], a[176:179], a[160:163], v[4:7]
    ds_read_b64_tr_b16 a[208:209], v235 offset:8192
    v_add_u32 v239, 49152, v239
    v_mfma_f32_16x16x32_bf16 v[36:39], a[176:179], a[164:167], v[36:39]
    ds_read_b64_tr_b16 a[210:211], v235 offset:9216
    v_mfma_f32_16x16x32_bf16 v[68:71], a[176:179], a[168:171], v[68:71]
    ds_read_b128 a[144:147], v240 offset:0
    v_mfma_f32_16x16x32_bf16 v[100:103], a[176:179], a[172:175], v[100:103]
    buffer_load_dwordx4 v207, s[84:87], s88 offen offset:3072 lds
    v_mfma_f32_16x16x32_bf16 v[104:107], a[180:183], a[172:175], v[104:107]
    ds_read_b128 a[148:151], v240 offset:2048
    s_add_u32 s89, s89, 196608
    v_mfma_f32_16x16x32_bf16 v[72:75], a[180:183], a[168:171], v[72:75]
    ds_read_b128 a[152:155], v240 offset:4096
    s_add_u32 m0, s90, 20480
    v_mfma_f32_16x16x32_bf16 v[40:43], a[180:183], a[164:167], v[40:43]
    ds_read_b128 a[156:159], v240 offset:6144
    v_add_u32 v240, 49152, v240
    v_mfma_f32_16x16x32_bf16 v[8:11], a[180:183], a[160:163], v[8:11]
    ds_read_b64_tr_b16 a[212:213], v235 offset:24576
    v_mfma_f32_16x16x32_bf16 v[12:15], a[184:187], a[160:163], v[12:15]
    buffer_load_dwordx4 v204, s[84:87], s89 offen offset:0 lds
    v_mfma_f32_16x16x32_bf16 v[44:47], a[184:187], a[164:167], v[44:47]
    ds_read_b64_tr_b16 a[214:215], v235 offset:25600
    v_add_u32 v235, 49152, v235
    v_mfma_f32_16x16x32_bf16 v[76:79], a[184:187], a[168:171], v[76:79]
    ds_read_b64_tr_b16 a[216:217], v236 offset:8192
    v_mfma_f32_16x16x32_bf16 v[108:111], a[184:187], a[172:175], v[108:111]
    ds_read_b64_tr_b16 a[218:219], v236 offset:9216
    v_mfma_f32_16x16x32_bf16 v[112:115], a[188:191], a[172:175], v[112:115]
    ds_read_b64_tr_b16 a[220:221], v236 offset:24576
    v_mfma_f32_16x16x32_bf16 v[80:83], a[188:191], a[168:171], v[80:83]
    buffer_load_dwordx4 v205, s[84:87], s89 offen offset:1024 lds
    v_mfma_f32_16x16x32_bf16 v[48:51], a[188:191], a[164:167], v[48:51]
    ds_read_b64_tr_b16 a[222:223], v236 offset:25600
    v_add_u32 v236, 49152, v236
    v_mfma_f32_16x16x32_bf16 v[16:19], a[188:191], a[160:163], v[16:19]
    s_waitcnt lgkmcnt(12)
    v_mfma_f32_16x16x32_bf16 v[20:23], a[192:195], a[160:163], v[20:23]
    ds_read_b64_tr_b16 a[224:225], v237 offset:8192
    v_mfma_f32_16x16x32_bf16 v[52:55], a[192:195], a[164:167], v[52:55]
    ds_read_b64_tr_b16 a[226:227], v237 offset:9216
    v_mfma_f32_16x16x32_bf16 v[84:87], a[192:195], a[168:171], v[84:87]
    buffer_load_dwordx4 v206, s[84:87], s89 offen offset:2048 lds
    v_mfma_f32_16x16x32_bf16 v[116:119], a[192:195], a[172:175], v[116:119]
    ds_read_b64_tr_b16 a[228:229], v237 offset:24576
    v_mfma_f32_16x16x32_bf16 v[120:123], a[196:199], a[172:175], v[120:123]
    ds_read_b64_tr_b16 a[230:231], v237 offset:25600
    v_add_u32 v237, 49152, v237
    v_mfma_f32_16x16x32_bf16 v[88:91], a[196:199], a[168:171], v[88:91]
    ds_read_b64_tr_b16 a[232:233], v238 offset:8192
    v_mfma_f32_16x16x32_bf16 v[56:59], a[196:199], a[164:167], v[56:59]
    ds_read_b64_tr_b16 a[234:235], v238 offset:9216
    v_mfma_f32_16x16x32_bf16 v[24:27], a[196:199], a[160:163], v[24:27]
    buffer_load_dwordx4 v207, s[84:87], s89 offen offset:3072 lds
    v_mfma_f32_16x16x32_bf16 v[28:31], a[200:203], a[160:163], v[28:31]
    ds_read_b64_tr_b16 a[236:237], v238 offset:24576
    s_add_u32 s83, s83, 128
    v_mfma_f32_16x16x32_bf16 v[60:63], a[200:203], a[164:167], v[60:63]
    ds_read_b64_tr_b16 a[238:239], v238 offset:25600
    v_add_u32 v238, 49152, v238
    v_mfma_f32_16x16x32_bf16 v[92:95], a[200:203], a[168:171], v[92:95]
    s_add_u32 m0, s91, 98304
    v_mfma_f32_16x16x32_bf16 v[124:127], a[200:203], a[172:175], v[124:127]
    v_mfma_f32_16x16x32_bf16 v[128:131], a[204:207], a[172:175], v[128:131]
    v_mfma_f32_16x16x32_bf16 v[96:99], a[204:207], a[168:171], v[96:99]
    v_mfma_f32_16x16x32_bf16 v[64:67], a[204:207], a[164:167], v[64:67]
    v_mfma_f32_16x16x32_bf16 v[32:35], a[204:207], a[160:163], v[32:35]
    s_waitcnt vmcnt(11)
    v_cmp_ne_u64 s[50:51], s[48:49], v[192:193]
    s_nop 0
    s_cmp_lg_u64 s[50:51], 0
    s_cbranch_scc1 L_slow_f0
L_ok_f0:
    s_waitcnt lgkmcnt(0)
    s_barrier
    v_mfma_f32_16x16x32_bf16 v[4:7], a[208:211], a[144:147], v[4:7]
    buffer_load_dwordx4 v208, s[36:39], s83 offen offset:0 lds
    v_mfma_f32_16x16x32_bf16 v[36:39], a[208:211], a[148:151], v[36:39]
    ds_read_b64_tr_b16 a[176:177], v235 offset:0
    v_mfma_f32_16x16x32_bf16 v[68:71], a[208:211], a[152:155], v[68:71]
    ds_read_b64_tr_b16 a[178:179], v235 offset:1024
    v_mfma_f32_16x16x32_bf16 v[100:103], a[208:211], a[156:159], v[100:103]
    ds_read_b128 a[160:163], v239 offset:0
    buffer_load_dwordx4 v[160:163], v223, s[40:43], s7 offen offset:0 sc1
    v_mfma_f32_16x16x32_bf16 v[104:107], a[212:215], a[156:159], v[104:107]
    ds_read_b128 a[164:167], v239 offset:2048
    v_mfma_f32_16x16x32_bf16 v[72:75], a[212:215], a[152:155], v[72:75]
    v_mfma_f32_16x16x32_bf16 v[40:43], a[212:215], a[148:151], v[40:43]
    ds_read_b128 a[168:171], v239 offset:4096
    buffer_load_dwordx4 v209, s[36:39], s83 offen offset:1024 lds
    v_mfma_f32_16x16x32_bf16 v[8:11], a[212:215], a[144:147], v[8:11]
    ds_read_b128 a[172:175], v239 offset:6144
    v_mfma_f32_16x16x32_bf16 v[12:15], a[216:219], a[144:147], v[12:15]
    ds_read_b64_tr_b16 a[180:181], v235 offset:16384
    v_mfma_f32_16x16x32_bf16 v[44:47], a[216:219], a[148:151], v[44:47]
    ds_read_b64_tr_b16 a[182:183], v235 offset:17408
    buffer_load_dwordx4 v[164:167], v223, s[40:43], s7 offen offset:2048 sc1
    v_mfma_f32_16x16x32_bf16 v[76:79], a[216:219], a[152:155], v[76:79]
    v_mfma_f32_16x16x32_bf16 v[108:111], a[216:219], a[156:159], v[108:111]
    ds_read_b64_tr_b16 a[184:185], v236 offset:0
    v_mfma_f32_16x16x32_bf16 v[112:115], a[220:223], a[156:159], v[112:115]
    ds_read_b64_tr_b16 a[186:187], v236 offset:1024
    buffer_load_dwordx4 v210, s[36:39], s83 offen offset:2048 lds
    v_mfma_f32_16x16x32_bf16 v[80:83], a[220:223], a[152:155], v[80:83]
    ds_read_b64_tr_b16 a[188:189], v236 offset:16384
    v_mfma_f32_16x16x32_bf16 v[48:51], a[220:223], a[148:151], v[48:51]
    ds_read_b64_tr_b16 a[190:191], v236 offset:17408
    v_mfma_f32_16x16x32_bf16 v[16:19], a[220:223], a[144:147], v[16:19]
    buffer_load_dwordx4 v211, s[36:39], s83 offen offset:3072 lds
    v_mfma_f32_16x16x32_bf16 v[20:23], a[224:227], a[144:147], v[20:23]
    ds_read_b64_tr_b16 a[192:193], v237 offset:0
    s_add_u32 s88, s88, 196608
    v_mfma_f32_16x16x32_bf16 v[52:55], a[224:227], a[148:151], v[52:55]
    ds_read_b64_tr_b16 a[194:195], v237 offset:1024
    s_add_u32 m0, s90, 65536
    v_mfma_f32_16x16x32_bf16 v[84:87], a[224:227], a[152:155], v[84:87]
    ds_read_b64_tr_b16 a[196:197], v237 offset:16384
    buffer_load_dwordx2 v[176:177], v220, s[40:43], s5 offen offset:0 sc1
    v_mfma_f32_16x16x32_bf16 v[116:119], a[224:227], a[156:159], v[116:119]
    ds_read_b64_tr_b16 a[198:199], v237 offset:17408
    v_mfma_f32_16x16x32_bf16 v[120:123], a[228:231], a[156:159], v[120:123]
    v_mfma_f32_16x16x32_bf16 v[88:91], a[228:231], a[152:155], v[88:91]
    ds_read_b64_tr_b16 a[200:201], v238 offset:0
    buffer_load_dwordx4 v204, s[84:87], s88 offen offset:0 lds
    v_mfma_f32_16x16x32_bf16 v[56:59], a[228:231], a[148:151], v[56:59]
    ds_read_b64_tr_b16 a[202:203], v238 offset:1024
    v_mfma_f32_16x16x32_bf16 v[24:27], a[228:231], a[144:147], v[24:27]
    ds_read_b64_tr_b16 a[204:205], v238 offset:16384
    v_mfma_f32_16x16x32_bf16 v[28:31], a[232:235], a[144:147], v[28:31]
    ds_read_b64_tr_b16 a[206:207], v238 offset:17408
    buffer_load_dwordx2 v[178:179], v220, s[40:43], s5 offen offset:128 sc1
    v_mfma_f32_16x16x32_bf16 v[60:63], a[232:235], a[148:151], v[60:63]
    v_mfma_f32_16x16x32_bf16 v[92:95], a[232:235], a[152:155], v[92:95]
    v_mfma_f32_16x16x32_bf16 v[124:127], a[232:235], a[156:159], v[124:127]
    buffer_load_dwordx4 v205, s[84:87], s88 offen offset:1024 lds
    v_mfma_f32_16x16x32_bf16 v[128:131], a[236:239], a[156:159], v[128:131]
    v_mfma_f32_16x16x32_bf16 v[96:99], a[236:239], a[152:155], v[96:99]
    v_mfma_f32_16x16x32_bf16 v[64:67], a[236:239], a[148:151], v[64:67]
    buffer_load_dwordx4 v206, s[84:87], s88 offen offset:2048 lds
    v_mfma_f32_16x16x32_bf16 v[32:35], a[236:239], a[144:147], v[32:35]
    s_waitcnt lgkmcnt(8)
    v_mfma_f32_16x16x32_bf16 v[4:7], a[176:179], a[160:163], v[4:7]
    ds_read_b64_tr_b16 a[208:209], v235 offset:8192
    v_subrev_u32 v239, 98304, v239
    v_mfma_f32_16x16x32_bf16 v[36:39], a[176:179], a[164:167], v[36:39]
    ds_read_b64_tr_b16 a[210:211], v235 offset:9216
    buffer_load_dwordx2 v[180:181], v220, s[40:43], s5 offen offset:256 sc1
    v_mfma_f32_16x16x32_bf16 v[68:71], a[176:179], a[168:171], v[68:71]
    ds_read_b128 a[144:147], v240 offset:0
    v_mfma_f32_16x16x32_bf16 v[100:103], a[176:179], a[172:175], v[100:103]
    v_mfma_f32_16x16x32_bf16 v[104:107], a[180:183], a[172:175], v[104:107]
    ds_read_b128 a[148:151], v240 offset:2048
    buffer_load_dwordx4 v207, s[84:87], s88 offen offset:3072 lds
    v_mfma_f32_16x16x32_bf16 v[72:75], a[180:183], a[168:171], v[72:75]
    ds_read_b128 a[152:155], v240 offset:4096
    s_add_u32 s89, s89, 196608
    v_mfma_f32_16x16x32_bf16 v[40:43], a[180:183], a[164:167], v[40:43]
    ds_read_b128 a[156:159], v240 offset:6144
    v_subrev_u32 v240, 98304, v240
    v_mfma_f32_16x16x32_bf16 v[8:11], a[180:183], a[160:163], v[8:11]
    ds_read_b64_tr_b16 a[212:213], v235 offset:24576
    buffer_load_dwordx2 v[182:183], v220, s[40:43], s5 offen offset:384 sc1
    v_mfma_f32_16x16x32_bf16 v[12:15], a[184:187], a[160:163], v[12:15]
    s_add_u32 m0, s90, 69632
    v_mfma_f32_16x16x32_bf16 v[44:47], a[184:187], a[164:167], v[44:47]
    ds_read_b64_tr_b16 a[214:215], v235 offset:25600
    v_subrev_u32 v235, 98304, v235
    v_mfma_f32_16x16x32_bf16 v[76:79], a[184:187], a[168:171], v[76:79]
    ds_read_b64_tr_b16 a[216:217], v236 offset:8192
    buffer_load_dwordx4 v204, s[84:87], s89 offen offset:0 lds
    v_mfma_f32_16x16x32_bf16 v[108:111], a[184:187], a[172:175], v[108:111]
    ds_read_b64_tr_b16 a[218:219], v236 offset:9216
    v_mfma_f32_16x16x32_bf16 v[112:115], a[188:191], a[172:175], v[112:115]
    ds_read_b64_tr_b16 a[220:221], v236 offset:24576
    v_mfma_f32_16x16x32_bf16 v[80:83], a[188:191], a[168:171], v[80:83]
    buffer_load_dwordx4 v205, s[84:87], s89 offen offset:1024 lds
    v_mfma_f32_16x16x32_bf16 v[48:51], a[188:191], a[164:167], v[48:51]
    ds_read_b64_tr_b16 a[222:223], v236 offset:25600
    v_subrev_u32 v236, 98304, v236
    v_mfma_f32_16x16x32_bf16 v[16:19], a[188:191], a[160:163], v[16:19]
    s_waitcnt lgkmcnt(12)
    v_mfma_f32_16x16x32_bf16 v[20:23], a[192:195], a[160:163], v[20:23]
    ds_read_b64_tr_b16 a[224:225], v237 offset:8192
    buffer_load_dwordx4 a[0:3], v252, s[40:43], s67 offen offset:0 sc1
    v_mfma_f32_16x16x32_bf16 v[52:55], a[192:195], a[164:167], v[52:55]
    ds_read_b64_tr_b16 a[226:227], v237 offset:9216
    v_mfma_f32_16x16x32_bf16 v[84:87], a[192:195], a[168:171], v[84:87]
    v_mfma_f32_16x16x32_bf16 v[116:119], a[192:195], a[172:175], v[116:119]
    ds_read_b64_tr_b16 a[228:229], v237 offset:24576
    buffer_load_dwordx4 v206, s[84:87], s89 offen offset:2048 lds
    v_mfma_f32_16x16x32_bf16 v[120:123], a[196:199], a[172:175], v[120:123]
    ds_read_b64_tr_b16 a[230:231], v237 offset:25600
    v_subrev_u32 v237, 98304, v237
    v_mfma_f32_16x16x32_bf16 v[88:91], a[196:199], a[168:171], v[88:91]
    ds_read_b64_tr_b16 a[232:233], v238 offset:8192
    v_mfma_f32_16x16x32_bf16 v[56:59], a[196:199], a[164:167], v[56:59]
    ds_read_b64_tr_b16 a[234:235], v238 offset:9216
    buffer_load_dwordx4 a[4:7], v252, s[40:43], s67 offen offset:1024 sc1
    v_mfma_f32_16x16x32_bf16 v[24:27], a[196:199], a[160:163], v[24:27]
    v_mfma_f32_16x16x32_bf16 v[28:31], a[200:203], a[160:163], v[28:31]
    ds_read_b64_tr_b16 a[236:237], v238 offset:24576
    v_mfma_f32_16x16x32_bf16 v[60:63], a[200:203], a[164:167], v[60:63]
    ds_read_b64_tr_b16 a[238:239], v238 offset:25600
    buffer_load_dwordx4 v207, s[84:87], s89 offen offset:3072 lds
    v_mfma_f32_16x16x32_bf16 v[92:95], a[200:203], a[168:171], v[92:95]
    v_subrev_u32 v238, 98304, v238
    v_mfma_f32_16x16x32_bf16 v[124:127], a[200:203], a[172:175], v[124:127]
    v_mfma_f32_16x16x32_bf16 v[128:131], a[204:207], a[172:175], v[128:131]
    v_mfma_f32_16x16x32_bf16 v[96:99], a[204:207], a[168:171], v[96:99]
    v_mfma_f32_16x16x32_bf16 v[64:67], a[204:207], a[164:167], v[64:67]
    v_mfma_f32_16x16x32_bf16 v[32:35], a[204:207], a[160:163], v[32:35]
    s_waitcnt vmcnt(20) lgkmcnt(0)
    s_barrier
    v_mfma_f32_16x16x32_bf16 v[4:7], a[208:211], a[144:147], v[4:7]
    v_mfma_f32_16x16x32_bf16 v[36:39], a[208:211], a[148:151], v[36:39]
    ds_read_b64_tr_b16 a[176:177], v235 offset:0
    v_mfma_f32_16x16x32_bf16 v[68:71], a[208:211], a[152:155], v[68:71]
    ds_read_b64_tr_b16 a[178:179], v235 offset:1024
    v_mfma_f32_16x16x32_bf16 v[100:103], a[208:211], a[156:159], v[100:103]
    ds_read_b128 a[160:163], v239 offset:0
    v_mfma_f32_16x16x32_bf16 v[104:107], a[212:215], a[156:159], v[104:107]
    ds_read_b128 a[164:167], v239 offset:2048
    v_mfma_f32_16x16x32_bf16 v[72:75], a[212:215], a[152:155], v[72:75]
    v_mfma_f32_16x16x32_bf16 v[40:43], a[212:215], a[148:151], v[40:43]
    ds_read_b128 a[168:171], v239 offset:4096
    buffer_load_dwordx4 a[8:11], v252, s[40:43], s67 offen offset:2048 sc1
    v_mfma_f32_16x16x32_bf16 v[8:11], a[212:215], a[144:147], v[8:11]
    ds_read_b128 a[172:175], v239 offset:6144
    v_mfma_f32_16x16x32_bf16 v[12:15], a[216:219], a[144:147], v[12:15]
    ds_read_b64_tr_b16 a[180:181], v235 offset:16384
    v_mfma_f32_16x16x32_bf16 v[44:47], a[216:219], a[148:151], v[44:47]
    ds_read_b64_tr_b16 a[182:183], v235 offset:17408
    buffer_load_dwordx2 v[192:193], v234, s[40:43], s9 offen sc1
    v_mfma_f32_16x16x32_bf16 v[76:79], a[216:219], a[152:155], v[76:79]
    v_mfma_f32_16x16x32_bf16 v[108:111], a[216:219], a[156:159], v[108:111]
    ds_read_b64_tr_b16 a[184:185], v236 offset:0
    v_mfma_f32_16x16x32_bf16 v[112:115], a[220:223], a[156:159], v[112:115]
    ds_read_b64_tr_b16 a[186:187], v236 offset:1024
    buffer_load_dwordx4 a[12:15], v252, s[40:43], s67 offen offset:3072 sc1
    v_mfma_f32_16x16x32_bf16 v[80:83], a[220:223], a[152:155], v[80:83]
    ds_read_b64_tr_b16 a[188:189], v236 offset:16384
    s_add_u32 s67, s67, 4096
    v_mfma_f32_16x16x32_bf16 v[48:51], a[220:223], a[148:151], v[48:51]
    ds_read_b64_tr_b16 a[190:191], v236 offset:17408
    v_mfma_f32_16x16x32_bf16 v[16:19], a[220:223], a[144:147], v[16:19]
    v_mfma_f32_16x16x32_bf16 v[20:23], a[224:227], a[144:147], v[20:23]
    ds_read_b64_tr_b16 a[192:193], v237 offset:0
    buffer_load_dwordx4 a[16:19], v252, s[40:43], s67 offen offset:0 sc1
    v_mfma_f32_16x16x32_bf16 v[52:55], a[224:227], a[148:151], v[52:55]
    ds_read_b64_tr_b16 a[194:195], v237 offset:1024
    v_mfma_f32_16x16x32_bf16 v[84:87], a[224:227], a[152:155], v[84:87]
    ds_read_b64_tr_b16 a[196:197], v237 offset:16384
    v_mfma_f32_16x16x32_bf16 v[116:119], a[224:227], a[156:159], v[116:119]
    ds_read_b64_tr_b16 a[198:199], v237 offset:17408
    v_mfma_f32_16x16x32_bf16 v[120:123], a[228:231], a[156:159], v[120:123]
    v_mfma_f32_16x16x32_bf16 v[88:91], a[228:231], a[152:155], v[88:91]
    ds_read_b64_tr_b16 a[200:201], v238 offset:0
    buffer_load_dwordx4 a[20:23], v252, s[40:43], s67 offen offset:1024 sc1
    v_mfma_f32_16x16x32_bf16 v[56:59], a[228:231], a[148:151], v[56:59]
    ds_read_b64_tr_b16 a[202:203], v238 offset:1024
    v_mfma_f32_16x16x32_bf16 v[24:27], a[228:231], a[144:147], v[24:27]
    ds_read_b64_tr_b16 a[204:205], v238 offset:16384
    v_mfma_f32_16x16x32_bf16 v[28:31], a[232:235], a[144:147], v[28:31]
    ds_read_b64_tr_b16 a[206:207], v238 offset:17408
    v_mfma_f32_16x16x32_bf16 v[60:63], a[232:235], a[148:151], v[60:63]
    v_mfma_f32_16x16x32_bf16 v[92:95], a[232:235], a[152:155], v[92:95]
    buffer_load_dwordx4 a[24:27], v252, s[40:43], s67 offen offset:2048 sc1
    v_mfma_f32_16x16x32_bf16 v[124:127], a[232:235], a[156:159], v[124:127]
    v_mfma_f32_16x16x32_bf16 v[128:131], a[236:239], a[156:159], v[128:131]
    v_mfma_f32_16x16x32_bf16 v[96:99], a[236:239], a[152:155], v[96:99]
    v_mfma_f32_16x16x32_bf16 v[64:67], a[236:239], a[148:151], v[64:67]
    v_mfma_f32_16x16x32_bf16 v[32:35], a[236:239], a[144:147], v[32:35]
    buffer_load_dwordx4 a[28:31], v252, s[40:43], s67 offen offset:3072 sc1
    s_waitcnt lgkmcnt(8)
    v_mfma_f32_16x16x32_bf16 v[4:7], a[176:179], a[160:163], v[4:7]
    ds_read_b64_tr_b16 a[208:209], v235 offset:8192
    ds_write_b128 v227, v[132:135] offset:0
    v_mfma_f32_16x16x32_bf16 v[36:39], a[176:179], a[164:167], v[36:39]
    ds_read_b64_tr_b16 a[210:211], v235 offset:9216
    v_add_u32 v239, 49152, v239
    v_mfma_f32_16x16x32_bf16 v[68:71], a[176:179], a[168:171], v[68:71]
    ds_read_b128 v[204:207], v240 offset:0
    s_add_u32 s67, s67, 4096
    v_mfma_f32_16x16x32_bf16 v[100:103], a[176:179], a[172:175], v[100:103]
    ds_write_b128 v227, v[136:139] offset:1024
    v_mfma_f32_16x16x32_bf16 v[104:107], a[180:183], a[172:175], v[104:107]
    ds_read_b128 v[208:211], v240 offset:2048
    buffer_load_dwordx4 a[32:35], v252, s[40:43], s67 offen offset:0 sc1
    v_mfma_f32_16x16x32_bf16 v[72:75], a[180:183], a[168:171], v[72:75]
    ds_read_b128 v[216:219], v240 offset:4096
    v_mfma_f32_16x16x32_bf16 v[40:43], a[180:183], a[164:167], v[40:43]
    ds_read_b128 v[212:215], v240 offset:6144
    ds_write_b128 v227, v[140:143] offset:2048
    v_mfma_f32_16x16x32_bf16 v[8:11], a[180:183], a[160:163], v[8:11]
    ds_read_b64_tr_b16 a[212:213], v235 offset:24576
    v_add_u32 v240, 49152, v240
    v_mfma_f32_16x16x32_bf16 v[12:15], a[184:187], a[160:163], v[12:15]
    v_mfma_f32_16x16x32_bf16 v[44:47], a[184:187], a[164:167], v[44:47]
    ds_read_b64_tr_b16 a[214:215], v235 offset:25600
    buffer_load_dwordx4 a[36:39], v252, s[40:43], s67 offen offset:1024 sc1
    v_mfma_f32_16x16x32_bf16 v[76:79], a[184:187], a[168:171], v[76:79]
    ds_read_b64_tr_b16 a[216:217], v236 offset:8192
    v_add_u32 v235, 49152, v235
    v_mfma_f32_16x16x32_bf16 v[108:111], a[184:187], a[172:175], v[108:111]
    ds_read_b64_tr_b16 a[218:219], v236 offset:9216
    v_mfma_f32_16x16x32_bf16 v[112:115], a[188:191], a[172:175], v[112:115]
    ds_read_b64_tr_b16 a[220:221], v236 offset:24576
    v_mfma_f32_16x16x32_bf16 v[80:83], a[188:191], a[168:171], v[80:83]
    v_mfma_f32_16x16x32_bf16 v[48:51], a[188:191], a[164:167], v[48:51]
    ds_read_b64_tr_b16 a[222:223], v236 offset:25600
    buffer_load_dwordx4 a[40:43], v252, s[40:43], s67 offen offset:2048 sc1
    v_mfma_f32_16x16x32_bf16 v[16:19], a[188:191], a[160:163], v[16:19]
    v_add_u32 v236, 49152, v236
    s_waitcnt lgkmcnt(15)
    v_mfma_f32_16x16x32_bf16 v[20:23], a[192:195], a[160:163], v[20:23]
    ds_read_b64_tr_b16 a[224:225], v237 offset:8192
    v_mfma_f32_16x16x32_bf16 v[52:55], a[192:195], a[164:167], v[52:55]
    ds_read_b64_tr_b16 a[226:227], v237 offset:9216
    v_mfma_f32_16x16x32_bf16 v[84:87], a[192:195], a[168:171], v[84:87]
    v_mfma_f32_16x16x32_bf16 v[116:119], a[192:195], a[172:175], v[116:119]
    ds_read_b64_tr_b16 a[228:229], v237 offset:24576
    buffer_load_dwordx4 a[44:47], v252, s[40:43], s67 offen offset:3072 sc1
    v_mfma_f32_16x16x32_bf16 v[120:123], a[196:199], a[172:175], v[120:123]
    ds_read_b64_tr_b16 a[230:231], v237 offset:25600
    v_add_u32 v237, 49152, v237
    v_mfma_f32_16x16x32_bf16 v[88:91], a[196:199], a[168:171], v[88:91]
    ds_read_b64_tr_b16 a[232:233], v238 offset:8192
    s_add_u32 s67, s67, 4096
    v_mfma_f32_16x16x32_bf16 v[56:59], a[196:199], a[164:167], v[56:59]
    ds_read_b64_tr_b16 a[234:235], v238 offset:9216
    v_mfma_f32_16x16x32_bf16 v[24:27], a[196:199], a[160:163], v[24:27]
    v_mfma_f32_16x16x32_bf16 v[28:31], a[200:203], a[160:163], v[28:31]
    ds_read_b64_tr_b16 a[236:237], v238 offset:24576
    buffer_load_dwordx4 a[48:51], v252, s[40:43], s67 offen offset:0 sc1
    v_mfma_f32_16x16x32_bf16 v[60:63], a[200:203], a[164:167], v[60:63]
    ds_read_b64_tr_b16 a[238:239], v238 offset:25600
    v_add_u32 v238, 49152, v238
    v_mfma_f32_16x16x32_bf16 v[92:95], a[200:203], a[168:171], v[92:95]
    v_mfma_f32_16x16x32_bf16 v[124:127], a[200:203], a[172:175], v[124:127]
    v_mfma_f32_16x16x32_bf16 v[128:131], a[204:207], a[172:175], v[128:131]
    v_mfma_f32_16x16x32_bf16 v[96:99], a[204:207], a[168:171], v[96:99]
    buffer_load_dwordx4 a[52:55], v252, s[40:43], s67 offen offset:1024 sc1
    v_mfma_f32_16x16x32_bf16 v[64:67], a[204:207], a[164:167], v[64:67]
    v_mfma_f32_16x16x32_bf16 v[32:35], a[204:207], a[160:163], v[32:35]
    s_waitcnt vmcnt(13) lgkmcnt(0)
    s_barrier
    v_mfma_f32_16x16x32_bf16 v[4:7], a[208:211], v[204:207], v[4:7]
    v_mfma_f32_16x16x32_bf16 v[36:39], a[208:211], v[208:211], v[36:39]
    ds_read_b64_tr_b16 a[176:177], v235 offset:0
    v_mfma_f32_16x16x32_bf16 v[68:71], a[208:211], v[216:219], v[68:71]
L_padG3:
    s_cmp_lg_u32 s3, 0
    s_cbranch_scc1 L_padT0
    ds_read_b64_tr_b16 a[178:179], v235 offset:1024
    buffer_load_dwordx4 a[56:59], v252, s[40:43], s67 offen offset:2048 sc1
    v_mfma_f32_16x16x32_bf16 v[100:103], a[208:211], v[212:215], v[100:103]
    ds_read_b128 a[160:163], v239 offset:0
    v_mfma_f32_16x16x32_bf16 v[104:107], a[212:215], v[212:215], v[104:107]
    ds_read_b128 a[164:167], v239 offset:2048
    s_waitcnt vmcnt(12)
    v_cmp_ne_u64 s[50:51], s[48:49], v[192:193]
    s_nop 0
    s_cmp_lg_u64 s[50:51], 0
    s_cbranch_scc1 L_slow_fc
L_ok_fc:
    v_mfma_f32_16x16x32_bf16 v[72:75], a[212:215], v[216:219], v[72:75]
    buffer_load_dword v196, v221, s[40:43], s6 offen offset:0 sc1
    v_mfma_f32_16x16x32_bf16 v[40:43], a[212:215], v[208:211], v[40:43]
    ds_read_b128 a[168:171], v239 offset:4096
    v_mfma_f32_16x16x32_bf16 v[8:11], a[212:215], v[204:207], v[8:11]
    ds_read_b128 a[172:175], v239 offset:6144
    v_mfma_f32_16x16x32_bf16 v[12:15], a[216:219], v[204:207], v[12:15]
    ds_read_b64_tr_b16 a[180:181], v235 offset:16384
    buffer_load_dword v197, v221, s[40:43], s6 offen offset:128 sc1
    v_mfma_f32_16x16x32_bf16 v[44:47], a[216:219], v[208:211], v[44:47]
    ds_read_b64_tr_b16 a[182:183], v235 offset:17408
    v_mfma_f32_16x16x32_bf16 v[76:79], a[216:219], v[216:219], v[76:79]
    ds_read_b128 v[148:151], v228 offset:0
    v_mfma_f32_16x16x32_bf16 v[108:111], a[216:219], v[212:215], v[108:111]
    ds_read_b64_tr_b16 a[184:185], v236 offset:0
    buffer_load_dwordx4 a[60:63], v252, s[40:43], s67 offen offset:3072 sc1
    v_mfma_f32_16x16x32_bf16 v[112:115], a[220:223], v[212:215], v[112:115]
    ds_read_b64_tr_b16 a[186:187], v236 offset:1024
    ds_write_b64 v225, v[194:195]
    v_mfma_f32_16x16x32_bf16 v[80:83], a[220:223], v[216:219], v[80:83]
    ds_read_b64_tr_b16 a[188:189], v236 offset:16384
    s_add_u32 s6, s6, 6144
    v_mfma_f32_16x16x32_bf16 v[48:51], a[220:223], v[208:211], v[48:51]
    ds_read_b64_tr_b16 a[190:191], v236 offset:17408
    buffer_load_dword v198, v221, s[40:43], s6 offen offset:0 sc1
    v_mfma_f32_16x16x32_bf16 v[16:19], a[220:223], v[204:207], v[16:19]
    ds_write2_b64 v224, v[160:161], v[160:161] offset0:1 offset1:8
    v_mfma_f32_16x16x32_bf16 v[20:23], a[224:227], v[204:207], v[20:23]
    ds_read_b64_tr_b16 a[192:193], v237 offset:0
    s_add_u32 s67, s67, 4096
    v_mfma_f32_16x16x32_bf16 v[52:55], a[224:227], v[208:211], v[52:55]
    ds_read_b64_tr_b16 a[194:195], v237 offset:1024
    buffer_load_dword v199, v221, s[40:43], s6 offen offset:128 sc1
    v_mfma_f32_16x16x32_bf16 v[84:87], a[224:227], v[216:219], v[84:87]
    ds_read_b64_tr_b16 a[196:197], v237 offset:16384
    v_mfma_f32_16x16x32_bf16 v[116:119], a[224:227], v[212:215], v[116:119]
    ds_read_b64_tr_b16 a[198:199], v237 offset:17408
    v_mfma_f32_16x16x32_bf16 v[120:123], a[228:231], v[212:215], v[120:123]
    buffer_load_dwordx4 a[64:67], v252, s[40:43], s67 offen offset:0 sc1
    v_mfma_f32_16x16x32_bf16 v[88:91], a[228:231], v[216:219], v[88:91]
    ds_read_b64_tr_b16 a[200:201], v238 offset:0
    ds_write2_b64 v224, v[162:163], v[162:163] offset0:3 offset1:10
    v_mfma_f32_16x16x32_bf16 v[56:59], a[228:231], v[208:211], v[56:59]
    ds_read_b64_tr_b16 a[202:203], v238 offset:1024
    s_add_u32 s6, s6, 6144
    v_mfma_f32_16x16x32_bf16 v[24:27], a[228:231], v[204:207], v[24:27]
    ds_read_b64_tr_b16 a[204:205], v238 offset:16384
    buffer_load_dword v200, v221, s[40:43], s6 offen offset:0 sc1
    v_mfma_f32_16x16x32_bf16 v[28:31], a[232:235], v[204:207], v[28:31]
    ds_read_b64_tr_b16 a[206:207], v238 offset:17408
    v_and_b32 v194, 0xffff0000, v176
    v_mfma_f32_16x16x32_bf16 v[60:63], a[232:235], v[208:211], v[60:63]
    ds_read_b128 v[152:155], v228 offset:1024
    v_and_b32 v195, 0xffff0000, v178
    v_mfma_f32_16x16x32_bf16 v[92:95], a[232:235], v[216:219], v[92:95]
    buffer_load_dword v201, v221, s[40:43], s6 offen offset:128 sc1
    v_mfma_f32_16x16x32_bf16 v[124:127], a[232:235], v[212:215], v[124:127]
    ds_write2_b64 v224, v[164:165], v[164:165] offset0:129 offset1:136
    v_mfma_f32_16x16x32_bf16 v[128:131], a[236:239], v[212:215], v[128:131]
    ds_read_b128 v[156:159], v228 offset:2048
    v_and_b32 v192, 0xffff0000, v180
    v_mfma_f32_16x16x32_bf16 v[96:99], a[236:239], v[216:219], v[96:99]
    buffer_load_dwordx4 a[68:71], v252, s[40:43], s67 offen offset:1024 sc1
    v_mfma_f32_16x16x32_bf16 v[64:67], a[236:239], v[208:211], v[64:67]
    s_add_u32 s6, s6, 6144
    v_and_b32 v193, 0xffff0000, v182
    v_mfma_f32_16x16x32_bf16 v[32:35], a[236:239], v[204:207], v[32:35]
    v_rcp_f32 v244, v177
    s_waitcnt lgkmcnt(13)
    v_mfma_f32_16x16x32_bf16 v[4:7], a[176:179], a[160:163], v[4:7]
    ds_read_b64_tr_b16 a[208:209], v235 offset:8192
    buffer_load_dword v202, v221, s[40:43], s6 offen offset:0 sc1
    v_mfma_f32_16x16x32_bf16 v[36:39], a[176:179], a[164:167], v[36:39]
    ds_read_b64_tr_b16 a[210:211], v235 offset:9216
    ds_write2_b64 v224, v[166:167], v[166:167] offset0:131 offset1:138
    v_mfma_f32_16x16x32_bf16 v[68:71], a[176:179], a[168:171], v[68:71]
    ds_read_b128 v[204:207], v240 offset:0
    v_mul_f32 v176, v177, v177
    v_mfma_f32_16x16x32_bf16 v[100:103], a[176:179], a[172:175], v[100:103]
    buffer_load_dword v203, v221, s[40:43], s6 offen offset:128 sc1
    v_mfma_f32_16x16x32_bf16 v[104:107], a[180:183], a[172:175], v[104:107]
    ds_read_b128 v[208:211], v240 offset:2048
    v_add_f32 v132, v132, v148
    v_mfma_f32_16x16x32_bf16 v[72:75], a[180:183], a[168:171], v[72:75]
    ds_read_b128 v[216:219], v240 offset:4096
    v_add_f32 v133, v133, v149
    v_mfma_f32_16x16x32_bf16 v[40:43], a[180:183], a[164:167], v[40:43]
    ds_read_b128 v[212:215], v240 offset:6144
    buffer_load_dwordx4 a[72:75], v252, s[40:43], s67 offen offset:2048 sc1
    v_mfma_f32_16x16x32_bf16 v[8:11], a[180:183], a[160:163], v[8:11]
    ds_read_b64_tr_b16 a[212:213], v235 offset:24576
    s_add_u32 s6, s6, 6144
    v_mfma_f32_16x16x32_bf16 v[12:15], a[184:187], a[160:163], v[12:15]
    v_add_f32 v134, v134, v150
    v_add_f32 v135, v135, v151
    v_mfma_f32_16x16x32_bf16 v[44:47], a[184:187], a[164:167], v[44:47]
    ds_read_b64_tr_b16 a[214:215], v235 offset:25600
    buffer_load_dword v250, v221, s[40:43], s6 offen offset:0 sc1
    v_mfma_f32_16x16x32_bf16 v[76:79], a[184:187], a[168:171], v[76:79]
    ds_read_b64_tr_b16 a[216:217], v236 offset:8192
    s_waitcnt lgkmcnt(12)
    v_add_f32 v136, v136, v152
    v_mfma_f32_16x16x32_bf16 v[108:111], a[184:187], a[172:175], v[108:111]
    ds_read_b64_tr_b16 a[218:219], v236 offset:9216
    v_add_f32 v137, v137, v153
    v_mfma_f32_16x16x32_bf16 v[112:115], a[188:191], a[172:175], v[112:115]
    ds_read_b64_tr_b16 a[220:221], v236 offset:24576
    buffer_load_dword v251, v221, s[40:43], s6 offen offset:128 sc1
    v_mfma_f32_16x16x32_bf16 v[80:83], a[188:191], a[168:171], v[80:83]
    v_add_f32 v138, v138, v154
    v_add_f32 v139, v139, v155
    v_mfma_f32_16x16x32_bf16 v[48:51], a[188:191], a[164:167], v[48:51]
    ds_read_b64_tr_b16 a[222:223], v236 offset:25600
    s_waitcnt lgkmcnt(13)
    v_add_f32 v140, v140, v156
    v_mfma_f32_16x16x32_bf16 v[16:19], a[188:191], a[160:163], v[16:19]
    buffer_load_dwordx4 a[76:79], v252, s[40:43], s67 offen offset:3072 sc1
    v_mfma_f32_16x16x32_bf16 v[20:23], a[192:195], a[160:163], v[20:23]
    ds_read_b64_tr_b16 a[224:225], v237 offset:8192
    v_add_f32 v141, v141, v157
    v_mfma_f32_16x16x32_bf16 v[52:55], a[192:195], a[164:167], v[52:55]
    ds_read_b64_tr_b16 a[226:227], v237 offset:9216
    v_add_f32 v142, v142, v158
    v_mfma_f32_16x16x32_bf16 v[84:87], a[192:195], a[168:171], v[84:87]
    v_add_f32 v143, v143, v159
    v_cvt_pk_bf16_f32 v148, v132, v133
    v_mfma_f32_16x16x32_bf16 v[116:119], a[192:195], a[172:175], v[116:119]
    ds_read_b64_tr_b16 a[228:229], v237 offset:24576
    v_cvt_pk_bf16_f32 v149, v134, v135
    v_mfma_f32_16x16x32_bf16 v[120:123], a[196:199], a[172:175], v[120:123]
    ds_read_b64_tr_b16 a[230:231], v237 offset:25600
    v_cvt_pk_bf16_f32 v150, v136, v137
    v_mfma_f32_16x16x32_bf16 v[88:91], a[196:199], a[168:171], v[88:91]
    ds_read_b64_tr_b16 a[232:233], v238 offset:8192
    v_cvt_pk_bf16_f32 v151, v138, v139
    v_mfma_f32_16x16x32_bf16 v[56:59], a[196:199], a[164:167], v[56:59]
    ds_read_b64_tr_b16 a[234:235], v238 offset:9216
    v_cvt_pk_bf16_f32 v152, v140, v141
    v_mfma_f32_16x16x32_bf16 v[24:27], a[196:199], a[160:163], v[24:27]
    v_cvt_pk_bf16_f32 v153, v142, v143
    s_add_u32 s67, s67, 4096
    v_mfma_f32_16x16x32_bf16 v[28:31], a[200:203], a[160:163], v[28:31]
    ds_read_b64_tr_b16 a[236:237], v238 offset:24576
    buffer_load_dwordx4 a[80:83], v252, s[40:43], s67 offen offset:0 sc1
    v_mfma_f32_16x16x32_bf16 v[60:63], a[200:203], a[164:167], v[60:63]
    ds_read_b64_tr_b16 a[238:239], v238 offset:25600
    ds_write_b64 v168, v[148:149]
    v_mfma_f32_16x16x32_bf16 v[92:95], a[200:203], a[168:171], v[92:95]
    ds_write_b32 v169, v150
    v_mfma_f32_16x16x32_bf16 v[124:127], a[200:203], a[172:175], v[124:127]
    ds_write_b32 v170, v151
    v_mfma_f32_16x16x32_bf16 v[128:131], a[204:207], a[172:175], v[128:131]
    ds_write_b16 v171, v152 offset:1024
    v_mfma_f32_16x16x32_bf16 v[96:99], a[204:207], a[168:171], v[96:99]
    ds_write_b16_d16_hi v171, v152 offset:1088
    v_mfma_f32_16x16x32_bf16 v[64:67], a[204:207], a[164:167], v[64:67]
    ds_write_b16 v171, v153 offset:1152
    v_mfma_f32_16x16x32_bf16 v[32:35], a[204:207], a[160:163], v[32:35]
    ds_write_b16_d16_hi v171, v153 offset:1216
    s_waitcnt lgkmcnt(15)
    v_mfma_f32_16x16x32_bf16 v[4:7], a[208:211], v[204:207], v[4:7]
    buffer_load_dwordx4 a[84:87], v252, s[40:43], s67 offen offset:1024 sc1
    v_mfma_f32_16x16x32_bf16 v[36:39], a[208:211], v[208:211], v[36:39]
    v_mul_f32 v185, 0xc0135761, v244
    v_mul_f32 v245, v244, v244
    v_mfma_f32_16x16x32_bf16 v[68:71], a[208:211], v[216:219], v[68:71]
    v_mul_f32 v245, 0x3d372713, v245
    v_mul_f32 v184, v245, v185
    v_mfma_f32_16x16x32_bf16 v[100:103], a[208:211], v[212:215], v[100:103]
    buffer_load_dwordx4 a[88:91], v252, s[40:43], s67 offen offset:2048 sc1
    v_mfma_f32_16x16x32_bf16 v[104:107], a[212:215], v[212:215], v[104:107]
    v_rcp_f32 v244, v179
    v_mfma_f32_16x16x32_bf16 v[72:75], a[212:215], v[216:219], v[72:75]
    v_mul_f32 v178, v179, v179
    v_mul_f32 v187, 0xc0135761, v244
    v_mfma_f32_16x16x32_bf16 v[40:43], a[212:215], v[208:211], v[40:43]
    buffer_load_dwordx4 a[92:95], v252, s[40:43], s67 offen offset:3072 sc1
    v_mfma_f32_16x16x32_bf16 v[8:11], a[212:215], v[204:207], v[8:11]
    s_add_u32 s67, s67, 4096
    v_mul_f32 v245, v244, v244
    v_mfma_f32_16x16x32_bf16 v[12:15], a[216:219], v[204:207], v[12:15]
    v_mul_f32 v245, 0x3d372713, v245
    v_mul_f32 v186, v245, v187
    v_mfma_f32_16x16x32_bf16 v[44:47], a[216:219], v[208:211], v[44:47]
    buffer_load_dwordx4 a[96:99], v252, s[40:43], s67 offen offset:0 sc1
    v_mfma_f32_16x16x32_bf16 v[76:79], a[216:219], v[216:219], v[76:79]
    v_rcp_f32 v244, v181
    v_mfma_f32_16x16x32_bf16 v[108:111], a[216:219], v[212:215], v[108:111]
    v_mul_f32 v180, v181, v181
    v_mul_f32 v189, 0xc0135761, v244
    v_mfma_f32_16x16x32_bf16 v[112:115], a[220:223], v[212:215], v[112:115]
    s_waitcnt lgkmcnt(0)
    s_barrier
    v_mfma_f32_16x16x32_bf16 v[80:83], a[220:223], v[216:219], v[80:83]
    buffer_load_dwordx4 a[100:103], v252, s[40:43], s67 offen offset:1024 sc1
    v_mfma_f32_16x16x32_bf16 v[48:51], a[220:223], v[208:211], v[48:51]
    ds_read2_b32 v[160:161], v172 offset0:0 offset1:1
    v_mul_f32 v245, v244, v244
    v_mfma_f32_16x16x32_bf16 v[16:19], a[220:223], v[204:207], v[16:19]
    ds_read2_b32 v[162:163], v173 offset0:0 offset1:1
    v_mul_f32 v245, 0x3d372713, v245
    v_mfma_f32_16x16x32_bf16 v[20:23], a[224:227], v[204:207], v[20:23]
    buffer_load_dwordx4 a[104:107], v252, s[40:43], s67 offen offset:2048 sc1
    v_mfma_f32_16x16x32_bf16 v[52:55], a[224:227], v[208:211], v[52:55]
    ds_read2_b32 v[164:165], v174 offset0:0 offset1:1
    v_mul_f32 v188, v245, v189
    v_mfma_f32_16x16x32_bf16 v[84:87], a[224:227], v[216:219], v[84:87]
    v_rcp_f32 v244, v183
    v_mfma_f32_16x16x32_bf16 v[116:119], a[224:227], v[212:215], v[116:119]
    buffer_load_dwordx4 a[108:111], v252, s[40:43], s67 offen offset:3072 sc1
    v_mfma_f32_16x16x32_bf16 v[120:123], a[228:231], v[212:215], v[120:123]
    ds_read2_b32 v[166:167], v175 offset0:0 offset1:1
    s_waitcnt vmcnt(19)
    v_add_f32 v196, v196, v198
    v_mfma_f32_16x16x32_bf16 v[88:91], a[228:231], v[216:219], v[88:91]
    s_waitcnt vmcnt(18)
    v_add_f32 v197, v197, v199
    s_waitcnt vmcnt(16)
    v_add_f32 v196, v196, v200
    v_mfma_f32_16x16x32_bf16 v[56:59], a[228:231], v[208:211], v[56:59]
    s_waitcnt vmcnt(15)
    v_add_f32 v197, v197, v201
    s_waitcnt vmcnt(13)
    v_add_f32 v196, v196, v202
    v_mfma_f32_16x16x32_bf16 v[24:27], a[228:231], v[204:207], v[24:27]
    s_waitcnt vmcnt(12)
    v_add_f32 v197, v197, v203
    s_waitcnt vmcnt(10)
    v_add_f32 v196, v196, v250
    v_mfma_f32_16x16x32_bf16 v[28:31], a[232:235], v[204:207], v[28:31]
    s_waitcnt vmcnt(9)
    v_add_f32 v197, v197, v251
    s_add_u32 s67, s67, 4096
    v_mfma_f32_16x16x32_bf16 v[60:63], a[232:235], v[208:211], v[60:63]
    buffer_load_dwordx4 a[112:115], v252, s[40:43], s67 offen offset:0 sc1
    v_mfma_f32_16x16x32_bf16 v[92:95], a[232:235], v[216:219], v[92:95]
    v_mul_f32 v182, v183, v183
    v_mul_f32 v191, 0xc0135761, v244
    v_mfma_f32_16x16x32_bf16 v[124:127], a[232:235], v[212:215], v[124:127]
    v_mul_f32 v245, v244, v244
    v_mul_f32 v245, 0x3d372713, v245
    v_mfma_f32_16x16x32_bf16 v[128:131], a[236:239], v[212:215], v[128:131]
    buffer_load_dwordx4 a[116:119], v252, s[40:43], s67 offen offset:1024 sc1
    v_mfma_f32_16x16x32_bf16 v[96:99], a[236:239], v[216:219], v[96:99]
    s_waitcnt lgkmcnt(3)
    v_perm_b32 v168, v161, v160, v229
    v_perm_b32 v169, v161, v160, v230
    v_mfma_f32_16x16x32_bf16 v[64:67], a[236:239], v[208:211], v[64:67]
    s_waitcnt lgkmcnt(2)
    v_perm_b32 v170, v163, v162, v231
    v_perm_b32 v171, v163, v162, v232
    v_mfma_f32_16x16x32_bf16 v[32:35], a[236:239], v[204:207], v[32:35]
    ds_write_b128 v233, v[168:171] offset:0
    v_mfma_f32_16x16x1_4b_f32 v[4:19], v196, v194, v[4:19]
    buffer_load_dwordx4 a[120:123], v252, s[40:43], s67 offen offset:2048 sc1
    s_waitcnt lgkmcnt(2)
    v_perm_b32 v172, v165, v164, v229
    v_perm_b32 v173, v165, v164, v230
    s_waitcnt lgkmcnt(1)
    v_perm_b32 v174, v167, v166, v231
    v_mfma_f32_16x16x1_4b_f32 v[36:51], v196, v195, v[36:51]
    v_perm_b32 v175, v167, v166, v232
    v_mul_f32 v190, v245, v191
    v_lshrrev_b32 v238, 3, v255
    ds_write_b128 v233, v[172:175] offset:4224
    v_mfma_f32_16x16x1_4b_f32 v[68:83], v196, v192, v[68:83]
    buffer_load_dwordx4 a[124:127], v252, s[40:43], s67 offen offset:3072 sc1
    s_add_u32 s67, s67, 4096
    v_min_u32 v238, 5, v238
    v_lshlrev_b32 v238, 7, v238
    v_mfma_f32_16x16x1_4b_f32 v[100:115], v196, v193, v[100:115]
    v_lshlrev_b32 v235, 5, v0
    v_cmp_gt_u32 vcc, 8, v0
    v_add_u32 v236, 16128, v235
    buffer_load_dwordx4 a[128:131], v252, s[40:43], s67 offen offset:0 sc1
    v_mfma_f32_16x16x1_4b_f32 v[20:35], v197, v194, v[20:35]
    v_mov_b32 v246, 262144
    v_cndmask_b32 v236, v236, v246, vcc
    v_lshrrev_b32 v247, 3, v0
    v_and_b32 v246, 7, v0
    v_mul_u32_u24 v247, 81920, v247
    v_lshl_add_u32 v237, v246, 4, v247
    v_mfma_f32_16x16x1_4b_f32 v[52:67], v197, v195, v[52:67]
    buffer_load_dwordx4 a[132:135], v252, s[40:43], s67 offen offset:1024 sc1
    s_mul_i32 s61, s75, 49152
    s_add_u32 s61, s61, s72
    v_add_u32 v239, s61, v252
    v_mfma_f32_16x16x1_4b_f32 v[84:99], v197, v192, v[84:99]
    buffer_load_dwordx4 a[136:139], v252, s[40:43], s67 offen offset:2048 sc1
    v_mfma_f32_16x16x1_4b_f32 v[116:131], v197, v193, v[116:131]
    s_waitcnt lgkmcnt(0)
    s_barrier
    s_bitcmp1_b32 s57, 30
    s_cbranch_scc1 L_nf1
    s_nop 0
    s_atomic_swap_x2 s[48:49], s[40:41], s57
L_nf1:
    v_pk_mul_f32 v[132:133], v[4:5], v[4:5]
    v_pk_mul_f32 v[134:135], v[6:7], v[6:7]
    v_pk_mul_f32 v[136:137], v[12:13], v[12:13]
    v_pk_mul_f32 v[138:139], v[14:15], v[14:15]
    v_pk_mul_f32 v[140:141], v[20:21], v[20:21]
    v_pk_mul_f32 v[142:143], v[22:23], v[22:23]
    v_pk_mul_f32 v[144:145], v[28:29], v[28:29]
    v_pk_mul_f32 v[146:147], v[30:31], v[30:31]
    v_pk_fma_f32 v[132:133], v[132:133], v[184:185], v[184:185] op_sel:[0,0,1] op_sel_hi:[1,0,1]
    v_pk_fma_f32 v[134:135], v[134:135], v[184:185], v[184:185] op_sel:[0,0,1] op_sel_hi:[1,0,1]
    v_pk_fma_f32 v[136:137], v[136:137], v[184:185], v[184:185] op_sel:[0,0,1] op_sel_hi:[1,0,1]
    v_pk_fma_f32 v[138:139], v[138:139], v[184:185], v[184:185] op_sel:[0,0,1] op_sel_hi:[1,0,1]
    buffer_load_dwordx4 a[140:143], v252, s[40:43], s67 offen offset:3072 sc1
    v_pk_fma_f32 v[140:141], v[140:141], v[184:185], v[184:185] op_sel:[0,0,1] op_sel_hi:[1,0,1]
    v_pk_fma_f32 v[142:143], v[142:143], v[184:185], v[184:185] op_sel:[0,0,1] op_sel_hi:[1,0,1]
    v_pk_fma_f32 v[144:145], v[144:145], v[184:185], v[184:185] op_sel:[0,0,1] op_sel_hi:[1,0,1]
    v_pk_fma_f32 v[146:147], v[146:147], v[184:185], v[184:185] op_sel:[0,0,1] op_sel_hi:[1,0,1]
    v_pk_mul_f32 v[132:133], v[132:133], v[4:5]
    v_pk_mul_f32 v[134:135], v[134:135], v[6:7]
    v_pk_mul_f32 v[136:137], v[136:137], v[12:13]
    v_pk_mul_f32 v[138:139], v[138:139], v[14:15]
    v_pk_mul_f32 v[140:141], v[140:141], v[20:21]
    v_pk_mul_f32 v[142:143], v[142:143], v[22:23]
    v_pk_mul_f32 v[144:145], v[144:145], v[28:29]
    s_add_u32 s67, s67, 4096
    v_pk_mul_f32 v[146:147], v[146:147], v[30:31]
    buffer_load_dwordx4 a[144:147], v252, s[40:43], s67 offen offset:0 sc1
    v_exp_f32 v132, v132
    v_exp_f32 v133, v133
    v_exp_f32 v134, v134
    v_exp_f32 v135, v135
    v_exp_f32 v136, v136
    v_exp_f32 v137, v137
    v_exp_f32 v138, v138
    v_exp_f32 v139, v139
    v_exp_f32 v140, v140
    v_exp_f32 v141, v141
    v_exp_f32 v142, v142
    v_exp_f32 v143, v143
    buffer_load_dwordx4 a[148:151], v252, s[40:43], s67 offen offset:1024 sc1
    v_exp_f32 v144, v144
    v_exp_f32 v145, v145
    v_exp_f32 v146, v146
    v_exp_f32 v147, v147
    v_pk_mul_f32 v[8:9], v[4:5], v[8:9]
    v_pk_mul_f32 v[10:11], v[6:7], v[10:11]
    v_pk_mul_f32 v[16:17], v[12:13], v[16:17]
    v_pk_mul_f32 v[18:19], v[14:15], v[18:19]
    v_pk_mul_f32 v[24:25], v[20:21], v[24:25]
    v_pk_mul_f32 v[26:27], v[22:23], v[26:27]
    v_pk_mul_f32 v[32:33], v[28:29], v[32:33]
    v_pk_mul_f32 v[34:35], v[30:31], v[34:35]
    buffer_load_dwordx4 a[152:155], v252, s[40:43], s67 offen offset:2048 sc1
    v_pk_fma_f32 v[132:133], v[132:133], v[176:177], v[176:177] op_sel_hi:[1,0,0]
    v_pk_fma_f32 v[134:135], v[134:135], v[176:177], v[176:177] op_sel_hi:[1,0,0]
    v_pk_fma_f32 v[136:137], v[136:137], v[176:177], v[176:177] op_sel_hi:[1,0,0]
    v_pk_fma_f32 v[138:139], v[138:139], v[176:177], v[176:177] op_sel_hi:[1,0,0]
    v_pk_fma_f32 v[140:141], v[140:141], v[176:177], v[176:177] op_sel_hi:[1,0,0]
    v_pk_fma_f32 v[142:143], v[142:143], v[176:177], v[176:177] op_sel_hi:[1,0,0]
    v_pk_fma_f32 v[144:145], v[144:145], v[176:177], v[176:177] op_sel_hi:[1,0,0]
    v_pk_fma_f32 v[146:147], v[146:147], v[176:177], v[176:177] op_sel_hi:[1,0,0]
    v_rcp_f32 v132, v132
    v_rcp_f32 v133, v133
    v_rcp_f32 v134, v134
    v_rcp_f32 v135, v135
    buffer_load_dwordx4 a[156:159], v252, s[40:43], s67 offen offset:3072 sc1
    v_rcp_f32 v136, v136
    v_rcp_f32 v137, v137
    v_rcp_f32 v138, v138
    v_rcp_f32 v139, v139
    v_pk_mul_f32 v[8:9], v[8:9], v[132:133]
    v_pk_mul_f32 v[10:11], v[10:11], v[134:135]
    v_pk_mul_f32 v[16:17], v[16:17], v[136:137]
    v_pk_mul_f32 v[18:19], v[18:19], v[138:139]
    v_cvt_pk_bf16_f32 v148, v8, v9
    v_cvt_pk_bf16_f32 v149, v10, v11
    v_cvt_pk_bf16_f32 v150, v16, v17
    v_cvt_pk_bf16_f32 v151, v18, v19
    v_rcp_f32 v140, v140
    v_rcp_f32 v141, v141
    v_rcp_f32 v142, v142
    v_rcp_f32 v143, v143
    v_rcp_f32 v144, v144
    v_rcp_f32 v145, v145
    v_rcp_f32 v146, v146
    v_rcp_f32 v147, v147
    v_pk_mul_f32 v[24:25], v[24:25], v[140:141]
    v_pk_mul_f32 v[26:27], v[26:27], v[142:143]
    v_pk_mul_f32 v[32:33], v[32:33], v[144:145]
    s_add_u32 s67, s67, 4096
    v_pk_mul_f32 v[34:35], v[34:35], v[146:147]
    buffer_load_dwordx4 a[160:163], v252, s[40:43], s67 offen offset:0 sc1
    v_cvt_pk_bf16_f32 v152, v24, v25
    v_cvt_pk_bf16_f32 v153, v26, v27
    v_cvt_pk_bf16_f32 v154, v32, v33
    v_cvt_pk_bf16_f32 v155, v34, v35
    v_pk_mul_f32 v[132:133], v[36:37], v[36:37]
    v_pk_mul_f32 v[134:135], v[38:39], v[38:39]
    v_pk_mul_f32 v[136:137], v[44:45], v[44:45]
    v_pk_mul_f32 v[138:139], v[46:47], v[46:47]
    v_pk_mul_f32 v[140:141], v[52:53], v[52:53]
    v_pk_mul_f32 v[142:143], v[54:55], v[54:55]
    v_pk_mul_f32 v[144:145], v[60:61], v[60:61]
    v_pk_mul_f32 v[146:147], v[62:63], v[62:63]
    v_pk_fma_f32 v[132:133], v[132:133], v[186:187], v[186:187] op_sel:[0,0,1] op_sel_hi:[1,0,1]
    ds_read_b64_tr_b16 v[20:21], v242 offset:544
    ds_read_b64_tr_b16 v[22:23], v242 offset:512
    ds_read_b128 v[24:27], v241 offset:1024
    v_pk_fma_f32 v[134:135], v[134:135], v[186:187], v[186:187] op_sel:[0,0,1] op_sel_hi:[1,0,1]
    v_pk_fma_f32 v[136:137], v[136:137], v[186:187], v[186:187] op_sel:[0,0,1] op_sel_hi:[1,0,1]
    v_pk_fma_f32 v[138:139], v[138:139], v[186:187], v[186:187] op_sel:[0,0,1] op_sel_hi:[1,0,1]
    buffer_store_dwordx4 v[148:151], v252, s[40:43], s4 offen offset:0 sc1
    v_pk_fma_f32 v[140:141], v[140:141], v[186:187], v[186:187] op_sel:[0,0,1] op_sel_hi:[1,0,1]
    v_pk_fma_f32 v[142:143], v[142:143], v[186:187], v[186:187] op_sel:[0,0,1] op_sel_hi:[1,0,1]
    v_pk_fma_f32 v[144:145], v[144:145], v[186:187], v[186:187] op_sel:[0,0,1] op_sel_hi:[1,0,1]
    v_pk_fma_f32 v[146:147], v[146:147], v[186:187], v[186:187] op_sel:[0,0,1] op_sel_hi:[1,0,1]
    v_pk_mul_f32 v[132:133], v[132:133], v[36:37]
    v_pk_mul_f32 v[134:135], v[134:135], v[38:39]
    v_pk_mul_f32 v[136:137], v[136:137], v[44:45]
    v_pk_mul_f32 v[138:139], v[138:139], v[46:47]
    v_pk_mul_f32 v[140:141], v[140:141], v[52:53]
    v_pk_mul_f32 v[142:143], v[142:143], v[54:55]
    v_pk_mul_f32 v[144:145], v[144:145], v[60:61]
    v_pk_mul_f32 v[146:147], v[146:147], v[62:63]
    v_exp_f32_e64 v132, v132
    ds_read_b64_tr_b16 v[12:13], v242 offset:288
    ds_read_b64_tr_b16 v[14:15], v242 offset:256
    ds_read_b128 v[16:19], v241 offset:512
    v_exp_f32 v133, v133
    v_exp_f32 v134, v134
    buffer_store_dwordx4 v[152:155], v252, s[40:43], s4 offen offset:1024 sc1
    v_exp_f32 v135, v135
    v_exp_f32 v136, v136
    v_exp_f32 v137, v137
    v_exp_f32 v138, v138
    v_exp_f32 v139, v139
    v_exp_f32 v140, v140
    v_exp_f32 v141, v141
    v_exp_f32 v142, v142
    v_exp_f32 v143, v143
    v_exp_f32 v144, v144
    v_exp_f32 v145, v145
    v_exp_f32 v146, v146
    v_exp_f32_e64 v147, v147
    v_pk_mul_f32 v[40:41], v[36:37], v[40:41]
    ds_read_b64_tr_b16 v[4:5], v242 offset:32
    ds_read_b64_tr_b16 v[6:7], v242 offset:0
    ds_read_b128 v[8:11], v241 offset:0
    v_pk_mul_f32 v[42:43], v[38:39], v[42:43]
    v_pk_mul_f32 v[48:49], v[44:45], v[48:49]
    v_pk_mul_f32 v[50:51], v[46:47], v[50:51]
    v_pk_mul_f32 v[56:57], v[52:53], v[56:57]
    v_pk_mul_f32 v[58:59], v[54:55], v[58:59]
    v_pk_mul_f32 v[64:65], v[60:61], v[64:65]
    v_pk_mul_f32 v[66:67], v[62:63], v[66:67]
    v_pk_fma_f32 v[132:133], v[132:133], v[178:179], v[178:179] op_sel_hi:[1,0,0]
    v_pk_fma_f32 v[134:135], v[134:135], v[178:179], v[178:179] op_sel_hi:[1,0,0]
    v_pk_fma_f32 v[136:137], v[136:137], v[178:179], v[178:179] op_sel_hi:[1,0,0]
    v_pk_fma_f32 v[138:139], v[138:139], v[178:179], v[178:179] op_sel_hi:[1,0,0]
    v_pk_fma_f32 v[140:141], v[140:141], v[178:179], v[178:179] op_sel_hi:[1,0,0]
    v_pk_fma_f32 v[142:143], v[142:143], v[178:179], v[178:179] op_sel_hi:[1,0,0]
    v_pk_fma_f32 v[144:145], v[144:145], v[178:179], v[178:179] op_sel_hi:[1,0,0]
    v_pk_fma_f32 v[146:147], v[146:147], v[178:179], v[178:179] op_sel_hi:[1,0,0]
    v_rcp_f32 v132, v132
    v_rcp_f32 v133, v133
    v_rcp_f32 v134, v134
    v_rcp_f32 v135, v135
    v_rcp_f32 v136, v136
    v_rcp_f32 v137, v137
    v_rcp_f32 v138, v138
    v_rcp_f32 v139, v139
    v_pk_mul_f32 v[40:41], v[40:41], v[132:133]
    v_pk_mul_f32 v[42:43], v[42:43], v[134:135]
    v_pk_mul_f32 v[48:49], v[48:49], v[136:137]
    v_pk_mul_f32 v[50:51], v[50:51], v[138:139]
    v_cvt_pk_bf16_f32 v156, v40, v41
    v_cvt_pk_bf16_f32 v157, v42, v43
    v_cvt_pk_bf16_f32 v158, v48, v49
    v_cvt_pk_bf16_f32 v159, v50, v51
    s_add_u32 s4, s4, 49152
    buffer_store_dwordx4 v[156:159], v252, s[40:43], s4 offen offset:0 sc1
    v_rcp_f32 v140, v140
    v_rcp_f32 v141, v141
    v_rcp_f32 v142, v142
    v_rcp_f32 v143, v143
    v_rcp_f32 v144, v144
    v_rcp_f32 v145, v145
    v_rcp_f32 v146, v146
    v_rcp_f32 v147, v147
    v_pk_mul_f32 v[56:57], v[56:57], v[140:141]
    v_pk_mul_f32 v[58:59], v[58:59], v[142:143]
    v_pk_mul_f32 v[64:65], v[64:65], v[144:145]
    v_pk_mul_f32 v[66:67], v[66:67], v[146:147]
    v_cvt_pk_bf16_f32 v160, v56, v57
    v_cvt_pk_bf16_f32 v161, v58, v59
    v_cvt_pk_bf16_f32 v162, v64, v65
    v_cvt_pk_bf16_f32 v163, v66, v67
    buffer_store_dwordx4 v[160:163], v252, s[40:43], s4 offen offset:1024 sc1
    v_pk_mul_f32 v[132:133], v[68:69], v[68:69]
    v_pk_mul_f32 v[134:135], v[70:71], v[70:71]
    v_pk_mul_f32 v[136:137], v[76:77], v[76:77]
    v_pk_mul_f32 v[138:139], v[78:79], v[78:79]
    v_pk_mul_f32 v[140:141], v[84:85], v[84:85]
    v_pk_mul_f32 v[142:143], v[86:87], v[86:87]
    v_pk_mul_f32 v[144:145], v[92:93], v[92:93]
    v_pk_mul_f32 v[146:147], v[94:95], v[94:95]
    v_pk_fma_f32 v[132:133], v[132:133], v[188:189], v[188:189] op_sel:[0,0,1] op_sel_hi:[1,0,1]
    ds_read_b64_tr_b16 v[44:45], v242 offset:1312
    ds_read_b64_tr_b16 v[46:47], v242 offset:1280
    ds_read_b128 v[48:51], v241 offset:2560
    v_pk_fma_f32 v[134:135], v[134:135], v[188:189], v[188:189] op_sel:[0,0,1] op_sel_hi:[1,0,1]
    v_pk_fma_f32 v[136:137], v[136:137], v[188:189], v[188:189] op_sel:[0,0,1] op_sel_hi:[1,0,1]
    v_pk_fma_f32 v[138:139], v[138:139], v[188:189], v[188:189] op_sel:[0,0,1] op_sel_hi:[1,0,1]
    v_pk_fma_f32 v[140:141], v[140:141], v[188:189], v[188:189] op_sel:[0,0,1] op_sel_hi:[1,0,1]
    v_pk_fma_f32 v[142:143], v[142:143], v[188:189], v[188:189] op_sel:[0,0,1] op_sel_hi:[1,0,1]
    v_pk_fma_f32 v[144:145], v[144:145], v[188:189], v[188:189] op_sel:[0,0,1] op_sel_hi:[1,0,1]
    v_pk_fma_f32 v[146:147], v[146:147], v[188:189], v[188:189] op_sel:[0,0,1] op_sel_hi:[1,0,1]
    v_pk_mul_f32 v[132:133], v[132:133], v[68:69]
    v_pk_mul_f32 v[134:135], v[134:135], v[70:71]
    v_pk_mul_f32 v[136:137], v[136:137], v[76:77]
    v_pk_mul_f32 v[138:139], v[138:139], v[78:79]
    v_pk_mul_f32 v[140:141], v[140:141], v[84:85]
    v_pk_mul_f32 v[142:143], v[142:143], v[86:87]
    v_pk_mul_f32 v[144:145], v[144:145], v[92:93]
    v_pk_mul_f32 v[146:147], v[146:147], v[94:95]
    v_exp_f32_e64 v132, v132
    ds_read_b64_tr_b16 v[36:37], v242 offset:1056
    ds_read_b64_tr_b16 v[38:39], v242 offset:1024
    ds_read_b128 v[40:43], v241 offset:2048
    v_exp_f32 v133, v133
    v_exp_f32 v134, v134
    v_exp_f32 v135, v135
    v_exp_f32 v136, v136
    v_exp_f32 v137, v137
    v_exp_f32 v138, v138
    v_exp_f32 v139, v139
    v_exp_f32 v140, v140
    v_exp_f32 v141, v141
    v_exp_f32 v142, v142
    v_exp_f32 v143, v143
    v_exp_f32 v144, v144
    v_exp_f32 v145, v145
    v_exp_f32 v146, v146
    v_exp_f32_e64 v147, v147
    v_pk_mul_f32 v[72:73], v[68:69], v[72:73]
    ds_read_b64_tr_b16 v[28:29], v242 offset:800
    ds_read_b64_tr_b16 v[30:31], v242 offset:768
    ds_read_b128 v[32:35], v241 offset:1536
    v_pk_mul_f32 v[74:75], v[70:71], v[74:75]
    v_pk_mul_f32 v[80:81], v[76:77], v[80:81]
    v_pk_mul_f32 v[82:83], v[78:79], v[82:83]
    v_pk_mul_f32 v[88:89], v[84:85], v[88:89]
    v_pk_mul_f32 v[90:91], v[86:87], v[90:91]
    v_pk_mul_f32 v[96:97], v[92:93], v[96:97]
    v_pk_mul_f32 v[98:99], v[94:95], v[98:99]
    v_pk_fma_f32 v[132:133], v[132:133], v[180:181], v[180:181] op_sel_hi:[1,0,0]
    v_pk_fma_f32 v[134:135], v[134:135], v[180:181], v[180:181] op_sel_hi:[1,0,0]
    v_pk_fma_f32 v[136:137], v[136:137], v[180:181], v[180:181] op_sel_hi:[1,0,0]
    v_pk_fma_f32 v[138:139], v[138:139], v[180:181], v[180:181] op_sel_hi:[1,0,0]
    v_pk_fma_f32 v[140:141], v[140:141], v[180:181], v[180:181] op_sel_hi:[1,0,0]
    v_pk_fma_f32 v[142:143], v[142:143], v[180:181], v[180:181] op_sel_hi:[1,0,0]
    v_pk_fma_f32 v[144:145], v[144:145], v[180:181], v[180:181] op_sel_hi:[1,0,0]
    v_pk_fma_f32 v[146:147], v[146:147], v[180:181], v[180:181] op_sel_hi:[1,0,0]
    v_rcp_f32 v132, v132
    v_rcp_f32 v133, v133
    v_rcp_f32 v134, v134
    v_rcp_f32 v135, v135
    v_rcp_f32 v136, v136
    v_rcp_f32 v137, v137
    v_rcp_f32 v138, v138
    v_rcp_f32 v139, v139
    v_pk_mul_f32 v[72:73], v[72:73], v[132:133]
    v_pk_mul_f32 v[74:75], v[74:75], v[134:135]
    v_pk_mul_f32 v[80:81], v[80:81], v[136:137]
    v_pk_mul_f32 v[82:83], v[82:83], v[138:139]
    v_cvt_pk_bf16_f32 v164, v72, v73
    v_cvt_pk_bf16_f32 v165, v74, v75
    v_cvt_pk_bf16_f32 v166, v80, v81
    v_cvt_pk_bf16_f32 v167, v82, v83
    s_add_u32 s4, s4, 49152
    buffer_store_dwordx4 v[164:167], v252, s[40:43], s4 offen offset:0 sc1
    v_rcp_f32 v140, v140
    v_rcp_f32 v141, v141
L_padG4:
    s_cmp_lg_u32 s3, 0
    s_cbranch_scc1 L_wdone
    v_rcp_f32 v142, v142
    v_rcp_f32 v143, v143
    v_rcp_f32 v144, v144
    v_rcp_f32 v145, v145
    v_rcp_f32 v146, v146
    v_rcp_f32 v147, v147
    v_pk_mul_f32 v[88:89], v[88:89], v[140:141]
    v_pk_mul_f32 v[90:91], v[90:91], v[142:143]
    v_pk_mul_f32 v[96:97], v[96:97], v[144:145]
    v_pk_mul_f32 v[98:99], v[98:99], v[146:147]
    v_cvt_pk_bf16_f32 v168, v88, v89
    v_cvt_pk_bf16_f32 v169, v90, v91
    v_cvt_pk_bf16_f32 v170, v96, v97
    v_cvt_pk_bf16_f32 v171, v98, v99
    buffer_store_dwordx4 v[168:171], v252, s[40:43], s4 offen offset:1024 sc1
    v_pk_mul_f32 v[132:133], v[100:101], v[100:101]
    v_pk_mul_f32 v[134:135], v[102:103], v[102:103]
    v_pk_mul_f32 v[136:137], v[108:109], v[108:109]
    v_pk_mul_f32 v[138:139], v[110:111], v[110:111]
    v_pk_mul_f32 v[140:141], v[116:117], v[116:117]
    v_pk_mul_f32 v[142:143], v[118:119], v[118:119]
    v_pk_mul_f32 v[144:145], v[124:125], v[124:125]
    v_pk_mul_f32 v[146:147], v[126:127], v[126:127]
    v_pk_fma_f32 v[132:133], v[132:133], v[190:191], v[190:191] op_sel:[0,0,1] op_sel_hi:[1,0,1]
    v_pk_fma_f32 v[134:135], v[134:135], v[190:191], v[190:191] op_sel:[0,0,1] op_sel_hi:[1,0,1]
    v_pk_fma_f32 v[136:137], v[136:137], v[190:191], v[190:191] op_sel:[0,0,1] op_sel_hi:[1,0,1]
    v_pk_fma_f32 v[138:139], v[138:139], v[190:191], v[190:191] op_sel:[0,0,1] op_sel_hi:[1,0,1]
    v_pk_fma_f32 v[140:141], v[140:141], v[190:191], v[190:191] op_sel:[0,0,1] op_sel_hi:[1,0,1]
    v_pk_fma_f32 v[142:143], v[142:143], v[190:191], v[190:191] op_sel:[0,0,1] op_sel_hi:[1,0,1]
    v_pk_fma_f32 v[144:145], v[144:145], v[190:191], v[190:191] op_sel:[0,0,1] op_sel_hi:[1,0,1]
    v_pk_fma_f32 v[146:147], v[146:147], v[190:191], v[190:191] op_sel:[0,0,1] op_sel_hi:[1,0,1]
    v_pk_mul_f32 v[132:133], v[132:133], v[100:101]
    v_pk_mul_f32 v[134:135], v[134:135], v[102:103]
    v_pk_mul_f32 v[136:137], v[136:137], v[108:109]
    v_pk_mul_f32 v[138:139], v[138:139], v[110:111]
    v_pk_mul_f32 v[140:141], v[140:141], v[116:117]
    v_pk_mul_f32 v[142:143], v[142:143], v[118:119]
    v_pk_mul_f32 v[144:145], v[144:145], v[124:125]
    v_pk_mul_f32 v[146:147], v[146:147], v[126:127]
    v_exp_f32_e64 v132, v132
    ds_read_b64_tr_b16 v[60:61], v242 offset:1824
    ds_read_b64_tr_b16 v[62:63], v242 offset:1792
    ds_read_b128 v[64:67], v241 offset:3584
    v_exp_f32 v133, v133
    v_exp_f32 v134, v134
    v_exp_f32 v135, v135
    v_exp_f32 v136, v136
    v_exp_f32 v137, v137
    v_exp_f32 v138, v138
    v_exp_f32 v139, v139
    v_exp_f32 v140, v140
    v_exp_f32 v141, v141
    v_exp_f32 v142, v142
    v_exp_f32 v143, v143
    v_exp_f32 v144, v144
    v_exp_f32 v145, v145
    v_exp_f32 v146, v146
    v_exp_f32_e64 v147, v147
    v_pk_mul_f32 v[104:105], v[100:101], v[104:105]
    ds_read_b64_tr_b16 v[52:53], v242 offset:1568
    ds_read_b64_tr_b16 v[54:55], v242 offset:1536
    ds_read_b128 v[56:59], v241 offset:3072
    v_pk_mul_f32 v[106:107], v[102:103], v[106:107]
    v_pk_mul_f32 v[112:113], v[108:109], v[112:113]
    v_pk_mul_f32 v[114:115], v[110:111], v[114:115]
    v_pk_mul_f32 v[120:121], v[116:117], v[120:121]
    v_pk_mul_f32 v[122:123], v[118:119], v[122:123]
    v_pk_mul_f32 v[128:129], v[124:125], v[128:129]
    v_pk_mul_f32 v[130:131], v[126:127], v[130:131]
    v_pk_fma_f32 v[132:133], v[132:133], v[182:183], v[182:183] op_sel_hi:[1,0,0]
    v_pk_fma_f32 v[134:135], v[134:135], v[182:183], v[182:183] op_sel_hi:[1,0,0]
    v_pk_fma_f32 v[136:137], v[136:137], v[182:183], v[182:183] op_sel_hi:[1,0,0]
    v_pk_fma_f32 v[138:139], v[138:139], v[182:183], v[182:183] op_sel_hi:[1,0,0]
    v_pk_fma_f32 v[140:141], v[140:141], v[182:183], v[182:183] op_sel_hi:[1,0,0]
    v_pk_fma_f32 v[142:143], v[142:143], v[182:183], v[182:183] op_sel_hi:[1,0,0]
    v_pk_fma_f32 v[144:145], v[144:145], v[182:183], v[182:183] op_sel_hi:[1,0,0]
    v_pk_fma_f32 v[146:147], v[146:147], v[182:183], v[182:183] op_sel_hi:[1,0,0]
    v_rcp_f32 v132, v132
    v_rcp_f32 v133, v133
    v_rcp_f32 v134, v134
    v_rcp_f32 v135, v135
    v_rcp_f32 v136, v136
    v_rcp_f32 v137, v137
    v_rcp_f32 v138, v138
    v_rcp_f32 v139, v139
    v_pk_mul_f32 v[104:105], v[104:105], v[132:133]
    v_pk_mul_f32 v[106:107], v[106:107], v[134:135]
    v_pk_mul_f32 v[112:113], v[112:113], v[136:137]
    v_pk_mul_f32 v[114:115], v[114:115], v[138:139]
    v_cvt_pk_bf16_f32 v148, v104, v105
    v_cvt_pk_bf16_f32 v149, v106, v107
    v_cvt_pk_bf16_f32 v150, v112, v113
    v_cvt_pk_bf16_f32 v151, v114, v115
    s_add_u32 s4, s4, 49152
    buffer_store_dwordx4 v[148:151], v252, s[40:43], s4 offen offset:0 sc1
    v_rcp_f32 v140, v140
    v_rcp_f32 v141, v141
    v_rcp_f32 v142, v142
    v_rcp_f32 v143, v143
    v_rcp_f32 v144, v144
    v_rcp_f32 v145, v145
    v_rcp_f32 v146, v146
    v_rcp_f32 v147, v147
    v_pk_mul_f32 v[120:121], v[120:121], v[140:141]
    v_pk_mul_f32 v[122:123], v[122:123], v[142:143]
    v_pk_mul_f32 v[128:129], v[128:129], v[144:145]
    v_pk_mul_f32 v[130:131], v[130:131], v[146:147]
    v_cvt_pk_bf16_f32 v152, v120, v121
    v_cvt_pk_bf16_f32 v153, v122, v123
    v_cvt_pk_bf16_f32 v154, v128, v129
    v_cvt_pk_bf16_f32 v155, v130, v131
    buffer_store_dwordx4 v[152:155], v252, s[40:43], s4 offen offset:1024 sc1
    s_waitcnt lgkmcnt(0)
    s_mov_b32 m0, s69
    s_nop 0
L_tail:
    s_bitcmp1_b32 s54, 1
    s_cbranch_scc1 L_cvBt
    v_mfma_f32_16x16x32_bf16 v[196:199], v[8:11], v[4:7], 0
    ds_read_b64_tr_b16 v[68:69], v242 offset:2080
    s_add_u32 s5, s71, 131072
    v_mfma_f32_16x16x32_bf16 v[200:203], v[24:27], v[12:15], 0
    ds_read_b64_tr_b16 v[70:71], v242 offset:2048
    s_mul_i32 s6, s54, 3072
    v_mfma_f32_16x16x32_bf16 v[200:203], v[16:19], v[20:23], v[200:203]
    ds_read_b128 v[72:75], v241 offset:4096
    s_add_u32 s6, s6, 147456
    v_mfma_f32_16x16x32_bf16 v[200:203], v[32:35], v[4:7], v[200:203]
    buffer_load_dwordx4 a[164:167], v252, s[40:43], s67 offen offset:1024 sc1
    v_mfma_f32_16x16x32_bf16 v[200:203], v[8:11], v[28:31], v[200:203]
    ds_read_b64_tr_b16 v[76:77], v242 offset:2336
    v_add_f32_dpp v212, v199, v198 wave_ror:1 row_mask:0xf bank_mask:0xf bound_ctrl:0
    v_mfma_f32_16x16x32_bf16 v[204:207], v[24:27], v[20:23], 0
    ds_read_b64_tr_b16 v[78:79], v242 offset:2304
    v_add_f32_dpp v198, v199, v198 wave_shr:1 row_mask:0xf bank_mask:0xf bound_ctrl:0
    v_mfma_f32_16x16x32_bf16 v[204:207], v[32:35], v[12:15], v[204:207]
    s_waitcnt vmcnt(3)
    s_bitcmp1_b32 s68, 30
    s_cbranch_scc1 L_nf5
    s_atomic_swap_x2 s[48:49], s[40:41], s68
L_nf5:
    v_mfma_f32_16x16x32_bf16 v[204:207], v[16:19], v[28:31], v[204:207]
    ds_read_b128 v[80:83], v241 offset:4608
    s_add_u32 s68, s68, 131072
    v_mfma_f32_16x16x32_bf16 v[204:207], v[40:43], v[4:7], v[204:207]
    buffer_load_dwordx4 a[168:171], v252, s[40:43], s67 offen offset:2048 sc1
    v_mfma_f32_16x16x32_bf16 v[204:207], v[8:11], v[36:39], v[204:207]
    ds_read_b64_tr_b16 v[84:85], v242 offset:2592
    v_add_f32_dpp v213, v212, v197 wave_ror:1 row_mask:0xf bank_mask:0xf bound_ctrl:0
    v_mfma_f32_16x16x32_bf16 v[208:211], v[40:43], v[28:31], 0
    ds_read_b64_tr_b16 v[86:87], v242 offset:2560
    v_add_f32_dpp v197, v198, v197 wave_shr:1 row_mask:0xf bank_mask:0xf bound_ctrl:0
    v_mfma_f32_16x16x32_bf16 v[208:211], v[32:35], v[36:39], v[208:211]
    buffer_load_dwordx4 a[172:175], v252, s[40:43], s67 offen offset:3072 sc1
    v_mfma_f32_16x16x32_bf16 v[208:211], v[48:51], v[20:23], v[208:211]
    ds_read_b128 v[88:91], v241 offset:5120
    s_add_u32 s67, s67, 4096
    v_mfma_f32_16x16x32_bf16 v[208:211], v[24:27], v[44:47], v[208:211]
    ds_read_b64_tr_b16 v[92:93], v242 offset:2848
    v_add_f32_dpp v214, v213, v196 wave_ror:1 row_mask:0xf bank_mask:0xf bound_ctrl:0
    v_mfma_f32_16x16x32_bf16 v[208:211], v[56:59], v[12:15], v[208:211]
    buffer_load_dwordx4 a[176:179], v252, s[40:43], s67 offen offset:0 sc1
    v_mfma_f32_16x16x32_bf16 v[208:211], v[16:19], v[52:55], v[208:211]
    ds_read_b64_tr_b16 v[94:95], v242 offset:2816
    v_add_f32_dpp v196, v197, v196 wave_shr:1 row_mask:0xf bank_mask:0xf bound_ctrl:0
    v_mfma_f32_16x16x32_bf16 v[208:211], v[64:67], v[4:7], v[208:211]
    ds_read_b128 v[96:99], v241 offset:5632
    v_sub_f32 v197, v214, v196
    v_mfma_f32_16x16x32_bf16 v[208:211], v[8:11], v[60:63], v[208:211]
    ds_write_addtid_b32 v196 offset:0
    v_mfma_f32_16x16x32_bf16 v[216:219], v[40:43], v[36:39], 0
    buffer_load_dwordx4 a[180:183], v252, s[40:43], s67 offen offset:1024 sc1
    v_mfma_f32_16x16x32_bf16 v[216:219], v[48:51], v[28:31], v[216:219]
    ds_write_addtid_b32 v197 offset:16384
    v_add_f32_dpp v212, v203, v202 wave_ror:1 row_mask:0xf bank_mask:0xf bound_ctrl:0
    v_mfma_f32_16x16x32_bf16 v[216:219], v[32:35], v[44:47], v[216:219]
    ds_read_b64_tr_b16 v[100:101], v242 offset:3104
    v_add_f32_dpp v202, v203, v202 wave_shr:1 row_mask:0xf bank_mask:0xf bound_ctrl:0
    v_mfma_f32_16x16x32_bf16 v[216:219], v[56:59], v[20:23], v[216:219]
    ds_read_b64_tr_b16 v[102:103], v242 offset:3072
    v_add_f32_dpp v213, v212, v201 wave_ror:1 row_mask:0xf bank_mask:0xf bound_ctrl:0
    v_mfma_f32_16x16x32_bf16 v[216:219], v[24:27], v[52:55], v[216:219]
    buffer_load_dwordx4 a[184:187], v252, s[40:43], s67 offen offset:2048 sc1
    v_mfma_f32_16x16x32_bf16 v[216:219], v[64:67], v[12:15], v[216:219]
    ds_read_b128 v[104:107], v241 offset:6144
    v_add_f32_dpp v201, v202, v201 wave_shr:1 row_mask:0xf bank_mask:0xf bound_ctrl:0
    v_mfma_f32_16x16x32_bf16 v[216:219], v[16:19], v[60:63], v[216:219]
    ds_read_b64_tr_b16 v[108:109], v242 offset:3360
    v_add_f32_dpp v214, v213, v200 wave_ror:1 row_mask:0xf bank_mask:0xf bound_ctrl:0
    s_waitcnt lgkmcnt(15)
    v_mfma_f32_16x16x32_bf16 v[216:219], v[72:75], v[4:7], v[216:219]
    ds_read_b64_tr_b16 v[110:111], v242 offset:3328
    v_add_f32_dpp v200, v201, v200 wave_shr:1 row_mask:0xf bank_mask:0xf bound_ctrl:0
    v_mfma_f32_16x16x32_bf16 v[216:219], v[8:11], v[68:71], v[216:219]
    ds_read_b128 v[112:115], v241 offset:6656
    v_sub_f32 v201, v214, v200
    v_mfma_f32_16x16x32_bf16 v[220:223], v[56:59], v[44:47], 0
    s_mov_b32 m0, s6
    s_nop 0
    buffer_load_dwordx4 v249, s[36:39], s79 offen offset:0 lds
    s_mov_b32 m0, s69
    v_mfma_f32_16x16x32_bf16 v[220:223], v[48:51], v[52:55], v[220:223]
    ds_write_addtid_b32 v200 offset:1536
    v_mfma_f32_16x16x32_bf16 v[220:223], v[64:67], v[36:39], v[220:223]
    ds_write_addtid_b32 v201 offset:17920
    v_add_f32_dpp v212, v207, v206 wave_ror:1 row_mask:0xf bank_mask:0xf bound_ctrl:0
    v_mfma_f32_16x16x32_bf16 v[220:223], v[40:43], v[60:63], v[220:223]
    ds_read_b64_tr_b16 v[116:117], v242 offset:3616
    v_add_f32_dpp v206, v207, v206 wave_shr:1 row_mask:0xf bank_mask:0xf bound_ctrl:0
    v_mfma_f32_16x16x32_bf16 v[220:223], v[72:75], v[28:31], v[220:223]
    ds_read_b64_tr_b16 v[118:119], v242 offset:3584
    v_add_f32_dpp v213, v212, v205 wave_ror:1 row_mask:0xf bank_mask:0xf bound_ctrl:0
    v_mfma_f32_16x16x32_bf16 v[220:223], v[32:35], v[68:71], v[220:223]
    ds_read_b128 v[120:123], v241 offset:7168
    v_add_f32_dpp v205, v206, v205 wave_shr:1 row_mask:0xf bank_mask:0xf bound_ctrl:0
    s_waitcnt lgkmcnt(15)
    v_mfma_f32_16x16x32_bf16 v[220:223], v[80:83], v[20:23], v[220:223]
    s_mov_b32 m0, s6
    s_nop 0
    buffer_load_dwordx4 v2, s[36:39], s79 offen offset:1024 lds
    s_mov_b32 m0, s69
    v_mfma_f32_16x16x32_bf16 v[220:223], v[24:27], v[76:79], v[220:223]
    ds_read_b64_tr_b16 v[124:125], v242 offset:3872
    v_add_f32_dpp v214, v213, v204 wave_ror:1 row_mask:0xf bank_mask:0xf bound_ctrl:0
    v_mfma_f32_16x16x32_bf16 v[220:223], v[88:91], v[12:15], v[220:223]
    ds_read_b64_tr_b16 v[126:127], v242 offset:3840
    v_add_f32_dpp v204, v205, v204 wave_shr:1 row_mask:0xf bank_mask:0xf bound_ctrl:0
    v_mfma_f32_16x16x32_bf16 v[220:223], v[16:19], v[84:87], v[220:223]
    ds_read_b128 v[128:131], v241 offset:7680
    v_sub_f32 v205, v214, v204
    s_waitcnt lgkmcnt(15)
    v_mfma_f32_16x16x32_bf16 v[220:223], v[96:99], v[4:7], v[220:223]
    ds_write_addtid_b32 v204 offset:2048
    v_mfma_f32_16x16x32_bf16 v[220:223], v[8:11], v[92:95], v[220:223]
    ds_write_addtid_b32 v205 offset:18432
    v_add_f32_dpp v212, v211, v210 wave_ror:1 row_mask:0xf bank_mask:0xf bound_ctrl:0
    v_mfma_f32_16x16x32_bf16 v[224:227], v[56:59], v[52:55], 0
    s_mov_b32 m0, s6
    s_nop 0
    buffer_load_dwordx4 v3, s[36:39], s79 offen offset:2048 lds
    s_mov_b32 m0, s69
    v_mfma_f32_16x16x32_bf16 v[224:227], v[64:67], v[44:47], v[224:227]
    ds_read_b64_tr_b16 v[132:133], v242 offset:4256
    v_add_f32_dpp v210, v211, v210 wave_shr:1 row_mask:0xf bank_mask:0xf bound_ctrl:0
    v_mfma_f32_16x16x32_bf16 v[224:227], v[48:51], v[60:63], v[224:227]
    ds_read_b64_tr_b16 v[134:135], v242 offset:4224
    v_add_f32_dpp v213, v212, v209 wave_ror:1 row_mask:0xf bank_mask:0xf bound_ctrl:0
    v_mfma_f32_16x16x32_bf16 v[224:227], v[72:75], v[36:39], v[224:227]
    ds_read_b128 v[136:139], v241 offset:8656
    v_add_f32_dpp v209, v210, v209 wave_shr:1 row_mask:0xf bank_mask:0xf bound_ctrl:0
    v_mfma_f32_16x16x32_bf16 v[224:227], v[40:43], v[68:71], v[224:227]
    ds_read_b64_tr_b16 v[140:141], v242 offset:4512
    v_add_f32_dpp v214, v213, v208 wave_ror:1 row_mask:0xf bank_mask:0xf bound_ctrl:0
    v_mfma_f32_16x16x32_bf16 v[224:227], v[80:83], v[28:31], v[224:227]
    ds_read_b64_tr_b16 v[142:143], v242 offset:4480
    v_add_f32_dpp v208, v209, v208 wave_shr:1 row_mask:0xf bank_mask:0xf bound_ctrl:0
    v_mfma_f32_16x16x32_bf16 v[224:227], v[32:35], v[76:79], v[224:227]
    ds_read_b128 v[144:147], v241 offset:9168
    v_sub_f32 v209, v214, v208
    v_mfma_f32_16x16x32_bf16 v[224:227], v[88:91], v[20:23], v[224:227]
    buffer_load_dwordx4 a[188:191], v252, s[40:43], s67 offen offset:3072 sc1
    v_mfma_f32_16x16x32_bf16 v[224:227], v[24:27], v[84:87], v[224:227]
    ds_write_addtid_b32 v208 offset:3584
    s_add_u32 s67, s67, 4096
    v_mfma_f32_16x16x32_bf16 v[224:227], v[96:99], v[12:15], v[224:227]
    ds_write_addtid_b32 v209 offset:19968
    v_mov_b32 v232, 0
    v_mfma_f32_16x16x32_bf16 v[224:227], v[16:19], v[92:95], v[224:227]
    ds_read_b64_tr_b16 v[148:149], v242 offset:4768
    v_mov_b32 v233, 0
    s_waitcnt lgkmcnt(15)
    v_mfma_f32_16x16x32_bf16 v[224:227], v[104:107], v[4:7], v[224:227]
    s_mov_b32 exec_lo, 0x1010101
    s_mov_b32 exec_hi, 0x101
    buffer_atomic_or_x2 v[232:233], v238, s[40:43], s71 offen sc0
    s_mov_b64 exec, -1
    v_mfma_f32_16x16x32_bf16 v[224:227], v[8:11], v[100:103], v[224:227]
    buffer_load_dwordx4 a[192:195], v252, s[40:43], s67 offen offset:0 sc1
    v_mfma_f32_16x16x32_bf16 v[196:199], v[72:75], v[60:63], 0
    ds_read_b64_tr_b16 v[150:151], v242 offset:4736
    v_add_f32_dpp v212, v219, v218 wave_ror:1 row_mask:0xf bank_mask:0xf bound_ctrl:0
    v_mfma_f32_16x16x32_bf16 v[196:199], v[64:67], v[68:71], v[196:199]
    ds_read_b128 v[152:155], v241 offset:9680
    v_add_f32_dpp v218, v219, v218 wave_shr:1 row_mask:0xf bank_mask:0xf bound_ctrl:0
    v_mfma_f32_16x16x32_bf16 v[196:199], v[80:83], v[52:55], v[196:199]
    ds_read_b64_tr_b16 v[156:157], v242 offset:5024
    v_add_f32_dpp v213, v212, v217 wave_ror:1 row_mask:0xf bank_mask:0xf bound_ctrl:0
    v_mfma_f32_16x16x32_bf16 v[196:199], v[56:59], v[76:79], v[196:199]
    buffer_load_dwordx4 a[196:199], v252, s[40:43], s67 offen offset:1024 sc1
    v_mfma_f32_16x16x32_bf16 v[196:199], v[88:91], v[44:47], v[196:199]
    s_waitcnt vmcnt(13)
    s_bitcmp1_b32 s68, 30
    s_cbranch_scc1 L_nf4
    s_atomic_swap_x2 s[48:49], s[40:41], s68
L_nf4:
    v_mfma_f32_16x16x32_bf16 v[196:199], v[48:51], v[84:87], v[196:199]
    ds_read_b64_tr_b16 v[158:159], v242 offset:4992
    v_add_f32_dpp v217, v218, v217 wave_shr:1 row_mask:0xf bank_mask:0xf bound_ctrl:0
    v_mfma_f32_16x16x32_bf16 v[196:199], v[96:99], v[36:39], v[196:199]
    ds_read_b128 v[160:163], v241 offset:10192
    v_add_f32_dpp v214, v213, v216 wave_ror:1 row_mask:0xf bank_mask:0xf bound_ctrl:0
    v_mfma_f32_16x16x32_bf16 v[196:199], v[40:43], v[92:95], v[196:199]
    ds_read_b64_tr_b16 v[164:165], v242 offset:5280
    v_add_f32_dpp v216, v217, v216 wave_shr:1 row_mask:0xf bank_mask:0xf bound_ctrl:0
    v_mfma_f32_16x16x32_bf16 v[196:199], v[104:107], v[28:31], v[196:199]
    buffer_load_dwordx4 a[200:203], v252, s[40:43], s67 offen offset:2048 sc1
    v_mfma_f32_16x16x32_bf16 v[196:199], v[32:35], v[100:103], v[196:199]
    ds_read_b64_tr_b16 v[166:167], v242 offset:5248
    v_sub_f32 v217, v214, v216
    v_mfma_f32_16x16x32_bf16 v[196:199], v[112:115], v[20:23], v[196:199]
    ds_write_addtid_b32 v216 offset:4096
    v_mfma_f32_16x16x32_bf16 v[196:199], v[24:27], v[108:111], v[196:199]
    ds_write_addtid_b32 v217 offset:20480
    v_add_f32_dpp v212, v223, v222 wave_ror:1 row_mask:0xf bank_mask:0xf bound_ctrl:0
    s_waitcnt lgkmcnt(15)
    v_mfma_f32_16x16x32_bf16 v[196:199], v[120:123], v[12:15], v[196:199]
    buffer_load_dwordx4 a[204:207], v252, s[40:43], s67 offen offset:3072 sc1
    v_mfma_f32_16x16x32_bf16 v[196:199], v[16:19], v[116:119], v[196:199]
    ds_read_b128 v[168:171], v241 offset:10704
    s_add_u32 s67, s67, 4096
    v_mfma_f32_16x16x32_bf16 v[196:199], v[128:131], v[4:7], v[196:199]
    ds_read_b64_tr_b16 v[172:173], v242 offset:5536
    v_add_f32_dpp v222, v223, v222 wave_shr:1 row_mask:0xf bank_mask:0xf bound_ctrl:0
    v_mfma_f32_16x16x32_bf16 v[196:199], v[8:11], v[124:127], v[196:199]
    ds_read_b64_tr_b16 v[174:175], v242 offset:5504
    v_add_f32_dpp v213, v212, v221 wave_ror:1 row_mask:0xf bank_mask:0xf bound_ctrl:0
    ds_read_b128 v[176:179], v241 offset:11216
    ds_read_b64_tr_b16 v[180:181], v242 offset:5792
    ds_read_b64_tr_b16 v[182:183], v242 offset:5760
    ds_read_b128 v[184:187], v241 offset:11728
    ds_read_b64_tr_b16 v[188:189], v242 offset:6048
    ds_read_b64_tr_b16 v[190:191], v242 offset:6016
    ds_read_b128 v[192:195], v241 offset:12240
    v_mfma_f32_16x16x32_bf16 v[200:203], v[136:139], v[132:135], 0
    buffer_load_dwordx4 a[208:211], v252, s[40:43], s67 offen offset:0 sc1
    s_waitcnt lgkmcnt(14)
    v_mfma_f32_16x16x32_bf16 v[204:207], v[152:155], v[140:143], 0
    ds_read_b64_tr_b16 v[4:5], v242 offset:6304
    v_add_f32_dpp v221, v222, v221 wave_shr:1 row_mask:0xf bank_mask:0xf bound_ctrl:0
    v_mfma_f32_16x16x32_bf16 v[204:207], v[144:147], v[148:151], v[204:207]
    ds_read_b64_tr_b16 v[6:7], v242 offset:6272
    v_add_f32_dpp v214, v213, v220 wave_ror:1 row_mask:0xf bank_mask:0xf bound_ctrl:0
    v_mfma_f32_16x16x32_bf16 v[204:207], v[160:163], v[132:135], v[204:207]
    ds_read_b128 v[8:11], v241 offset:12752
    v_add_f32_dpp v220, v221, v220 wave_shr:1 row_mask:0xf bank_mask:0xf bound_ctrl:0
    v_mfma_f32_16x16x32_bf16 v[204:207], v[136:139], v[156:159], v[204:207]
    ds_read_b64_tr_b16 v[12:13], v242 offset:6560
    v_sub_f32 v221, v214, v220
    s_waitcnt lgkmcnt(13)
    v_mfma_f32_16x16x32_bf16 v[208:211], v[152:155], v[148:151], 0
    buffer_load_dwordx4 a[212:215], v252, s[40:43], s67 offen offset:1024 sc1
    v_mfma_f32_16x16x32_bf16 v[208:211], v[160:163], v[140:143], v[208:211]
    ds_write_addtid_b32 v220 offset:5632
    v_mfma_f32_16x16x32_bf16 v[208:211], v[144:147], v[156:159], v[208:211]
    ds_write_addtid_b32 v221 offset:22016
    v_add_f32_dpp v212, v227, v226 wave_ror:1 row_mask:0xf bank_mask:0xf bound_ctrl:0
    v_mfma_f32_16x16x32_bf16 v[208:211], v[168:171], v[132:135], v[208:211]
    ds_read_b64_tr_b16 v[14:15], v242 offset:6528
    v_add_f32_dpp v226, v227, v226 wave_shr:1 row_mask:0xf bank_mask:0xf bound_ctrl:0
    v_mfma_f32_16x16x32_bf16 v[208:211], v[136:139], v[164:167], v[208:211]
    buffer_load_dwordx4 a[216:219], v252, s[40:43], s67 offen offset:2048 sc1
    s_waitcnt lgkmcnt(10)
    v_mfma_f32_16x16x32_bf16 v[216:219], v[168:171], v[156:159], 0
    ds_read_b128 v[16:19], v241 offset:13264
    v_add_f32_dpp v213, v212, v225 wave_ror:1 row_mask:0xf bank_mask:0xf bound_ctrl:0
    v_mfma_f32_16x16x32_bf16 v[216:219], v[160:163], v[164:167], v[216:219]
    ds_read_b64_tr_b16 v[20:21], v242 offset:6816
    v_add_f32_dpp v225, v226, v225 wave_shr:1 row_mask:0xf bank_mask:0xf bound_ctrl:0
    v_mfma_f32_16x16x32_bf16 v[216:219], v[176:179], v[148:151], v[216:219]
    ds_read_b64_tr_b16 v[22:23], v242 offset:6784
    v_add_f32_dpp v214, v213, v224 wave_ror:1 row_mask:0xf bank_mask:0xf bound_ctrl:0
    v_mfma_f32_16x16x32_bf16 v[216:219], v[152:155], v[172:175], v[216:219]
    ds_read_b128 v[24:27], v241 offset:13776
    v_add_f32_dpp v224, v225, v224 wave_shr:1 row_mask:0xf bank_mask:0xf bound_ctrl:0
    v_mfma_f32_16x16x32_bf16 v[216:219], v[184:187], v[140:143], v[216:219]
    buffer_load_dwordx4 a[220:223], v252, s[40:43], s67 offen offset:3072 sc1
    v_mfma_f32_16x16x32_bf16 v[216:219], v[144:147], v[180:183], v[216:219]
    ds_read_b64_tr_b16 v[28:29], v242 offset:7072
    s_add_u32 s67, s67, 4096
    s_waitcnt lgkmcnt(12)
    v_mfma_f32_16x16x32_bf16 v[216:219], v[192:195], v[132:135], v[216:219]
    ds_read_b64_tr_b16 v[30:31], v242 offset:7040
    v_sub_f32 v225, v214, v224
    v_mfma_f32_16x16x32_bf16 v[216:219], v[136:139], v[188:191], v[216:219]
    ds_write_addtid_b32 v224 offset:6144
    v_mfma_f32_16x16x32_bf16 v[220:223], v[168:171], v[164:167], 0
    buffer_load_dwordx4 a[224:227], v252, s[40:43], s67 offen offset:0 sc1
    v_mfma_f32_16x16x32_bf16 v[220:223], v[176:179], v[156:159], v[220:223]
    ds_write_addtid_b32 v225 offset:22528
    v_add_f32_dpp v212, v199, v198 wave_ror:1 row_mask:0xf bank_mask:0xf bound_ctrl:0
    v_mfma_f32_16x16x32_bf16 v[220:223], v[160:163], v[172:175], v[220:223]
    ds_read_b128 v[32:35], v241 offset:14288
    v_add_f32_dpp v198, v199, v198 wave_shr:1 row_mask:0xf bank_mask:0xf bound_ctrl:0
    v_mfma_f32_16x16x32_bf16 v[220:223], v[184:187], v[148:151], v[220:223]
    ds_read_b64_tr_b16 v[36:37], v242 offset:7328
    v_add_f32_dpp v213, v212, v197 wave_ror:1 row_mask:0xf bank_mask:0xf bound_ctrl:0
    v_mfma_f32_16x16x32_bf16 v[220:223], v[152:155], v[180:183], v[220:223]
    buffer_load_dwordx4 a[228:231], v252, s[40:43], s67 offen offset:1024 sc1
    v_mfma_f32_16x16x32_bf16 v[220:223], v[192:195], v[140:143], v[220:223]
    ds_read_b64_tr_b16 v[38:39], v242 offset:7296
    v_add_f32_dpp v197, v198, v197 wave_shr:1 row_mask:0xf bank_mask:0xf bound_ctrl:0
    v_mfma_f32_16x16x32_bf16 v[220:223], v[144:147], v[188:191], v[220:223]
    ds_read_b128 v[40:43], v241 offset:14800
    v_add_f32_dpp v214, v213, v196 wave_ror:1 row_mask:0xf bank_mask:0xf bound_ctrl:0
    s_waitcnt lgkmcnt(15)
    v_mfma_f32_16x16x32_bf16 v[220:223], v[8:11], v[132:135], v[220:223]
    s_cmp_eq_u32 s80, 0
    s_cbranch_scc1 L_ep0
L_epr0:
    v_mfma_f32_16x16x32_bf16 v[220:223], v[136:139], v[4:7], v[220:223]
    buffer_load_dwordx4 a[232:235], v252, s[40:43], s67 offen offset:2048 sc1
    v_mfma_f32_16x16x32_bf16 v[224:227], v[184:187], v[172:175], 0
    ds_read_b64_tr_b16 v[44:45], v242 offset:7584
    v_add_f32_dpp v196, v197, v196 wave_shr:1 row_mask:0xf bank_mask:0xf bound_ctrl:0
    v_mfma_f32_16x16x32_bf16 v[224:227], v[176:179], v[180:183], v[224:227]
    s_waitcnt vmcnt(11)
    v_cmp_ne_u64 s[50:51], s[48:49], v[232:233]
    s_nop 0
    s_and_b32 s50, s50, 0x1010101
    s_and_b32 s51, s51, 0x101
    s_cmp_lg_u64 s[50:51], 0
    s_cbranch_scc1 L_slow_fh0
L_ok_fh0:
    v_mfma_f32_16x16x32_bf16 v[224:227], v[192:195], v[164:167], v[224:227]
    buffer_load_dwordx4 v[68:71], v239, s[40:43], 0 offen offset:0 sc1
    v_mfma_f32_16x16x32_bf16 v[224:227], v[168:171], v[188:191], v[224:227]
    ds_read_b64_tr_b16 v[46:47], v242 offset:7552
    v_sub_f32 v197, v214, v196
    v_mfma_f32_16x16x32_bf16 v[224:227], v[8:11], v[156:159], v[224:227]
    ds_write_addtid_b32 v196 offset:7680
    v_mfma_f32_16x16x32_bf16 v[224:227], v[160:163], v[4:7], v[224:227]
    ds_write_addtid_b32 v197 offset:24064
    v_add_f32_dpp v212, v203, v202 wave_ror:1 row_mask:0xf bank_mask:0xf bound_ctrl:0
    s_waitcnt lgkmcnt(15)
    v_mfma_f32_16x16x32_bf16 v[224:227], v[16:19], v[148:151], v[224:227]
    buffer_load_dwordx4 v[72:75], v239, s[40:43], 0 offen offset:1024 sc1
    v_mfma_f32_16x16x32_bf16 v[224:227], v[152:155], v[12:15], v[224:227]
    ds_read_b128 v[48:51], v241 offset:15312
    v_add_f32_dpp v202, v203, v202 wave_shr:1 row_mask:0xf bank_mask:0xf bound_ctrl:0
    s_waitcnt lgkmcnt(13)
    v_mfma_f32_16x16x32_bf16 v[224:227], v[24:27], v[140:143], v[224:227]
    ds_read_b64_tr_b16 v[52:53], v242 offset:7840
    v_add_f32_dpp v213, v212, v201 wave_ror:1 row_mask:0xf bank_mask:0xf bound_ctrl:0
    v_mfma_f32_16x16x32_bf16 v[224:227], v[144:147], v[20:23], v[224:227]
    ds_read_b64_tr_b16 v[54:55], v242 offset:7808
    v_add_f32_dpp v201, v202, v201 wave_shr:1 row_mask:0xf bank_mask:0xf bound_ctrl:0
    s_waitcnt lgkmcnt(10)
    v_mfma_f32_16x16x32_bf16 v[224:227], v[32:35], v[132:135], v[224:227]
    ds_read_b128 v[56:59], v241 offset:15824
    v_add_f32_dpp v214, v213, v200 wave_ror:1 row_mask:0xf bank_mask:0xf bound_ctrl:0
    v_mfma_f32_16x16x32_bf16 v[224:227], v[136:139], v[28:31], v[224:227]
    buffer_load_dwordx4 v[76:79], v239, s[40:43], 0 offen offset:2048 sc1
    v_mfma_f32_16x16x32_bf16 v[196:199], v[184:187], v[180:183], 0
    ds_read_b64_tr_b16 v[60:61], v242 offset:8096
    v_add_f32_dpp v200, v201, v200 wave_shr:1 row_mask:0xf bank_mask:0xf bound_ctrl:0
    v_mfma_f32_16x16x32_bf16 v[196:199], v[192:195], v[172:175], v[196:199]
    ds_read_b64_tr_b16 v[62:63], v242 offset:8064
    v_sub_f32 v201, v214, v200
    v_mfma_f32_16x16x32_bf16 v[196:199], v[176:179], v[188:191], v[196:199]
    ds_write_addtid_b32 v200 offset:8192
    v_mfma_f32_16x16x32_bf16 v[196:199], v[8:11], v[164:167], v[196:199]
    ds_write_addtid_b32 v201 offset:24576
    v_add_f32_dpp v212, v207, v206 wave_ror:1 row_mask:0xf bank_mask:0xf bound_ctrl:0
    v_mfma_f32_16x16x32_bf16 v[196:199], v[168:171], v[4:7], v[196:199]
    buffer_load_dwordx4 v[80:83], v239, s[40:43], 0 offen offset:3072 sc1
    v_mfma_f32_16x16x32_bf16 v[196:199], v[16:19], v[156:159], v[196:199]
    ds_read_b128 v[64:67], v241 offset:16336
    v_add_f32_dpp v206, v207, v206 wave_shr:1 row_mask:0xf bank_mask:0xf bound_ctrl:0
    v_mfma_f32_16x16x32_bf16 v[196:199], v[160:163], v[12:15], v[196:199]
    v_add_f32_dpp v213, v212, v205 wave_ror:1 row_mask:0xf bank_mask:0xf bound_ctrl:0
    v_add_f32_dpp v205, v206, v205 wave_shr:1 row_mask:0xf bank_mask:0xf bound_ctrl:0
    v_mfma_f32_16x16x32_bf16 v[196:199], v[24:27], v[148:151], v[196:199]
    v_add_f32_dpp v214, v213, v204 wave_ror:1 row_mask:0xf bank_mask:0xf bound_ctrl:0
    v_add_f32_dpp v204, v205, v204 wave_shr:1 row_mask:0xf bank_mask:0xf bound_ctrl:0
    v_mfma_f32_16x16x32_bf16 v[196:199], v[152:155], v[20:23], v[196:199]
    v_sub_f32 v205, v214, v204
    v_mfma_f32_16x16x32_bf16 v[196:199], v[32:35], v[140:143], v[196:199]
    buffer_load_dwordx4 v[84:87], v239, s[40:43], s73 offen offset:0 sc1
    v_mfma_f32_16x16x32_bf16 v[196:199], v[144:147], v[28:31], v[196:199]
    ds_write_addtid_b32 v204 offset:9728
    s_waitcnt lgkmcnt(14)
    v_mfma_f32_16x16x32_bf16 v[196:199], v[40:43], v[132:135], v[196:199]
    ds_write_addtid_b32 v205 offset:26112
    v_add_f32_dpp v212, v211, v210 wave_ror:1 row_mask:0xf bank_mask:0xf bound_ctrl:0
    v_mfma_f32_16x16x32_bf16 v[196:199], v[136:139], v[36:39], v[196:199]
    v_add_f32_dpp v210, v211, v210 wave_shr:1 row_mask:0xf bank_mask:0xf bound_ctrl:0
    v_add_f32_dpp v213, v212, v209 wave_ror:1 row_mask:0xf bank_mask:0xf bound_ctrl:0
    v_mfma_f32_16x16x32_bf16 v[200:203], v[8:11], v[188:191], 0
    v_add_f32_dpp v209, v210, v209 wave_shr:1 row_mask:0xf bank_mask:0xf bound_ctrl:0
    v_add_f32_dpp v214, v213, v208 wave_ror:1 row_mask:0xf bank_mask:0xf bound_ctrl:0
    v_mfma_f32_16x16x32_bf16 v[200:203], v[192:195], v[4:7], v[200:203]
    buffer_load_dwordx4 v[88:91], v239, s[40:43], s73 offen offset:1024 sc1
    v_mfma_f32_16x16x32_bf16 v[200:203], v[16:19], v[180:183], v[200:203]
    v_add_f32_dpp v208, v209, v208 wave_shr:1 row_mask:0xf bank_mask:0xf bound_ctrl:0
    v_sub_f32 v209, v214, v208
    v_mfma_f32_16x16x32_bf16 v[200:203], v[184:187], v[12:15], v[200:203]
    ds_write_addtid_b32 v208 offset:10240
    v_mfma_f32_16x16x32_bf16 v[200:203], v[24:27], v[172:175], v[200:203]
    ds_write_addtid_b32 v209 offset:26624
    v_add_f32_dpp v212, v219, v218 wave_ror:1 row_mask:0xf bank_mask:0xf bound_ctrl:0
    v_mfma_f32_16x16x32_bf16 v[200:203], v[176:179], v[20:23], v[200:203]
    v_add_f32_dpp v218, v219, v218 wave_shr:1 row_mask:0xf bank_mask:0xf bound_ctrl:0
    v_add_f32_dpp v213, v212, v217 wave_ror:1 row_mask:0xf bank_mask:0xf bound_ctrl:0
    v_mfma_f32_16x16x32_bf16 v[200:203], v[32:35], v[164:167], v[200:203]
    buffer_load_dwordx4 v[92:95], v239, s[40:43], s73 offen offset:2048 sc1
    v_mfma_f32_16x16x32_bf16 v[200:203], v[168:171], v[28:31], v[200:203]
    v_add_f32_dpp v217, v218, v217 wave_shr:1 row_mask:0xf bank_mask:0xf bound_ctrl:0
    v_add_f32_dpp v214, v213, v216 wave_ror:1 row_mask:0xf bank_mask:0xf bound_ctrl:0
    v_mfma_f32_16x16x32_bf16 v[200:203], v[40:43], v[156:159], v[200:203]
    v_add_f32_dpp v216, v217, v216 wave_shr:1 row_mask:0xf bank_mask:0xf bound_ctrl:0
    v_sub_f32 v217, v214, v216
    v_mfma_f32_16x16x32_bf16 v[200:203], v[160:163], v[36:39], v[200:203]
    ds_write_addtid_b32 v216 offset:11776
    s_waitcnt lgkmcnt(13)
    v_mfma_f32_16x16x32_bf16 v[200:203], v[48:51], v[148:151], v[200:203]
    buffer_load_dwordx4 v[96:99], v239, s[40:43], s73 offen offset:3072 sc1
    v_mfma_f32_16x16x32_bf16 v[200:203], v[152:155], v[44:47], v[200:203]
    ds_write_addtid_b32 v217 offset:28160
    v_add_f32_dpp v212, v223, v222 wave_ror:1 row_mask:0xf bank_mask:0xf bound_ctrl:0
    s_waitcnt lgkmcnt(11)
    v_mfma_f32_16x16x32_bf16 v[200:203], v[56:59], v[140:143], v[200:203]
    v_add_f32_dpp v222, v223, v222 wave_shr:1 row_mask:0xf bank_mask:0xf bound_ctrl:0
    v_add_f32_dpp v213, v212, v221 wave_ror:1 row_mask:0xf bank_mask:0xf bound_ctrl:0
    v_mfma_f32_16x16x32_bf16 v[200:203], v[144:147], v[52:55], v[200:203]
    v_add_f32_dpp v221, v222, v221 wave_shr:1 row_mask:0xf bank_mask:0xf bound_ctrl:0
    v_add_f32_dpp v214, v213, v220 wave_ror:1 row_mask:0xf bank_mask:0xf bound_ctrl:0
    s_waitcnt lgkmcnt(6)
    v_mfma_f32_16x16x32_bf16 v[200:203], v[64:67], v[132:135], v[200:203]
    v_add_f32_dpp v220, v221, v220 wave_shr:1 row_mask:0xf bank_mask:0xf bound_ctrl:0
    v_sub_f32 v221, v214, v220
    v_mfma_f32_16x16x32_bf16 v[200:203], v[136:139], v[60:63], v[200:203]
    ds_write_addtid_b32 v220 offset:12288
    ds_write_addtid_b32 v221 offset:28672
    v_add_f32_dpp v212, v227, v226 wave_ror:1 row_mask:0xf bank_mask:0xf bound_ctrl:0
    v_add_f32_dpp v226, v227, v226 wave_shr:1 row_mask:0xf bank_mask:0xf bound_ctrl:0
    s_nop 0
    v_add_f32_dpp v213, v212, v225 wave_ror:1 row_mask:0xf bank_mask:0xf bound_ctrl:0
    v_add_f32_dpp v225, v226, v225 wave_shr:1 row_mask:0xf bank_mask:0xf bound_ctrl:0
    s_nop 0
    v_add_f32_dpp v214, v213, v224 wave_ror:1 row_mask:0xf bank_mask:0xf bound_ctrl:0
    v_add_f32_dpp v224, v225, v224 wave_shr:1 row_mask:0xf bank_mask:0xf bound_ctrl:0
    v_sub_f32 v225, v214, v224
    ds_write_addtid_b32 v224 offset:13824
    ds_write_addtid_b32 v225 offset:30208
    v_add_f32_dpp v212, v199, v198 wave_ror:1 row_mask:0xf bank_mask:0xf bound_ctrl:0
    v_add_f32_dpp v198, v199, v198 wave_shr:1 row_mask:0xf bank_mask:0xf bound_ctrl:0
    s_nop 0
    v_add_f32_dpp v213, v212, v197 wave_ror:1 row_mask:0xf bank_mask:0xf bound_ctrl:0
    v_add_f32_dpp v197, v198, v197 wave_shr:1 row_mask:0xf bank_mask:0xf bound_ctrl:0
    s_nop 0
    v_add_f32_dpp v214, v213, v196 wave_ror:1 row_mask:0xf bank_mask:0xf bound_ctrl:0
    v_add_f32_dpp v196, v197, v196 wave_shr:1 row_mask:0xf bank_mask:0xf bound_ctrl:0
    v_sub_f32_e64 v197, v214, v196
    ds_write_addtid_b32 v196 offset:14336
    ds_write_addtid_b32 v197 offset:30720
    s_add_u32 m0, s69, 512
    s_branch L_cvEt
.p2align 12
L_cvBt:
L_padT0:
    s_cmp_lg_u32 s3, 0
    s_cbranch_scc1 L_wdone
    v_mfma_f32_16x16x32_bf16 v[196:199], v[16:19], v[4:7], 0
    ds_read_b64_tr_b16 v[68:69], v242 offset:2080
    s_add_u32 s5, s71, 131072
    v_mfma_f32_16x16x32_bf16 v[196:199], v[8:11], v[12:15], v[196:199]
    ds_read_b64_tr_b16 v[70:71], v242 offset:2048
    s_mul_i32 s6, s54, 3072
    v_mfma_f32_16x16x32_bf16 v[200:203], v[16:19], v[12:15], 0
    ds_read_b128 v[72:75], v241 offset:4096
    s_add_u32 s6, s6, 147456
    v_mfma_f32_16x16x32_bf16 v[200:203], v[24:27], v[4:7], v[200:203]
    buffer_load_dwordx4 a[164:167], v252, s[40:43], s67 offen offset:1024 sc1
    v_mfma_f32_16x16x32_bf16 v[200:203], v[8:11], v[20:23], v[200:203]
    ds_read_b64_tr_b16 v[76:77], v242 offset:2336
    v_mfma_f32_16x16x32_bf16 v[204:207], v[32:35], v[20:23], 0
    ds_read_b64_tr_b16 v[78:79], v242 offset:2304
    v_add_f32_dpp v212, v199, v198 wave_ror:1 row_mask:0xf bank_mask:0xf bound_ctrl:0
    v_mfma_f32_16x16x32_bf16 v[204:207], v[24:27], v[28:31], v[204:207]
    s_waitcnt vmcnt(3)
    s_bitcmp1_b32 s68, 30
    s_cbranch_scc1 L_nf7
    s_atomic_swap_x2 s[48:49], s[40:41], s68
L_nf7:
    v_mfma_f32_16x16x32_bf16 v[204:207], v[40:43], v[12:15], v[204:207]
    ds_read_b128 v[80:83], v241 offset:4608
    s_add_u32 s68, s68, 131072
    v_mfma_f32_16x16x32_bf16 v[204:207], v[16:19], v[36:39], v[204:207]
    buffer_load_dwordx4 a[168:171], v252, s[40:43], s67 offen offset:2048 sc1
    v_mfma_f32_16x16x32_bf16 v[204:207], v[48:51], v[4:7], v[204:207]
    ds_read_b64_tr_b16 v[84:85], v242 offset:2592
    v_add_f32_dpp v198, v199, v198 wave_shr:1 row_mask:0xf bank_mask:0xf bound_ctrl:0
    v_mfma_f32_16x16x32_bf16 v[204:207], v[8:11], v[44:47], v[204:207]
    ds_read_b64_tr_b16 v[86:87], v242 offset:2560
    v_add_f32_dpp v213, v212, v197 wave_ror:1 row_mask:0xf bank_mask:0xf bound_ctrl:0
    v_mfma_f32_16x16x32_bf16 v[208:211], v[32:35], v[28:31], 0
    buffer_load_dwordx4 a[172:175], v252, s[40:43], s67 offen offset:3072 sc1
    v_mfma_f32_16x16x32_bf16 v[208:211], v[40:43], v[20:23], v[208:211]
    ds_read_b128 v[88:91], v241 offset:5120
    s_add_u32 s67, s67, 4096
    v_mfma_f32_16x16x32_bf16 v[208:211], v[24:27], v[36:39], v[208:211]
    ds_read_b64_tr_b16 v[92:93], v242 offset:2848
    v_add_f32_dpp v197, v198, v197 wave_shr:1 row_mask:0xf bank_mask:0xf bound_ctrl:0
    v_mfma_f32_16x16x32_bf16 v[208:211], v[48:51], v[12:15], v[208:211]
    buffer_load_dwordx4 a[176:179], v252, s[40:43], s67 offen offset:0 sc1
    v_mfma_f32_16x16x32_bf16 v[208:211], v[16:19], v[44:47], v[208:211]
    ds_read_b64_tr_b16 v[94:95], v242 offset:2816
    v_add_f32_dpp v214, v213, v196 wave_ror:1 row_mask:0xf bank_mask:0xf bound_ctrl:0
    v_mfma_f32_16x16x32_bf16 v[208:211], v[56:59], v[4:7], v[208:211]
    ds_read_b128 v[96:99], v241 offset:5632
    v_add_f32_dpp v196, v197, v196 wave_shr:1 row_mask:0xf bank_mask:0xf bound_ctrl:0
    v_mfma_f32_16x16x32_bf16 v[208:211], v[8:11], v[52:55], v[208:211]
    ds_read_b64_tr_b16 v[100:101], v242 offset:3104
    v_sub_f32 v197, v214, v196
    v_mfma_f32_16x16x32_bf16 v[216:219], v[48:51], v[36:39], 0
    buffer_load_dwordx4 a[180:183], v252, s[40:43], s67 offen offset:1024 sc1
    v_mfma_f32_16x16x32_bf16 v[216:219], v[40:43], v[44:47], v[216:219]
    ds_write_addtid_b32 v196 offset:512
    v_mfma_f32_16x16x32_bf16 v[216:219], v[56:59], v[28:31], v[216:219]
    ds_write_addtid_b32 v197 offset:16896
    v_add_f32_dpp v212, v203, v202 wave_ror:1 row_mask:0xf bank_mask:0xf bound_ctrl:0
    v_mfma_f32_16x16x32_bf16 v[216:219], v[32:35], v[52:55], v[216:219]
    ds_read_b64_tr_b16 v[102:103], v242 offset:3072
    v_add_f32_dpp v202, v203, v202 wave_shr:1 row_mask:0xf bank_mask:0xf bound_ctrl:0
    v_mfma_f32_16x16x32_bf16 v[216:219], v[64:67], v[20:23], v[216:219]
    buffer_load_dwordx4 a[184:187], v252, s[40:43], s67 offen offset:2048 sc1
    v_mfma_f32_16x16x32_bf16 v[216:219], v[24:27], v[60:63], v[216:219]
    ds_read_b128 v[104:107], v241 offset:6144
    v_add_f32_dpp v213, v212, v201 wave_ror:1 row_mask:0xf bank_mask:0xf bound_ctrl:0
    s_waitcnt lgkmcnt(14)
    v_mfma_f32_16x16x32_bf16 v[216:219], v[72:75], v[12:15], v[216:219]
    ds_read_b64_tr_b16 v[108:109], v242 offset:3360
    v_add_f32_dpp v201, v202, v201 wave_shr:1 row_mask:0xf bank_mask:0xf bound_ctrl:0
    v_mfma_f32_16x16x32_bf16 v[216:219], v[16:19], v[68:71], v[216:219]
    ds_read_b64_tr_b16 v[110:111], v242 offset:3328
    v_add_f32_dpp v214, v213, v200 wave_ror:1 row_mask:0xf bank_mask:0xf bound_ctrl:0
    s_waitcnt lgkmcnt(13)
    v_mfma_f32_16x16x32_bf16 v[216:219], v[80:83], v[4:7], v[216:219]
    ds_read_b128 v[112:115], v241 offset:6656
    v_add_f32_dpp v200, v201, v200 wave_shr:1 row_mask:0xf bank_mask:0xf bound_ctrl:0
    v_mfma_f32_16x16x32_bf16 v[216:219], v[8:11], v[76:79], v[216:219]
    s_mov_b32 m0, s6
    s_nop 0
    buffer_load_dwordx4 v249, s[36:39], s79 offen offset:0 lds
    s_mov_b32 m0, s69
    v_mfma_f32_16x16x32_bf16 v[220:223], v[48:51], v[44:47], 0
    ds_read_b64_tr_b16 v[116:117], v242 offset:3616
    v_sub_f32 v201, v214, v200
    v_mfma_f32_16x16x32_bf16 v[220:223], v[56:59], v[36:39], v[220:223]
    ds_write_addtid_b32 v200 offset:1024
    v_mfma_f32_16x16x32_bf16 v[220:223], v[40:43], v[52:55], v[220:223]
    ds_write_addtid_b32 v201 offset:17408
    v_add_f32_dpp v212, v207, v206 wave_ror:1 row_mask:0xf bank_mask:0xf bound_ctrl:0
    v_mfma_f32_16x16x32_bf16 v[220:223], v[64:67], v[28:31], v[220:223]
    ds_read_b64_tr_b16 v[118:119], v242 offset:3584
    v_add_f32_dpp v206, v207, v206 wave_shr:1 row_mask:0xf bank_mask:0xf bound_ctrl:0
    v_mfma_f32_16x16x32_bf16 v[220:223], v[32:35], v[60:63], v[220:223]
    ds_read_b128 v[120:123], v241 offset:7168
    v_add_f32_dpp v213, v212, v205 wave_ror:1 row_mask:0xf bank_mask:0xf bound_ctrl:0
    v_mfma_f32_16x16x32_bf16 v[220:223], v[72:75], v[20:23], v[220:223]
    s_mov_b32 m0, s6
    s_nop 0
    buffer_load_dwordx4 v2, s[36:39], s79 offen offset:1024 lds
    s_mov_b32 m0, s69
    v_mfma_f32_16x16x32_bf16 v[220:223], v[24:27], v[68:71], v[220:223]
    ds_read_b64_tr_b16 v[132:133], v242 offset:4256
    v_add_f32_dpp v205, v206, v205 wave_shr:1 row_mask:0xf bank_mask:0xf bound_ctrl:0
    v_mfma_f32_16x16x32_bf16 v[220:223], v[80:83], v[12:15], v[220:223]
    ds_read_b64_tr_b16 v[134:135], v242 offset:4224
    v_add_f32_dpp v214, v213, v204 wave_ror:1 row_mask:0xf bank_mask:0xf bound_ctrl:0
    v_mfma_f32_16x16x32_bf16 v[220:223], v[16:19], v[76:79], v[220:223]
    ds_read_b128 v[136:139], v241 offset:8656
    v_add_f32_dpp v204, v205, v204 wave_shr:1 row_mask:0xf bank_mask:0xf bound_ctrl:0
    s_waitcnt lgkmcnt(15)
    v_mfma_f32_16x16x32_bf16 v[220:223], v[88:91], v[4:7], v[220:223]
    ds_read_b64_tr_b16 v[140:141], v242 offset:4512
    v_sub_f32 v205, v214, v204
    v_mfma_f32_16x16x32_bf16 v[220:223], v[8:11], v[84:87], v[220:223]
    ds_write_addtid_b32 v204 offset:2560
    v_mfma_f32_16x16x32_bf16 v[224:227], v[64:67], v[52:55], 0
    s_mov_b32 m0, s6
    s_nop 0
    buffer_load_dwordx4 v3, s[36:39], s79 offen offset:2048 lds
    s_mov_b32 m0, s69
    v_mfma_f32_16x16x32_bf16 v[224:227], v[56:59], v[60:63], v[224:227]
    ds_write_addtid_b32 v205 offset:18944
    v_add_f32_dpp v212, v211, v210 wave_ror:1 row_mask:0xf bank_mask:0xf bound_ctrl:0
    v_mfma_f32_16x16x32_bf16 v[224:227], v[72:75], v[44:47], v[224:227]
    ds_read_b64_tr_b16 v[142:143], v242 offset:4480
    v_add_f32_dpp v210, v211, v210 wave_shr:1 row_mask:0xf bank_mask:0xf bound_ctrl:0
    v_mfma_f32_16x16x32_bf16 v[224:227], v[48:51], v[68:71], v[224:227]
    ds_read_b128 v[144:147], v241 offset:9168
    v_add_f32_dpp v213, v212, v209 wave_ror:1 row_mask:0xf bank_mask:0xf bound_ctrl:0
    v_mfma_f32_16x16x32_bf16 v[224:227], v[80:83], v[36:39], v[224:227]
    ds_read_b64_tr_b16 v[148:149], v242 offset:4768
    v_add_f32_dpp v209, v210, v209 wave_shr:1 row_mask:0xf bank_mask:0xf bound_ctrl:0
    v_mfma_f32_16x16x32_bf16 v[224:227], v[40:43], v[76:79], v[224:227]
    ds_read_b64_tr_b16 v[150:151], v242 offset:4736
    v_add_f32_dpp v214, v213, v208 wave_ror:1 row_mask:0xf bank_mask:0xf bound_ctrl:0
    v_mfma_f32_16x16x32_bf16 v[224:227], v[88:91], v[28:31], v[224:227]
    ds_read_b128 v[152:155], v241 offset:9680
    v_add_f32_dpp v208, v209, v208 wave_shr:1 row_mask:0xf bank_mask:0xf bound_ctrl:0
    v_mfma_f32_16x16x32_bf16 v[224:227], v[32:35], v[84:87], v[224:227]
    buffer_load_dwordx4 a[188:191], v252, s[40:43], s67 offen offset:3072 sc1
    v_mfma_f32_16x16x32_bf16 v[224:227], v[96:99], v[20:23], v[224:227]
    ds_read_b64_tr_b16 v[156:157], v242 offset:5024
    s_add_u32 s67, s67, 4096
    v_mfma_f32_16x16x32_bf16 v[224:227], v[24:27], v[92:95], v[224:227]
    ds_read_b64_tr_b16 v[158:159], v242 offset:4992
    v_mov_b32 v232, 0
    s_waitcnt lgkmcnt(15)
    v_mfma_f32_16x16x32_bf16 v[224:227], v[104:107], v[12:15], v[224:227]
    ds_read_b128 v[160:163], v241 offset:10192
    v_mov_b32 v233, 0
    v_mfma_f32_16x16x32_bf16 v[224:227], v[16:19], v[100:103], v[224:227]
    s_mov_b32 exec_lo, 0x1010101
    s_mov_b32 exec_hi, 0x101
    buffer_atomic_or_x2 v[232:233], v238, s[40:43], s71 offen sc0
    s_mov_b64 exec, -1
    v_mfma_f32_16x16x32_bf16 v[224:227], v[112:115], v[4:7], v[224:227]
    buffer_load_dwordx4 a[192:195], v252, s[40:43], s67 offen offset:0 sc1
    v_mfma_f32_16x16x32_bf16 v[224:227], v[8:11], v[108:111], v[224:227]
    ds_read_b64_tr_b16 v[164:165], v242 offset:5280
    v_sub_f32 v209, v214, v208
    v_mfma_f32_16x16x32_bf16 v[196:199], v[64:67], v[60:63], 0
    ds_write_addtid_b32 v208 offset:3072
    v_mfma_f32_16x16x32_bf16 v[196:199], v[72:75], v[52:55], v[196:199]
    ds_write_addtid_b32 v209 offset:19456
    v_add_f32_dpp v212, v219, v218 wave_ror:1 row_mask:0xf bank_mask:0xf bound_ctrl:0
    v_mfma_f32_16x16x32_bf16 v[196:199], v[56:59], v[68:71], v[196:199]
    buffer_load_dwordx4 a[196:199], v252, s[40:43], s67 offen offset:1024 sc1
    v_mfma_f32_16x16x32_bf16 v[196:199], v[80:83], v[44:47], v[196:199]
    s_waitcnt vmcnt(13)
    s_bitcmp1_b32 s68, 30
    s_cbranch_scc1 L_nf6
    s_atomic_swap_x2 s[48:49], s[40:41], s68
L_nf6:
    v_mfma_f32_16x16x32_bf16 v[196:199], v[48:51], v[76:79], v[196:199]
    ds_read_b64_tr_b16 v[166:167], v242 offset:5248
    v_add_f32_dpp v218, v219, v218 wave_shr:1 row_mask:0xf bank_mask:0xf bound_ctrl:0
    v_mfma_f32_16x16x32_bf16 v[196:199], v[88:91], v[36:39], v[196:199]
    ds_read_b128 v[168:171], v241 offset:10704
    v_add_f32_dpp v213, v212, v217 wave_ror:1 row_mask:0xf bank_mask:0xf bound_ctrl:0
    v_mfma_f32_16x16x32_bf16 v[196:199], v[40:43], v[84:87], v[196:199]
    ds_read_b64_tr_b16 v[172:173], v242 offset:5536
    v_add_f32_dpp v217, v218, v217 wave_shr:1 row_mask:0xf bank_mask:0xf bound_ctrl:0
    v_mfma_f32_16x16x32_bf16 v[196:199], v[96:99], v[28:31], v[196:199]
    buffer_load_dwordx4 a[200:203], v252, s[40:43], s67 offen offset:2048 sc1
    v_mfma_f32_16x16x32_bf16 v[196:199], v[32:35], v[92:95], v[196:199]
    ds_read_b64_tr_b16 v[174:175], v242 offset:5504
    v_add_f32_dpp v214, v213, v216 wave_ror:1 row_mask:0xf bank_mask:0xf bound_ctrl:0
    v_mfma_f32_16x16x32_bf16 v[196:199], v[104:107], v[20:23], v[196:199]
    ds_read_b128 v[176:179], v241 offset:11216
    v_add_f32_dpp v216, v217, v216 wave_shr:1 row_mask:0xf bank_mask:0xf bound_ctrl:0
    v_mfma_f32_16x16x32_bf16 v[196:199], v[24:27], v[100:103], v[196:199]
    ds_read_b64_tr_b16 v[180:181], v242 offset:5792
    v_sub_f32 v217, v214, v216
    v_mfma_f32_16x16x32_bf16 v[196:199], v[112:115], v[12:15], v[196:199]
    buffer_load_dwordx4 a[204:207], v252, s[40:43], s67 offen offset:3072 sc1
    v_mfma_f32_16x16x32_bf16 v[196:199], v[16:19], v[108:111], v[196:199]
    ds_write_addtid_b32 v216 offset:4608
    s_add_u32 s67, s67, 4096
    s_waitcnt lgkmcnt(15)
    v_mfma_f32_16x16x32_bf16 v[196:199], v[120:123], v[4:7], v[196:199]
    ds_write_addtid_b32 v217 offset:20992
    v_add_f32_dpp v212, v223, v222 wave_ror:1 row_mask:0xf bank_mask:0xf bound_ctrl:0
    v_mfma_f32_16x16x32_bf16 v[196:199], v[8:11], v[116:119], v[196:199]
    ds_read_b64_tr_b16 v[182:183], v242 offset:5760
    v_add_f32_dpp v222, v223, v222 wave_shr:1 row_mask:0xf bank_mask:0xf bound_ctrl:0
    ds_read_b128 v[184:187], v241 offset:11728
    ds_read_b64_tr_b16 v[188:189], v242 offset:6048
    ds_read_b64_tr_b16 v[190:191], v242 offset:6016
    ds_read_b128 v[192:195], v241 offset:12240
    v_mfma_f32_16x16x32_bf16 v[200:203], v[144:147], v[132:135], 0
    buffer_load_dwordx4 a[208:211], v252, s[40:43], s67 offen offset:0 sc1
    v_mfma_f32_16x16x32_bf16 v[200:203], v[136:139], v[140:143], v[200:203]
    ds_read_b64_tr_b16 v[4:5], v242 offset:6304
    v_add_f32_dpp v213, v212, v221 wave_ror:1 row_mask:0xf bank_mask:0xf bound_ctrl:0
    s_waitcnt lgkmcnt(15)
    v_mfma_f32_16x16x32_bf16 v[204:207], v[144:147], v[140:143], 0
    ds_read_b64_tr_b16 v[6:7], v242 offset:6272
    v_add_f32_dpp v221, v222, v221 wave_shr:1 row_mask:0xf bank_mask:0xf bound_ctrl:0
    v_mfma_f32_16x16x32_bf16 v[204:207], v[152:155], v[132:135], v[204:207]
    ds_read_b128 v[8:11], v241 offset:12752
    v_add_f32_dpp v214, v213, v220 wave_ror:1 row_mask:0xf bank_mask:0xf bound_ctrl:0
    v_mfma_f32_16x16x32_bf16 v[204:207], v[136:139], v[148:151], v[204:207]
    ds_read_b64_tr_b16 v[12:13], v242 offset:6560
    v_add_f32_dpp v220, v221, v220 wave_shr:1 row_mask:0xf bank_mask:0xf bound_ctrl:0
    s_waitcnt lgkmcnt(12)
    v_mfma_f32_16x16x32_bf16 v[208:211], v[160:163], v[148:151], 0
    buffer_load_dwordx4 a[212:215], v252, s[40:43], s67 offen offset:1024 sc1
    v_mfma_f32_16x16x32_bf16 v[208:211], v[152:155], v[156:159], v[208:211]
    ds_read_b64_tr_b16 v[14:15], v242 offset:6528
    v_sub_f32 v221, v214, v220
    v_mfma_f32_16x16x32_bf16 v[208:211], v[168:171], v[140:143], v[208:211]
    ds_write_addtid_b32 v220 offset:5120
    v_mfma_f32_16x16x32_bf16 v[208:211], v[144:147], v[164:167], v[208:211]
    ds_write_addtid_b32 v221 offset:21504
    v_add_f32_dpp v212, v227, v226 wave_ror:1 row_mask:0xf bank_mask:0xf bound_ctrl:0
    v_mfma_f32_16x16x32_bf16 v[208:211], v[176:179], v[132:135], v[208:211]
    buffer_load_dwordx4 a[216:219], v252, s[40:43], s67 offen offset:2048 sc1
    v_mfma_f32_16x16x32_bf16 v[208:211], v[136:139], v[172:175], v[208:211]
    ds_read_b128 v[16:19], v241 offset:13264
    v_add_f32_dpp v226, v227, v226 wave_shr:1 row_mask:0xf bank_mask:0xf bound_ctrl:0
    s_waitcnt lgkmcnt(11)
    v_mfma_f32_16x16x32_bf16 v[216:219], v[160:163], v[156:159], 0
    ds_read_b64_tr_b16 v[20:21], v242 offset:6816
    v_add_f32_dpp v213, v212, v225 wave_ror:1 row_mask:0xf bank_mask:0xf bound_ctrl:0
    v_mfma_f32_16x16x32_bf16 v[216:219], v[168:171], v[148:151], v[216:219]
    ds_read_b64_tr_b16 v[22:23], v242 offset:6784
    v_add_f32_dpp v225, v226, v225 wave_shr:1 row_mask:0xf bank_mask:0xf bound_ctrl:0
    v_mfma_f32_16x16x32_bf16 v[216:219], v[152:155], v[164:167], v[216:219]
    ds_read_b128 v[24:27], v241 offset:13776
    v_add_f32_dpp v214, v213, v224 wave_ror:1 row_mask:0xf bank_mask:0xf bound_ctrl:0
    v_mfma_f32_16x16x32_bf16 v[216:219], v[176:179], v[140:143], v[216:219]
    buffer_load_dwordx4 a[220:223], v252, s[40:43], s67 offen offset:3072 sc1
    v_mfma_f32_16x16x32_bf16 v[216:219], v[144:147], v[172:175], v[216:219]
    ds_read_b64_tr_b16 v[28:29], v242 offset:7072
    s_add_u32 s67, s67, 4096
    v_mfma_f32_16x16x32_bf16 v[216:219], v[184:187], v[132:135], v[216:219]
    ds_read_b64_tr_b16 v[30:31], v242 offset:7040
    v_add_f32_dpp v224, v225, v224 wave_shr:1 row_mask:0xf bank_mask:0xf bound_ctrl:0
    v_mfma_f32_16x16x32_bf16 v[216:219], v[136:139], v[180:183], v[216:219]
    ds_read_b128 v[32:35], v241 offset:14288
    v_sub_f32 v225, v214, v224
    s_waitcnt lgkmcnt(14)
    v_mfma_f32_16x16x32_bf16 v[220:223], v[176:179], v[164:167], 0
    buffer_load_dwordx4 a[224:227], v252, s[40:43], s67 offen offset:0 sc1
    v_mfma_f32_16x16x32_bf16 v[220:223], v[168:171], v[172:175], v[220:223]
    ds_write_addtid_b32 v224 offset:6656
    v_mfma_f32_16x16x32_bf16 v[220:223], v[184:187], v[156:159], v[220:223]
    ds_write_addtid_b32 v225 offset:23040
    v_add_f32_dpp v212, v199, v198 wave_ror:1 row_mask:0xf bank_mask:0xf bound_ctrl:0
    v_mfma_f32_16x16x32_bf16 v[220:223], v[160:163], v[180:183], v[220:223]
    ds_read_b64_tr_b16 v[36:37], v242 offset:7328
    v_add_f32_dpp v198, v199, v198 wave_shr:1 row_mask:0xf bank_mask:0xf bound_ctrl:0
    v_mfma_f32_16x16x32_bf16 v[220:223], v[192:195], v[148:151], v[220:223]
    buffer_load_dwordx4 a[228:231], v252, s[40:43], s67 offen offset:1024 sc1
    v_mfma_f32_16x16x32_bf16 v[220:223], v[152:155], v[188:191], v[220:223]
    ds_read_b64_tr_b16 v[38:39], v242 offset:7296
    v_add_f32_dpp v213, v212, v197 wave_ror:1 row_mask:0xf bank_mask:0xf bound_ctrl:0
    s_waitcnt lgkmcnt(15)
    v_mfma_f32_16x16x32_bf16 v[220:223], v[8:11], v[140:143], v[220:223]
    ds_read_b128 v[40:43], v241 offset:14800
    v_add_f32_dpp v197, v198, v197 wave_shr:1 row_mask:0xf bank_mask:0xf bound_ctrl:0
    v_mfma_f32_16x16x32_bf16 v[220:223], v[144:147], v[4:7], v[220:223]
    s_cmp_eq_u32 s80, 0
    s_cbranch_scc1 L_ep1
L_epr1:
    s_waitcnt lgkmcnt(11)
    v_mfma_f32_16x16x32_bf16 v[220:223], v[16:19], v[132:135], v[220:223]
    buffer_load_dwordx4 a[232:235], v252, s[40:43], s67 offen offset:2048 sc1
    v_mfma_f32_16x16x32_bf16 v[220:223], v[136:139], v[12:15], v[220:223]
    ds_read_b64_tr_b16 v[44:45], v242 offset:7584
    v_add_f32_dpp v214, v213, v196 wave_ror:1 row_mask:0xf bank_mask:0xf bound_ctrl:0
    v_mfma_f32_16x16x32_bf16 v[224:227], v[176:179], v[172:175], 0
    s_waitcnt vmcnt(11)
    v_cmp_ne_u64 s[50:51], s[48:49], v[232:233]
    s_nop 0
    s_and_b32 s50, s50, 0x1010101
    s_and_b32 s51, s51, 0x101
    s_cmp_lg_u64 s[50:51], 0
    s_cbranch_scc1 L_slow_fh1
L_ok_fh1:
    v_mfma_f32_16x16x32_bf16 v[224:227], v[184:187], v[164:167], v[224:227]
    buffer_load_dwordx4 v[68:71], v239, s[40:43], 0 offen offset:0 sc1
    v_mfma_f32_16x16x32_bf16 v[224:227], v[168:171], v[180:183], v[224:227]
    ds_read_b64_tr_b16 v[46:47], v242 offset:7552
    v_add_f32_dpp v196, v197, v196 wave_shr:1 row_mask:0xf bank_mask:0xf bound_ctrl:0
    v_mfma_f32_16x16x32_bf16 v[224:227], v[192:195], v[156:159], v[224:227]
    ds_read_b128 v[48:51], v241 offset:15312
    v_sub_f32 v197, v214, v196
    v_mfma_f32_16x16x32_bf16 v[224:227], v[160:163], v[188:191], v[224:227]
    ds_write_addtid_b32 v196 offset:7168
    v_mfma_f32_16x16x32_bf16 v[224:227], v[8:11], v[148:151], v[224:227]
    buffer_load_dwordx4 v[72:75], v239, s[40:43], 0 offen offset:1024 sc1
    v_mfma_f32_16x16x32_bf16 v[224:227], v[152:155], v[4:7], v[224:227]
    ds_write_addtid_b32 v197 offset:23552
    v_add_f32_dpp v212, v203, v202 wave_ror:1 row_mask:0xf bank_mask:0xf bound_ctrl:0
    v_mfma_f32_16x16x32_bf16 v[224:227], v[16:19], v[140:143], v[224:227]
    ds_read_b64_tr_b16 v[52:53], v242 offset:7840
    v_add_f32_dpp v202, v203, v202 wave_shr:1 row_mask:0xf bank_mask:0xf bound_ctrl:0
    v_mfma_f32_16x16x32_bf16 v[224:227], v[144:147], v[12:15], v[224:227]
    ds_read_b64_tr_b16 v[54:55], v242 offset:7808
    v_add_f32_dpp v213, v212, v201 wave_ror:1 row_mask:0xf bank_mask:0xf bound_ctrl:0
    s_waitcnt lgkmcnt(15)
    v_mfma_f32_16x16x32_bf16 v[224:227], v[24:27], v[132:135], v[224:227]
    ds_read_b128 v[56:59], v241 offset:15824
    v_add_f32_dpp v201, v202, v201 wave_shr:1 row_mask:0xf bank_mask:0xf bound_ctrl:0
    v_mfma_f32_16x16x32_bf16 v[224:227], v[136:139], v[20:23], v[224:227]
    buffer_load_dwordx4 v[76:79], v239, s[40:43], 0 offen offset:2048 sc1
    v_mfma_f32_16x16x32_bf16 v[196:199], v[192:195], v[180:183], 0
    v_add_f32_dpp v214, v213, v200 wave_ror:1 row_mask:0xf bank_mask:0xf bound_ctrl:0
    v_add_f32_dpp v200, v201, v200 wave_shr:1 row_mask:0xf bank_mask:0xf bound_ctrl:0
    v_mfma_f32_16x16x32_bf16 v[196:199], v[184:187], v[188:191], v[196:199]
    v_sub_f32 v201, v214, v200
    v_mfma_f32_16x16x32_bf16 v[196:199], v[8:11], v[172:175], v[196:199]
    ds_write_addtid_b32 v200 offset:8704
    v_mfma_f32_16x16x32_bf16 v[196:199], v[176:179], v[4:7], v[196:199]
    ds_write_addtid_b32 v201 offset:25088
    v_add_f32_dpp v212, v207, v206 wave_ror:1 row_mask:0xf bank_mask:0xf bound_ctrl:0
    v_mfma_f32_16x16x32_bf16 v[196:199], v[16:19], v[164:167], v[196:199]
    buffer_load_dwordx4 v[80:83], v239, s[40:43], 0 offen offset:3072 sc1
    v_mfma_f32_16x16x32_bf16 v[196:199], v[168:171], v[12:15], v[196:199]
    v_add_f32_dpp v206, v207, v206 wave_shr:1 row_mask:0xf bank_mask:0xf bound_ctrl:0
    v_add_f32_dpp v213, v212, v205 wave_ror:1 row_mask:0xf bank_mask:0xf bound_ctrl:0
    v_mfma_f32_16x16x32_bf16 v[196:199], v[24:27], v[156:159], v[196:199]
    v_add_f32_dpp v205, v206, v205 wave_shr:1 row_mask:0xf bank_mask:0xf bound_ctrl:0
    v_add_f32_dpp v214, v213, v204 wave_ror:1 row_mask:0xf bank_mask:0xf bound_ctrl:0
    v_mfma_f32_16x16x32_bf16 v[196:199], v[160:163], v[20:23], v[196:199]
    v_add_f32_dpp v204, v205, v204 wave_shr:1 row_mask:0xf bank_mask:0xf bound_ctrl:0
    v_sub_f32 v205, v214, v204
    s_waitcnt lgkmcnt(15)
    v_mfma_f32_16x16x32_bf16 v[196:199], v[32:35], v[148:151], v[196:199]
    ds_write_addtid_b32 v204 offset:9216
    v_mfma_f32_16x16x32_bf16 v[196:199], v[152:155], v[28:31], v[196:199]
    buffer_load_dwordx4 v[84:87], v239, s[40:43], s73 offen offset:0 sc1
    s_waitcnt lgkmcnt(11)
    v_mfma_f32_16x16x32_bf16 v[196:199], v[40:43], v[140:143], v[196:199]
    ds_write_addtid_b32 v205 offset:25600
    v_add_f32_dpp v212, v211, v210 wave_ror:1 row_mask:0xf bank_mask:0xf bound_ctrl:0
    v_mfma_f32_16x16x32_bf16 v[196:199], v[144:147], v[36:39], v[196:199]
    v_add_f32_dpp v210, v211, v210 wave_shr:1 row_mask:0xf bank_mask:0xf bound_ctrl:0
    v_add_f32_dpp v213, v212, v209 wave_ror:1 row_mask:0xf bank_mask:0xf bound_ctrl:0
    s_waitcnt lgkmcnt(9)
    v_mfma_f32_16x16x32_bf16 v[196:199], v[48:51], v[132:135], v[196:199]
    v_add_f32_dpp v209, v210, v209 wave_shr:1 row_mask:0xf bank_mask:0xf bound_ctrl:0
    v_add_f32_dpp v214, v213, v208 wave_ror:1 row_mask:0xf bank_mask:0xf bound_ctrl:0
    v_mfma_f32_16x16x32_bf16 v[196:199], v[136:139], v[44:47], v[196:199]
    v_add_f32_dpp v208, v209, v208 wave_shr:1 row_mask:0xf bank_mask:0xf bound_ctrl:0
    v_sub_f32 v209, v214, v208
    v_mfma_f32_16x16x32_bf16 v[200:203], v[192:195], v[188:191], 0
    buffer_load_dwordx4 v[88:91], v239, s[40:43], s73 offen offset:1024 sc1
    v_mfma_f32_16x16x32_bf16 v[200:203], v[8:11], v[180:183], v[200:203]
    ds_write_addtid_b32 v208 offset:10752
    v_mfma_f32_16x16x32_bf16 v[200:203], v[184:187], v[4:7], v[200:203]
    ds_write_addtid_b32 v209 offset:27136
    v_add_f32_dpp v212, v219, v218 wave_ror:1 row_mask:0xf bank_mask:0xf bound_ctrl:0
    v_mfma_f32_16x16x32_bf16 v[200:203], v[16:19], v[172:175], v[200:203]
    v_add_f32_dpp v218, v219, v218 wave_shr:1 row_mask:0xf bank_mask:0xf bound_ctrl:0
    v_add_f32_dpp v213, v212, v217 wave_ror:1 row_mask:0xf bank_mask:0xf bound_ctrl:0
    v_mfma_f32_16x16x32_bf16 v[200:203], v[176:179], v[12:15], v[200:203]
    v_add_f32_dpp v217, v218, v217 wave_shr:1 row_mask:0xf bank_mask:0xf bound_ctrl:0
    v_add_f32_dpp v214, v213, v216 wave_ror:1 row_mask:0xf bank_mask:0xf bound_ctrl:0
    v_mfma_f32_16x16x32_bf16 v[200:203], v[24:27], v[164:167], v[200:203]
    buffer_load_dwordx4 v[92:95], v239, s[40:43], s73 offen offset:2048 sc1
    v_mfma_f32_16x16x32_bf16 v[200:203], v[168:171], v[20:23], v[200:203]
    v_add_f32_dpp v216, v217, v216 wave_shr:1 row_mask:0xf bank_mask:0xf bound_ctrl:0
    v_sub_f32 v217, v214, v216
    v_mfma_f32_16x16x32_bf16 v[200:203], v[32:35], v[156:159], v[200:203]
    ds_write_addtid_b32 v216 offset:11264
    v_mfma_f32_16x16x32_bf16 v[200:203], v[160:163], v[28:31], v[200:203]
    ds_write_addtid_b32 v217 offset:27648
    v_add_f32_dpp v212, v223, v222 wave_ror:1 row_mask:0xf bank_mask:0xf bound_ctrl:0
    v_mfma_f32_16x16x32_bf16 v[200:203], v[40:43], v[148:151], v[200:203]
    buffer_load_dwordx4 v[96:99], v239, s[40:43], s73 offen offset:3072 sc1
    v_mfma_f32_16x16x32_bf16 v[200:203], v[152:155], v[36:39], v[200:203]
    v_add_f32_dpp v222, v223, v222 wave_shr:1 row_mask:0xf bank_mask:0xf bound_ctrl:0
    v_add_f32_dpp v213, v212, v221 wave_ror:1 row_mask:0xf bank_mask:0xf bound_ctrl:0
    v_mfma_f32_16x16x32_bf16 v[200:203], v[48:51], v[140:143], v[200:203]
    v_add_f32_dpp v221, v222, v221 wave_shr:1 row_mask:0xf bank_mask:0xf bound_ctrl:0
    v_add_f32_dpp v214, v213, v220 wave_ror:1 row_mask:0xf bank_mask:0xf bound_ctrl:0
    v_mfma_f32_16x16x32_bf16 v[200:203], v[144:147], v[44:47], v[200:203]
    v_add_f32_dpp v220, v221, v220 wave_shr:1 row_mask:0xf bank_mask:0xf bound_ctrl:0
    v_sub_f32 v221, v214, v220
    s_waitcnt lgkmcnt(8)
    v_mfma_f32_16x16x32_bf16 v[200:203], v[56:59], v[132:135], v[200:203]
    ds_write_addtid_b32 v220 offset:12800
    v_mfma_f32_16x16x32_bf16 v[200:203], v[136:139], v[52:55], v[200:203]
    ds_write_addtid_b32 v221 offset:29184
    v_add_f32_dpp v212, v227, v226 wave_ror:1 row_mask:0xf bank_mask:0xf bound_ctrl:0
    v_add_f32_dpp v226, v227, v226 wave_shr:1 row_mask:0xf bank_mask:0xf bound_ctrl:0
    s_nop 0
    v_add_f32_dpp v213, v212, v225 wave_ror:1 row_mask:0xf bank_mask:0xf bound_ctrl:0
    v_add_f32_dpp v225, v226, v225 wave_shr:1 row_mask:0xf bank_mask:0xf bound_ctrl:0
    s_nop 0
    v_add_f32_dpp v214, v213, v224 wave_ror:1 row_mask:0xf bank_mask:0xf bound_ctrl:0
    v_add_f32_dpp v224, v225, v224 wave_shr:1 row_mask:0xf bank_mask:0xf bound_ctrl:0
    v_sub_f32 v225, v214, v224
    ds_write_addtid_b32 v224 offset:13312
    ds_write_addtid_b32 v225 offset:29696
    v_add_f32_dpp v212, v199, v198 wave_ror:1 row_mask:0xf bank_mask:0xf bound_ctrl:0
    v_add_f32_dpp v198, v199, v198 wave_shr:1 row_mask:0xf bank_mask:0xf bound_ctrl:0
    s_nop 0
    v_add_f32_dpp v213, v212, v197 wave_ror:1 row_mask:0xf bank_mask:0xf bound_ctrl:0
    v_add_f32_dpp v197, v198, v197 wave_shr:1 row_mask:0xf bank_mask:0xf bound_ctrl:0
    s_nop 0
    v_add_f32_dpp v214, v213, v196 wave_ror:1 row_mask:0xf bank_mask:0xf bound_ctrl:0
    v_add_f32_dpp v196, v197, v196 wave_shr:1 row_mask:0xf bank_mask:0xf bound_ctrl:0
    v_sub_f32 v197, v214, v196
    ds_write_addtid_b32 v196 offset:14848
    ds_write_addtid_b32 v197 offset:31232
L_cvEt:
    s_waitcnt vmcnt(7)
    v_mfma_f32_16x16x32_bf16 v[132:135], a[0:3], v[68:71], 0
    buffer_load_dwordx4 v[100:103], v239, s[40:43], s74 offen offset:0 sc1
    v_mfma_f32_16x16x32_bf16 v[136:139], a[4:7], v[68:71], 0
    s_lshl_b32 s10, s55, 5
    s_add_u32 s10, s10, s56
    v_mfma_f32_16x16x32_bf16 v[140:143], a[8:11], v[68:71], 0
    s_lshl_b32 s10, s10, 7
    s_add_u32 s10, s10, 786432
    v_mfma_f32_16x16x32_bf16 v[144:147], a[12:15], v[68:71], 0
    buffer_load_dwordx4 v[104:107], v239, s[40:43], s74 offen offset:1024 sc1
    v_mfma_f32_16x16x32_bf16 v[148:151], a[16:19], v[68:71], 0
    s_lshl_b32 s11, s54, 16
    s_waitcnt vmcnt(8)
    v_mfma_f32_16x16x32_bf16 v[132:135], a[20:23], v[72:75], v[132:135]
    s_add_u32 s10, s10, s11
    s_add_u32 s11, s10, 0x8000
    v_mfma_f32_16x16x32_bf16 v[136:139], a[24:27], v[72:75], v[136:139]
    v_mfma_f32_16x16x32_bf16 v[140:143], a[28:31], v[72:75], v[140:143]
    buffer_load_dwordx4 v[108:111], v239, s[40:43], s74 offen offset:2048 sc1
    v_mfma_f32_16x16x32_bf16 v[144:147], a[32:35], v[72:75], v[144:147]
    v_add_f32_dpp v212, v203, v202 wave_ror:1 row_mask:0xf bank_mask:0xf bound_ctrl:0
    v_add_f32_dpp v202, v203, v202 wave_shr:1 row_mask:0xf bank_mask:0xf bound_ctrl:0
    v_mfma_f32_16x16x32_bf16 v[148:151], a[36:39], v[72:75], v[148:151]
    v_add_f32_dpp v213, v212, v201 wave_ror:1 row_mask:0xf bank_mask:0xf bound_ctrl:0
    s_waitcnt vmcnt(8)
    v_mfma_f32_16x16x32_bf16 v[132:135], a[40:43], v[76:79], v[132:135]
    v_add_f32_dpp v201, v202, v201 wave_shr:1 row_mask:0xf bank_mask:0xf bound_ctrl:0
    v_add_f32_dpp v214, v213, v200 wave_ror:1 row_mask:0xf bank_mask:0xf bound_ctrl:0
    v_mfma_f32_16x16x32_bf16 v[136:139], a[44:47], v[76:79], v[136:139]
    v_add_f32_dpp v200, v201, v200 wave_shr:1 row_mask:0xf bank_mask:0xf bound_ctrl:0
    v_sub_f32 v201, v214, v200
    v_mfma_f32_16x16x32_bf16 v[140:143], a[48:51], v[76:79], v[140:143]
    buffer_load_dwordx4 v[112:115], v239, s[40:43], s74 offen offset:3072 sc1
    v_mfma_f32_16x16x32_bf16 v[144:147], a[52:55], v[76:79], v[144:147]
    ds_write_addtid_b32 v200 offset:15360
    v_mfma_f32_16x16x32_bf16 v[148:151], a[56:59], v[76:79], v[148:151]
    ds_write_addtid_b32 v201 offset:31744
    s_waitcnt vmcnt(8)
    v_mfma_f32_16x16x32_bf16 v[132:135], a[60:63], v[80:83], v[132:135]
    v_mov_b32 v232, 0
    v_mov_b32 v233, 0
    v_mfma_f32_16x16x32_bf16 v[136:139], a[64:67], v[80:83], v[136:139]
    s_mov_b32 exec_lo, 0x1010101
    s_mov_b32 exec_hi, 0x101
    buffer_atomic_or_x2 v[232:233], v238, s[40:43], s5 offen sc0
    s_mov_b64 exec, -1
    v_mfma_f32_16x16x32_bf16 v[140:143], a[68:71], v[80:83], v[140:143]
    buffer_load_dwordx4 a[236:239], v252, s[40:43], s67 offen offset:3072 sc1
    v_mfma_f32_16x16x32_bf16 v[144:147], a[72:75], v[80:83], v[144:147]
    s_waitcnt lgkmcnt(0)
    s_barrier
    v_mfma_f32_16x16x32_bf16 v[148:151], a[76:79], v[80:83], v[148:151]
    ds_read_b128 v[172:175], v235 offset:0
    s_waitcnt vmcnt(9)
    v_mfma_f32_16x16x32_bf16 v[132:135], a[80:83], v[84:87], v[132:135]
    ds_read_b128 v[188:191], v236 offset:0
    s_add_u32 s67, s67, 4096
    v_mfma_f32_16x16x32_bf16 v[136:139], a[84:87], v[84:87], v[136:139]
    ds_read_b128 v[176:179], v235 offset:16
    s_mul_i32 s61, s76, 49152
    v_mfma_f32_16x16x32_bf16 v[140:143], a[88:91], v[84:87], v[140:143]
    ds_read_b128 v[180:183], v235 offset:8192
    s_add_u32 s61, s61, s72
    v_mfma_f32_16x16x32_bf16 v[144:147], a[92:95], v[84:87], v[144:147]
    ds_read_b128 v[192:195], v236 offset:8192
    v_add_u32 v239, s61, v252
    v_mfma_f32_16x16x32_bf16 v[148:151], a[96:99], v[84:87], v[148:151]
    buffer_load_dwordx4 v[116:119], v239, s[40:43], 0 offen offset:0 sc1
    s_waitcnt vmcnt(9)
    v_mfma_f32_16x16x32_bf16 v[132:135], a[100:103], v[88:91], v[132:135]
    ds_read_b128 v[184:187], v235 offset:8208
    s_lshl_b32 s57, s63, 7
    v_mfma_f32_16x16x32_bf16 v[136:139], a[104:107], v[88:91], v[136:139]
    s_add_u32 s57, s57, 6291456
    s_mul_i32 s62, s54, 10
    v_mfma_f32_16x16x32_bf16 v[140:143], a[108:111], v[88:91], v[140:143]
    buffer_load_dwordx4 v[120:123], v239, s[40:43], 0 offen offset:1024 sc1
    v_mfma_f32_16x16x32_bf16 v[144:147], a[112:115], v[88:91], v[144:147]
    s_min_u32 s62, s62, 27
    v_lshrrev_b32 v228, 2, v255
    v_mfma_f32_16x16x32_bf16 v[148:151], a[116:119], v[88:91], v[148:151]
    v_add_u32 v228, s62, v228
    s_waitcnt vmcnt(9)
    v_mfma_f32_16x16x32_bf16 v[132:135], a[120:123], v[92:95], v[132:135]
    buffer_load_dwordx4 v[124:127], v239, s[40:43], 0 offen offset:2048 sc1
    v_mfma_f32_16x16x32_bf16 v[136:139], a[124:127], v[92:95], v[136:139]
    s_waitcnt lgkmcnt(3)
    v_add_f32 v172, v172, v188
    v_add_f32 v173, v173, v189
    v_mfma_f32_16x16x32_bf16 v[140:143], a[128:131], v[92:95], v[140:143]
    v_add_f32 v174, v174, v190
    v_cvt_pk_bf16_f32 v204, v172, v173
    v_mfma_f32_16x16x32_bf16 v[144:147], a[132:135], v[92:95], v[144:147]
    v_cvt_pk_bf16_f32 v205, v174, v175
    v_cvt_pk_bf16_f32 v206, v176, v177
    v_mfma_f32_16x16x32_bf16 v[148:151], a[136:139], v[92:95], v[148:151]
    buffer_load_dwordx4 v[128:131], v239, s[40:43], 0 offen offset:3072 sc1
    s_waitcnt vmcnt(10)
    v_mfma_f32_16x16x32_bf16 v[132:135], a[140:143], v[96:99], v[132:135]
    v_cvt_pk_bf16_f32 v207, v178, v179
    s_waitcnt lgkmcnt(0)
    v_add_f32 v180, v180, v192
    v_mfma_f32_16x16x32_bf16 v[136:139], a[144:147], v[96:99], v[136:139]
    v_add_f32 v181, v181, v193
    v_add_f32 v182, v182, v194
    v_mfma_f32_16x16x32_bf16 v[140:143], a[148:151], v[96:99], v[140:143]
    v_cvt_pk_bf16_f32 v208, v180, v181
    v_cvt_pk_bf16_f32 v209, v182, v183
    v_mfma_f32_16x16x32_bf16 v[144:147], a[152:155], v[96:99], v[144:147]
    buffer_load_dwordx4 v[4:7], v239, s[40:43], s73 offen offset:0 sc1
    v_mfma_f32_16x16x32_bf16 v[148:151], a[156:159], v[96:99], v[148:151]
    v_cvt_pk_bf16_f32 v210, v184, v185
    s_waitcnt vmcnt(10)
    v_mfma_f32_16x16x32_bf16 v[132:135], a[160:163], v[100:103], v[132:135]
    v_cvt_pk_bf16_f32 v211, v186, v187
    s_mul_i32 s62, s54, 5
    v_mfma_f32_16x16x32_bf16 v[136:139], a[164:167], v[100:103], v[136:139]
    buffer_store_dwordx4 v[204:207], v237, s[40:43], s57 offen offset:0 sc1
    v_mfma_f32_16x16x32_bf16 v[140:143], a[168:171], v[100:103], v[140:143]
    s_add_u32 s62, s62, 16
    s_mul_i32 s9, s54, 10
    v_mfma_f32_16x16x32_bf16 v[144:147], a[172:175], v[100:103], v[144:147]
    s_add_u32 s9, s9, 9
    s_min_u32 s62, s62, s9
    v_mfma_f32_16x16x32_bf16 v[148:151], a[176:179], v[100:103], v[148:151]
    buffer_store_dwordx4 v[208:211], v237, s[40:43], s57 offen offset:128 sc1
    s_waitcnt vmcnt(11)
    v_mfma_f32_16x16x32_bf16 v[132:135], a[180:183], v[104:107], v[132:135]
    v_min_u32 v228, s62, v228
    v_lshlrev_b32 v228, 7, v228
    v_mfma_f32_16x16x32_bf16 v[136:139], a[184:187], v[104:107], v[136:139]
    s_lshl_b32 s7, s55, 3
    s_add_u32 s7, s7, s66
    v_mfma_f32_16x16x32_bf16 v[140:143], a[188:191], v[104:107], v[140:143]
    buffer_load_dwordx4 v[8:11], v239, s[40:43], s73 offen offset:1024 sc1
    v_mfma_f32_16x16x32_bf16 v[144:147], a[192:195], v[104:107], v[144:147]
L_padT1:
    s_cmp_lg_u32 s3, 0
    s_cbranch_scc1 L_wdone
    s_lshl_b32 s7, s7, 12
    s_add_u32 s7, s7, 786432
    v_mfma_f32_16x16x32_bf16 v[148:151], a[196:199], v[104:107], v[148:151]
    s_mul_i32 s8, s65, 81920
    s_waitcnt vmcnt(11)
    v_mfma_f32_16x16x32_bf16 v[132:135], a[200:203], v[108:111], v[132:135]
    buffer_load_dwordx4 v[12:15], v239, s[40:43], s73 offen offset:2048 sc1
    v_mfma_f32_16x16x32_bf16 v[136:139], a[204:207], v[108:111], v[136:139]
    s_sub_u32 s58, s75, s78
    s_ashr_i32 s58, s58, 31
    v_mfma_f32_16x16x32_bf16 v[140:143], a[208:211], v[108:111], v[140:143]
    s_add_u32 s58, s58, s78
    s_mul_i32 s59, s75, 3
    v_mfma_f32_16x16x32_bf16 v[144:147], a[212:215], v[108:111], v[144:147]
    buffer_load_dwordx4 v[16:19], v239, s[40:43], s73 offen offset:3072 sc1
    v_mfma_f32_16x16x32_bf16 v[148:151], a[216:219], v[108:111], v[148:151]
    s_add_u32 s58, s58, s59
    s_waitcnt vmcnt(12)
    v_mfma_f32_16x16x32_bf16 v[132:135], a[220:223], v[112:115], v[132:135]
    s_mul_i32 s58, s58, 5120
    s_add_u32 s58, s58, 32768
    v_mfma_f32_16x16x32_bf16 v[136:139], a[224:227], v[112:115], v[136:139]
    buffer_load_dwordx4 v[20:23], v239, s[40:43], s74 offen offset:0 sc1
    v_mfma_f32_16x16x32_bf16 v[140:143], a[228:231], v[112:115], v[140:143]
    v_add_u32 v234, s58, v252
    s_mul_i32 s62, s66, 10240
    v_mfma_f32_16x16x32_bf16 v[144:147], a[232:235], v[112:115], v[144:147]
    s_add_u32 s8, s8, s62
    s_mul_i32 s9, s54, 2560
    s_waitcnt vmcnt(11)
    v_mfma_f32_16x16x32_bf16 v[148:151], a[236:239], v[112:115], v[148:151]
    s_add_u32 s8, s8, s9
    s_waitcnt vmcnt(10)
    v_mfma_f32_16x16x32_bf16 v[152:155], a[0:3], v[116:119], 0
    buffer_load_dwordx4 v[24:27], v239, s[40:43], s74 offen offset:1024 sc1
    v_mfma_f32_16x16x32_bf16 v[156:159], a[4:7], v[116:119], 0
    s_add_u32 s8, s8, 6291456
    v_lshrrev_b32 v244, 2, v255
    v_mfma_f32_16x16x32_bf16 v[160:163], a[8:11], v[116:119], 0
    v_lshlrev_b32 v244, 7, v244
    v_and_b32 v245, 3, v255
    v_mfma_f32_16x16x32_bf16 v[164:167], a[12:15], v[116:119], 0
    ds_write_b64 v234, v[132:133] offset:0
    v_mfma_f32_16x16x32_bf16 v[168:171], a[16:19], v[116:119], 0
    v_lshl_add_u32 v244, v245, 3, v244
    s_waitcnt vmcnt(10)
    v_mfma_f32_16x16x32_bf16 v[152:155], a[20:23], v[120:123], v[152:155]
    buffer_load_dwordx4 v[28:31], v239, s[40:43], s74 offen offset:2048 sc1
    v_mfma_f32_16x16x32_bf16 v[156:159], a[24:27], v[120:123], v[156:159]
    ds_write_b64 v234, v[134:135] offset:8
    v_mfma_f32_16x16x32_bf16 v[160:163], a[28:31], v[120:123], v[160:163]
    s_lshl_b32 s62, s78, 5
    s_add_u32 s62, s62, 94208
    v_mfma_f32_16x16x32_bf16 v[164:167], a[32:35], v[120:123], v[164:167]
    v_add_u32 v225, s62, v244
    s_mul_i32 s62, s54, 3072
    v_mfma_f32_16x16x32_bf16 v[168:171], a[36:39], v[120:123], v[168:171]
    ds_write_b64 v234, v[136:137] offset:1024
    s_waitcnt vmcnt(10)
    v_mfma_f32_16x16x32_bf16 v[152:155], a[40:43], v[124:127], v[152:155]
    buffer_load_dwordx4 v[32:35], v239, s[40:43], s74 offen offset:3072 sc1
    v_mfma_f32_16x16x32_bf16 v[156:159], a[44:47], v[124:127], v[156:159]
    v_cmp_ne_u64 s[50:51], s[48:49], v[232:233]
    s_nop 0
    s_and_b32 s50, s50, 0x1010101
    s_and_b32 s51, s51, 0x101
    s_cmp_lg_u64 s[50:51], 0
    s_cbranch_scc1 L_slow_f3
L_ok_f3:
    v_mfma_f32_16x16x32_bf16 v[160:163], a[48:51], v[124:127], v[160:163]
    ds_write_b64 v234, v[138:139] offset:1032
    v_mfma_f32_16x16x32_bf16 v[164:167], a[52:55], v[124:127], v[164:167]
    s_mul_i32 s61, s77, 49152
    s_add_u32 s61, s61, s72
    v_mfma_f32_16x16x32_bf16 v[168:171], a[56:59], v[124:127], v[168:171]
    v_add_u32 v239, s61, v252
    s_waitcnt vmcnt(10)
    v_mfma_f32_16x16x32_bf16 v[152:155], a[60:63], v[128:131], v[152:155]
    ds_write_b64 v234, v[140:141] offset:2048
    v_mfma_f32_16x16x32_bf16 v[156:159], a[64:67], v[128:131], v[156:159]
    buffer_load_dwordx4 v[36:39], v239, s[40:43], 0 offen offset:0 sc1
    v_mfma_f32_16x16x32_bf16 v[160:163], a[68:71], v[128:131], v[160:163]
    s_add_u32 s62, s62, 147456
    v_mul_u32_u24 v244, 160, v254
    v_mfma_f32_16x16x32_bf16 v[164:167], a[72:75], v[128:131], v[164:167]
    ds_write_b64 v234, v[142:143] offset:2056
    v_mfma_f32_16x16x32_bf16 v[168:171], a[76:79], v[128:131], v[168:171]
    buffer_load_dwordx4 v[40:43], v239, s[40:43], 0 offen offset:1024 sc1
    s_waitcnt vmcnt(11)
    v_mfma_f32_16x16x32_bf16 v[152:155], a[80:83], v[4:7], v[152:155]
    v_lshl_add_u32 v244, v253, 3, v244
    v_add_u32 v224, s62, v244
    v_mfma_f32_16x16x32_bf16 v[156:159], a[84:87], v[4:7], v[156:159]
    ds_write_b64 v234, v[144:145] offset:3072
    v_mfma_f32_16x16x32_bf16 v[160:163], a[88:91], v[4:7], v[160:163]
    buffer_load_dwordx4 v[44:47], v239, s[40:43], 0 offen offset:2048 sc1
    v_mfma_f32_16x16x32_bf16 v[164:167], a[92:95], v[4:7], v[164:167]
    v_add_u32 v223, s62, v252
    s_mul_i32 s62, s78, 15360
    v_mfma_f32_16x16x32_bf16 v[168:171], a[96:99], v[4:7], v[168:171]
    ds_write_b64 v234, v[146:147] offset:3080
    s_waitcnt vmcnt(9)
    v_mfma_f32_16x16x32_bf16 v[152:155], a[100:103], v[8:11], v[152:155]
    s_add_u32 s62, s62, 32768
    v_add_u32 v229, s62, v252
    v_mfma_f32_16x16x32_bf16 v[156:159], a[104:107], v[8:11], v[156:159]
    v_mfma_f32_16x16x32_bf16 v[160:163], a[108:111], v[8:11], v[160:163]
    ds_write_b64 v234, v[148:149] offset:4096
    v_mfma_f32_16x16x32_bf16 v[164:167], a[112:115], v[8:11], v[164:167]
    buffer_load_dwordx4 v[48:51], v239, s[40:43], 0 offen offset:3072 sc1
    v_mfma_f32_16x16x32_bf16 v[168:171], a[116:119], v[8:11], v[168:171]
    s_waitcnt vmcnt(9)
    v_mfma_f32_16x16x32_bf16 v[152:155], a[120:123], v[12:15], v[152:155]
    s_barrier
    s_atomic_swap_x2 s[48:49], s[40:41], s10
    s_atomic_swap_x2 s[48:49], s[40:41], s11
    v_mfma_f32_16x16x32_bf16 v[156:159], a[124:127], v[12:15], v[156:159]
    ds_write_b64 v234, v[150:151] offset:4104
    v_mfma_f32_16x16x32_bf16 v[160:163], a[128:131], v[12:15], v[160:163]
    buffer_load_dwordx4 v[52:55], v239, s[40:43], s73 offen offset:0 sc1
    v_mfma_f32_16x16x32_bf16 v[164:167], a[132:135], v[12:15], v[164:167]
    ds_read_b64 v[196:197], v224 offset:0
    v_mfma_f32_16x16x32_bf16 v[168:171], a[136:139], v[12:15], v[168:171]
    ds_read_b64 v[198:199], v224 offset:32
    s_waitcnt vmcnt(9)
    v_mfma_f32_16x16x32_bf16 v[152:155], a[140:143], v[16:19], v[152:155]
    buffer_load_dwordx4 v[56:59], v239, s[40:43], s73 offen offset:1024 sc1
    v_mfma_f32_16x16x32_bf16 v[156:159], a[144:147], v[16:19], v[156:159]
    ds_read_b64 v[200:201], v224 offset:64
    v_mfma_f32_16x16x32_bf16 v[160:163], a[148:151], v[16:19], v[160:163]
    ds_read_b64 v[202:203], v224 offset:96
    v_mfma_f32_16x16x32_bf16 v[164:167], a[152:155], v[16:19], v[164:167]
    ds_read_b64 v[204:205], v224 offset:128
    v_mfma_f32_16x16x32_bf16 v[168:171], a[156:159], v[16:19], v[168:171]
    s_waitcnt vmcnt(9)
    v_mfma_f32_16x16x32_bf16 v[152:155], a[160:163], v[20:23], v[152:155]
    buffer_load_dwordx4 v[60:63], v239, s[40:43], s73 offen offset:2048 sc1
    v_mfma_f32_16x16x32_bf16 v[156:159], a[164:167], v[20:23], v[156:159]
    v_mfma_f32_16x16x32_bf16 v[160:163], a[168:171], v[20:23], v[160:163]
    v_mfma_f32_16x16x32_bf16 v[164:167], a[172:175], v[20:23], v[164:167]
    v_mfma_f32_16x16x32_bf16 v[168:171], a[176:179], v[20:23], v[168:171]
    buffer_load_dwordx4 v[64:67], v239, s[40:43], s73 offen offset:3072 sc1
    s_waitcnt vmcnt(10)
    v_mfma_f32_16x16x32_bf16 v[152:155], a[180:183], v[24:27], v[152:155]
    v_mfma_f32_16x16x32_bf16 v[156:159], a[184:187], v[24:27], v[156:159]
    v_mfma_f32_16x16x32_bf16 v[160:163], a[188:191], v[24:27], v[160:163]
    v_mfma_f32_16x16x32_bf16 v[164:167], a[192:195], v[24:27], v[164:167]
    v_mfma_f32_16x16x32_bf16 v[168:171], a[196:199], v[24:27], v[168:171]
    buffer_load_dwordx4 v[68:71], v239, s[40:43], s74 offen offset:0 sc1
    s_waitcnt vmcnt(10)
    v_mfma_f32_16x16x32_bf16 v[152:155], a[200:203], v[28:31], v[152:155]
    s_sub_u32 s58, s76, s78
    s_ashr_i32 s58, s58, 31
    v_mfma_f32_16x16x32_bf16 v[156:159], a[204:207], v[28:31], v[156:159]
    s_add_u32 s58, s58, s78
    s_mul_i32 s59, s76, 3
    v_mfma_f32_16x16x32_bf16 v[160:163], a[208:211], v[28:31], v[160:163]
    s_add_u32 s58, s58, s59
    s_mul_i32 s58, s58, 5120
    v_mfma_f32_16x16x32_bf16 v[164:167], a[212:215], v[28:31], v[164:167]
    buffer_load_dwordx4 v[72:75], v239, s[40:43], s74 offen offset:1024 sc1
    v_mfma_f32_16x16x32_bf16 v[168:171], a[216:219], v[28:31], v[168:171]
    s_add_u32 s58, s58, 32768
    s_waitcnt vmcnt(10)
    v_mfma_f32_16x16x32_bf16 v[152:155], a[220:223], v[32:35], v[152:155]
    v_add_u32 v234, s58, v252
    s_waitcnt lgkmcnt(4)
    v_lshlrev_b32 v4, 16, v196
    v_mfma_f32_16x16x32_bf16 v[156:159], a[224:227], v[32:35], v[156:159]
    v_and_b32 v5, 0xffff0000, v196
    v_lshlrev_b32 v6, 16, v197
    v_mfma_f32_16x16x32_bf16 v[160:163], a[228:231], v[32:35], v[160:163]
    buffer_load_dwordx4 v[76:79], v239, s[40:43], s74 offen offset:2048 sc1
    v_mfma_f32_16x16x32_bf16 v[164:167], a[232:235], v[32:35], v[164:167]
    v_and_b32 v7, 0xffff0000, v197
    s_waitcnt lgkmcnt(3)
    v_lshlrev_b32 v8, 16, v198
    v_mfma_f32_16x16x32_bf16 v[168:171], a[236:239], v[32:35], v[168:171]
    v_and_b32 v9, 0xffff0000, v198
    s_waitcnt vmcnt(10)
    v_mfma_f32_16x16x32_bf16 v[132:135], a[0:3], v[36:39], 0
    v_lshlrev_b32 v10, 16, v199
    v_and_b32 v11, 0xffff0000, v199
    v_mfma_f32_16x16x32_bf16 v[136:139], a[4:7], v[36:39], 0
    s_waitcnt lgkmcnt(2)
    v_lshlrev_b32 v12, 16, v200
    v_and_b32 v13, 0xffff0000, v200
    v_mfma_f32_16x16x32_bf16 v[140:143], a[8:11], v[36:39], 0
    buffer_load_dwordx4 v[80:83], v239, s[40:43], s74 offen offset:3072 sc1
    v_mfma_f32_16x16x32_bf16 v[144:147], a[12:15], v[36:39], 0
    ds_write_b64 v234, v[152:153] offset:0
    v_mfma_f32_16x16x32_bf16 v[148:151], a[16:19], v[36:39], 0
    v_lshlrev_b32 v14, 16, v201
    s_waitcnt vmcnt(10)
    v_mfma_f32_16x16x32_bf16 v[132:135], a[20:23], v[40:43], v[132:135]
    v_and_b32 v15, 0xffff0000, v201
    s_waitcnt lgkmcnt(2)
    v_lshlrev_b32 v16, 16, v202
    v_mfma_f32_16x16x32_bf16 v[136:139], a[24:27], v[40:43], v[136:139]
    ds_write_b64 v234, v[154:155] offset:8
    v_mfma_f32_16x16x32_bf16 v[140:143], a[28:31], v[40:43], v[140:143]
    s_mul_i32 s61, s78, 49152
    s_add_u32 s61, s61, s72
    v_mfma_f32_16x16x32_bf16 v[144:147], a[32:35], v[40:43], v[144:147]
    v_add_u32 v239, s61, v252
    v_and_b32 v17, 0xffff0000, v202
    v_mfma_f32_16x16x32_bf16 v[148:151], a[36:39], v[40:43], v[148:151]
    ds_write_b64 v234, v[156:157] offset:1024
    s_waitcnt vmcnt(9)
    v_mfma_f32_16x16x32_bf16 v[132:135], a[40:43], v[44:47], v[132:135]
    buffer_load_dwordx4 v[84:87], v239, s[40:43], 0 offen offset:0 sc1
    v_mfma_f32_16x16x32_bf16 v[136:139], a[44:47], v[44:47], v[136:139]
    v_lshlrev_b32 v18, 16, v203
    v_and_b32 v19, 0xffff0000, v203
    v_mfma_f32_16x16x32_bf16 v[140:143], a[48:51], v[44:47], v[140:143]
    ds_write_b64 v234, v[158:159] offset:1032
    v_mfma_f32_16x16x32_bf16 v[144:147], a[52:55], v[44:47], v[144:147]
    buffer_load_dwordx4 v[88:91], v239, s[40:43], 0 offen offset:1024 sc1
    v_mfma_f32_16x16x32_bf16 v[148:151], a[56:59], v[44:47], v[148:151]
    s_waitcnt lgkmcnt(4)
    v_lshlrev_b32 v20, 16, v204
    s_waitcnt vmcnt(10)
    v_mfma_f32_16x16x32_bf16 v[132:135], a[60:63], v[48:51], v[132:135]
    ds_write_b64 v234, v[160:161] offset:2048
    v_mfma_f32_16x16x32_bf16 v[136:139], a[64:67], v[48:51], v[136:139]
    buffer_load_dwordx4 v[92:95], v239, s[40:43], 0 offen offset:2048 sc1
    v_mfma_f32_16x16x32_bf16 v[140:143], a[68:71], v[48:51], v[140:143]
    v_and_b32 v21, 0xffff0000, v204
    v_lshlrev_b32 v22, 16, v205
    v_mfma_f32_16x16x32_bf16 v[144:147], a[72:75], v[48:51], v[144:147]
    ds_write_b64 v234, v[162:163] offset:2056
    v_mfma_f32_16x16x32_bf16 v[148:151], a[76:79], v[48:51], v[148:151]
    buffer_load_dwordx4 v[96:99], v239, s[40:43], 0 offen offset:3072 sc1
    s_waitcnt vmcnt(11)
    v_mfma_f32_16x16x32_bf16 v[132:135], a[80:83], v[52:55], v[132:135]
    v_and_b32 v23, 0xffff0000, v205
    v_mov_b32 v24, 0xbfb8aa3b
    v_mfma_f32_16x16x32_bf16 v[136:139], a[84:87], v[52:55], v[136:139]
    ds_write_b64 v234, v[164:165] offset:3072
    v_mfma_f32_16x16x32_bf16 v[140:143], a[88:91], v[52:55], v[140:143]
    v_mfma_f32_16x16x32_bf16 v[144:147], a[92:95], v[52:55], v[144:147]
    v_mfma_f32_16x16x32_bf16 v[148:151], a[96:99], v[52:55], v[148:151]
    ds_write_b64 v234, v[166:167] offset:3080
    s_waitcnt vmcnt(10)
    v_mfma_f32_16x16x32_bf16 v[132:135], a[100:103], v[56:59], v[132:135]
    buffer_load_dwordx4 v[100:103], v239, s[40:43], s73 offen offset:0 sc1
    v_mfma_f32_16x16x32_bf16 v[136:139], a[104:107], v[56:59], v[136:139]
    v_mfma_f32_16x16x32_bf16 v[140:143], a[108:111], v[56:59], v[140:143]
    ds_write_b64 v234, v[168:169] offset:4096
    v_mfma_f32_16x16x32_bf16 v[144:147], a[112:115], v[56:59], v[144:147]
    buffer_load_dwordx4 v[104:107], v239, s[40:43], s73 offen offset:1024 sc1
    v_mfma_f32_16x16x32_bf16 v[148:151], a[116:119], v[56:59], v[148:151]
    s_waitcnt vmcnt(11)
    v_mfma_f32_16x16x32_bf16 v[132:135], a[120:123], v[60:63], v[132:135]
    ds_write_b64 v234, v[170:171] offset:4104
    v_mfma_f32_16x16x32_bf16 v[136:139], a[124:127], v[60:63], v[136:139]
    v_mfma_f32_16x16x32_bf16 v[140:143], a[128:131], v[60:63], v[140:143]
    v_mfma_f32_16x16x32_bf16 v[144:147], a[132:135], v[60:63], v[144:147]
    buffer_load_dwordx4 v[108:111], v239, s[40:43], s73 offen offset:2048 sc1
    v_mfma_f32_16x16x32_bf16 v[148:151], a[136:139], v[60:63], v[148:151]
    s_waitcnt vmcnt(11)
    v_mfma_f32_16x16x32_bf16 v[132:135], a[140:143], v[64:67], v[132:135]
    v_mfma_f32_16x16x32_bf16 v[136:139], a[144:147], v[64:67], v[136:139]
    v_mfma_f32_16x16x32_bf16 v[140:143], a[148:151], v[64:67], v[140:143]
    buffer_load_dwordx4 v[112:115], v239, s[40:43], s73 offen offset:3072 sc1
    v_mfma_f32_16x16x32_bf16 v[144:147], a[152:155], v[64:67], v[144:147]
    v_mfma_f32_16x16x32_bf16 v[148:151], a[156:159], v[64:67], v[148:151]
    s_waitcnt vmcnt(11)
    v_mfma_f32_16x16x32_bf16 v[132:135], a[160:163], v[68:71], v[132:135]
    v_mfma_f32_16x16x32_bf16 v[136:139], a[164:167], v[68:71], v[136:139]
    buffer_load_dwordx4 v[116:119], v239, s[40:43], s74 offen offset:0 sc1
    v_mfma_f32_16x16x32_bf16 v[140:143], a[168:171], v[68:71], v[140:143]
    v_mfma_f32_16x16x32_bf16 v[144:147], a[172:175], v[68:71], v[144:147]
    v_mfma_f32_16x16x32_bf16 v[148:151], a[176:179], v[68:71], v[148:151]
    s_waitcnt vmcnt(11)
    v_mfma_f32_16x16x32_bf16 v[132:135], a[180:183], v[72:75], v[132:135]
    v_mfma_f32_16x16x32_bf16 v[136:139], a[184:187], v[72:75], v[136:139]
    buffer_load_dwordx4 v[120:123], v239, s[40:43], s74 offen offset:1024 sc1
    v_mfma_f32_16x16x32_bf16 v[140:143], a[188:191], v[72:75], v[140:143]
    v_mfma_f32_16x16x32_bf16 v[144:147], a[192:195], v[72:75], v[144:147]
    v_mfma_f32_16x16x32_bf16 v[148:151], a[196:199], v[72:75], v[148:151]
    s_waitcnt vmcnt(11)
    v_mfma_f32_16x16x32_bf16 v[132:135], a[200:203], v[76:79], v[132:135]
    buffer_load_dwordx4 v[124:127], v239, s[40:43], s74 offen offset:2048 sc1
    v_mfma_f32_16x16x32_bf16 v[136:139], a[204:207], v[76:79], v[136:139]
    s_sub_u32 s58, s77, s78
    s_ashr_i32 s58, s58, 31
    v_mfma_f32_16x16x32_bf16 v[140:143], a[208:211], v[76:79], v[140:143]
    s_add_u32 s58, s58, s78
    s_mul_i32 s59, s77, 3
    v_mfma_f32_16x16x32_bf16 v[144:147], a[212:215], v[76:79], v[144:147]
    s_add_u32 s58, s58, s59
    s_mul_i32 s58, s58, 5120
    v_mfma_f32_16x16x32_bf16 v[148:151], a[216:219], v[76:79], v[148:151]
    buffer_load_dwordx4 v[128:131], v239, s[40:43], s74 offen offset:3072 sc1
    s_waitcnt vmcnt(12)
    v_mfma_f32_16x16x32_bf16 v[132:135], a[220:223], v[80:83], v[132:135]
    v_mov_b32 v226, 0
    v_mov_b32 v227, 0
    v_mfma_f32_16x16x32_bf16 v[136:139], a[224:227], v[80:83], v[136:139]
    s_mov_b32 exec_lo, 0x11111111
    s_mov_b32 exec_hi, 0x11
    buffer_atomic_or_x2 v[226:227], v228, s[40:43], s7 offen sc0
    s_mov_b64 exec, -1
    v_mfma_f32_16x16x32_bf16 v[140:143], a[228:231], v[80:83], v[140:143]
    s_add_u32 m0, s9, 94208
    s_add_u32 s58, s58, 32768
    v_mfma_f32_16x16x32_bf16 v[144:147], a[232:235], v[80:83], v[144:147]
    v_add_u32 v234, s58, v252
    v_mfma_f32_16x16x32_bf16 v[148:151], a[236:239], v[80:83], v[148:151]
    s_waitcnt vmcnt(12)
    v_mfma_f32_16x16x32_bf16 v[152:155], a[0:3], v[84:87], 0
    v_mfma_f32_16x16x32_bf16 v[156:159], a[4:7], v[84:87], 0
    v_mfma_f32_16x16x32_bf16 v[160:163], a[8:11], v[84:87], 0
    v_mfma_f32_16x16x32_bf16 v[164:167], a[12:15], v[84:87], 0
    ds_write_b64 v234, v[132:133] offset:0
    v_mfma_f32_16x16x32_bf16 v[168:171], a[16:19], v[84:87], 0
    ds_write_b64 v234, v[134:135] offset:8
    s_waitcnt vmcnt(11)
    v_mfma_f32_16x16x32_bf16 v[152:155], a[20:23], v[88:91], v[152:155]
    ds_write_b64 v234, v[136:137] offset:1024
    v_mfma_f32_16x16x32_bf16 v[156:159], a[24:27], v[88:91], v[156:159]
    ds_write_b64 v234, v[138:139] offset:1032
    v_mfma_f32_16x16x32_bf16 v[160:163], a[28:31], v[88:91], v[160:163]
    ds_write_b64 v234, v[140:141] offset:2048
    v_mfma_f32_16x16x32_bf16 v[164:167], a[32:35], v[88:91], v[164:167]
    ds_write_b64 v234, v[142:143] offset:2056
    v_mfma_f32_16x16x32_bf16 v[168:171], a[36:39], v[88:91], v[168:171]
    ds_write_b64 v234, v[144:145] offset:3072
    s_waitcnt vmcnt(10)
    v_mfma_f32_16x16x32_bf16 v[152:155], a[40:43], v[92:95], v[152:155]
    ds_write_b64 v234, v[146:147] offset:3080
    v_mfma_f32_16x16x32_bf16 v[156:159], a[44:47], v[92:95], v[156:159]
    ds_write_b64 v234, v[148:149] offset:4096
    v_mfma_f32_16x16x32_bf16 v[160:163], a[48:51], v[92:95], v[160:163]
    ds_write_b64 v234, v[150:151] offset:4104
    v_mfma_f32_16x16x32_bf16 v[164:167], a[52:55], v[92:95], v[164:167]
    v_mfma_f32_16x16x32_bf16 v[168:171], a[56:59], v[92:95], v[168:171]
    s_waitcnt vmcnt(9)
    v_mfma_f32_16x16x32_bf16 v[152:155], a[60:63], v[96:99], v[152:155]
    v_mfma_f32_16x16x32_bf16 v[156:159], a[64:67], v[96:99], v[156:159]
    s_waitcnt lgkmcnt(0)
    s_barrier
    v_mfma_f32_16x16x32_bf16 v[160:163], a[68:71], v[96:99], v[160:163]
    ds_read_b128 v[176:179], v229 offset:0
    v_mfma_f32_16x16x32_bf16 v[164:167], a[72:75], v[96:99], v[164:167]
    ds_read_b128 v[180:183], v229 offset:1024
    v_mfma_f32_16x16x32_bf16 v[168:171], a[76:79], v[96:99], v[168:171]
    ds_read_b128 v[184:187], v229 offset:2048
    s_waitcnt vmcnt(8)
    v_mfma_f32_16x16x32_bf16 v[152:155], a[80:83], v[100:103], v[152:155]
    ds_read_b128 v[188:191], v229 offset:3072
    v_mfma_f32_16x16x32_bf16 v[156:159], a[84:87], v[100:103], v[156:159]
    ds_read_b128 v[192:195], v229 offset:4096
    v_mfma_f32_16x16x32_bf16 v[160:163], a[88:91], v[100:103], v[160:163]
    ds_read_b128 v[28:31], v229 offset:5120
    v_mfma_f32_16x16x32_bf16 v[164:167], a[92:95], v[100:103], v[164:167]
    ds_read_b128 v[32:35], v229 offset:6144
    v_mfma_f32_16x16x32_bf16 v[168:171], a[96:99], v[100:103], v[168:171]
    ds_read_b128 v[36:39], v229 offset:7168
    s_waitcnt vmcnt(7)
    v_mfma_f32_16x16x32_bf16 v[152:155], a[100:103], v[104:107], v[152:155]
    ds_read_b128 v[40:43], v229 offset:8192
    v_mfma_f32_16x16x32_bf16 v[156:159], a[104:107], v[104:107], v[156:159]
    ds_read_b128 v[44:47], v229 offset:9216
    v_mfma_f32_16x16x32_bf16 v[160:163], a[108:111], v[104:107], v[160:163]
    ds_read_b128 v[48:51], v229 offset:10240
    v_mfma_f32_16x16x32_bf16 v[164:167], a[112:115], v[104:107], v[164:167]
    ds_read_b128 v[52:55], v229 offset:11264
    v_mfma_f32_16x16x32_bf16 v[168:171], a[116:119], v[104:107], v[168:171]
    ds_read_b128 v[56:59], v229 offset:12288
    s_waitcnt vmcnt(6)
    v_mfma_f32_16x16x32_bf16 v[152:155], a[120:123], v[108:111], v[152:155]
    ds_read_b128 v[60:63], v229 offset:13312
    v_mfma_f32_16x16x32_bf16 v[156:159], a[124:127], v[108:111], v[156:159]
    ds_read_b128 v[64:67], v229 offset:14336
    s_waitcnt lgkmcnt(5)
    v_add_f32 v176, v176, v28
    v_mfma_f32_16x16x32_bf16 v[160:163], a[128:131], v[108:111], v[160:163]
    v_add_f32 v177, v177, v29
    v_add_f32 v178, v178, v30
    v_mfma_f32_16x16x32_bf16 v[164:167], a[132:135], v[108:111], v[164:167]
    v_add_f32 v179, v179, v31
    v_add_f32 v180, v180, v32
    v_mfma_f32_16x16x32_bf16 v[168:171], a[136:139], v[108:111], v[168:171]
    v_add_f32 v181, v181, v33
    s_waitcnt vmcnt(5)
    v_mfma_f32_16x16x32_bf16 v[152:155], a[140:143], v[112:115], v[152:155]
    v_add_f32 v182, v182, v34
    v_add_f32 v183, v183, v35
    v_mfma_f32_16x16x32_bf16 v[156:159], a[144:147], v[112:115], v[156:159]
    s_waitcnt vmcnt(0)
    v_cmp_ne_u64 s[50:51], s[48:49], v[226:227]
    s_nop 0
    s_and_b32 s50, s50, 0x11111111
    s_and_b32 s51, s51, 0x11
    s_cmp_lg_u64 s[50:51], 0
    s_cbranch_scc1 L_slow_fs
L_ok_fs:
    v_mfma_f32_16x16x32_bf16 v[160:163], a[148:151], v[112:115], v[160:163]
    buffer_load_dwordx4 v252, s[40:43], s8 offen offset:0 sc1 lds
    v_mfma_f32_16x16x32_bf16 v[164:167], a[152:155], v[112:115], v[164:167]
    v_add_f32 v184, v184, v36
    v_add_f32 v185, v185, v37
    v_mfma_f32_16x16x32_bf16 v[168:171], a[156:159], v[112:115], v[168:171]
    v_add_f32 v186, v186, v38
    v_mfma_f32_16x16x32_bf16 v[152:155], a[160:163], v[116:119], v[152:155]
    buffer_load_dwordx4 v252, s[40:43], s8 offen offset:1024 sc1 lds
    v_mfma_f32_16x16x32_bf16 v[156:159], a[164:167], v[116:119], v[156:159]
    s_mov_b32 exec_hi, 0
    buffer_load_dwordx4 v252, s[40:43], s8 offen offset:2048 sc1 lds
    s_mov_b32 exec_hi, -1
    v_mfma_f32_16x16x32_bf16 v[160:163], a[168:171], v[116:119], v[160:163]
    v_add_f32 v187, v187, v39
    v_add_f32 v188, v188, v40
    v_mfma_f32_16x16x32_bf16 v[164:167], a[172:175], v[116:119], v[164:167]
    v_add_f32 v189, v189, v41
    v_add_f32 v190, v190, v42
    v_mfma_f32_16x16x32_bf16 v[168:171], a[176:179], v[116:119], v[168:171]
    v_add_f32 v191, v191, v43
    v_mfma_f32_16x16x32_bf16 v[152:155], a[180:183], v[120:123], v[152:155]
    v_add_f32 v192, v192, v44
    v_add_f32 v193, v193, v45
    v_mfma_f32_16x16x32_bf16 v[156:159], a[184:187], v[120:123], v[156:159]
    v_add_f32 v194, v194, v46
    v_add_f32 v195, v195, v47
    v_mfma_f32_16x16x32_bf16 v[160:163], a[188:191], v[120:123], v[160:163]
    s_waitcnt lgkmcnt(0)
    v_add_f32 v176, v176, v48
    v_add_f32 v177, v177, v49
    v_mfma_f32_16x16x32_bf16 v[164:167], a[192:195], v[120:123], v[164:167]
    v_add_f32 v178, v178, v50
    v_add_f32 v179, v179, v51
    v_mfma_f32_16x16x32_bf16 v[168:171], a[196:199], v[120:123], v[168:171]
    v_add_f32 v180, v180, v52
    v_mfma_f32_16x16x32_bf16 v[152:155], a[200:203], v[124:127], v[152:155]
    v_add_f32 v181, v181, v53
    v_add_f32 v182, v182, v54
    v_mfma_f32_16x16x32_bf16 v[156:159], a[204:207], v[124:127], v[156:159]
    v_add_f32 v183, v183, v55
    v_add_f32 v184, v184, v56
    v_mfma_f32_16x16x32_bf16 v[160:163], a[208:211], v[124:127], v[160:163]
    v_add_f32 v185, v185, v57
    v_add_f32 v186, v186, v58
    v_mfma_f32_16x16x32_bf16 v[164:167], a[212:215], v[124:127], v[164:167]
    v_add_f32 v187, v187, v59
    v_add_f32 v188, v188, v60
    v_mfma_f32_16x16x32_bf16 v[168:171], a[216:219], v[124:127], v[168:171]
    v_add_f32 v189, v189, v61
    v_mfma_f32_16x16x32_bf16 v[152:155], a[220:223], v[128:131], v[152:155]
    v_add_f32 v190, v190, v62
    v_add_f32 v191, v191, v63
    v_mfma_f32_16x16x32_bf16 v[156:159], a[224:227], v[128:131], v[156:159]
    v_add_f32 v192, v192, v64
    v_add_f32 v193, v193, v65
    v_mfma_f32_16x16x32_bf16 v[160:163], a[228:231], v[128:131], v[160:163]
    v_add_f32 v194, v194, v66
    v_add_f32 v195, v195, v67
    v_mfma_f32_16x16x32_bf16 v[164:167], a[232:235], v[128:131], v[164:167]
    v_mfma_f32_16x16x32_bf16 v[168:171], a[236:239], v[128:131], v[168:171]
    v_pk_add_f32 v[152:153], v[152:153], v[176:177]
    v_pk_add_f32 v[154:155], v[154:155], v[178:179]
    v_pk_add_f32 v[156:157], v[156:157], v[180:181]
    v_pk_add_f32 v[158:159], v[158:159], v[182:183]
    v_pk_add_f32 v[160:161], v[160:161], v[184:185]
    v_pk_add_f32 v[162:163], v[162:163], v[186:187]
    s_nop 0
    s_nop 0
    v_pk_add_f32 v[164:165], v[164:165], v[188:189]
    v_pk_add_f32 v[166:167], v[166:167], v[190:191]
    v_pk_add_f32 v[168:169], v[168:169], v[192:193]
    v_pk_add_f32 v[170:171], v[170:171], v[194:195]
    v_pk_mul_f32 v[132:133], v[152:153], v[24:25] op_sel_hi:[1,0]
    v_pk_mul_f32 v[134:135], v[154:155], v[24:25] op_sel_hi:[1,0]
    v_pk_mul_f32 v[136:137], v[156:157], v[24:25] op_sel_hi:[1,0]
    v_pk_mul_f32 v[138:139], v[158:159], v[24:25] op_sel_hi:[1,0]
    v_pk_mul_f32 v[140:141], v[160:161], v[24:25] op_sel_hi:[1,0]
    v_pk_mul_f32 v[142:143], v[162:163], v[24:25] op_sel_hi:[1,0]
    v_pk_mul_f32 v[144:145], v[164:165], v[24:25] op_sel_hi:[1,0]
    v_pk_mul_f32 v[146:147], v[166:167], v[24:25] op_sel_hi:[1,0]
    v_pk_mul_f32 v[148:149], v[168:169], v[24:25] op_sel_hi:[1,0]
    v_pk_mul_f32 v[150:151], v[170:171], v[24:25] op_sel_hi:[1,0]
    v_exp_f32 v132, v132
    v_exp_f32 v133, v133
    v_exp_f32 v134, v134
    v_exp_f32 v135, v135
    v_exp_f32 v136, v136
    v_exp_f32 v137, v137
    v_exp_f32 v138, v138
    v_exp_f32 v139, v139
    v_exp_f32 v140, v140
    v_exp_f32 v141, v141
    v_exp_f32 v142, v142
    v_exp_f32 v143, v143
    v_exp_f32 v144, v144
    v_exp_f32 v145, v145
    v_exp_f32 v146, v146
    v_exp_f32 v147, v147
    v_exp_f32 v148, v148
    v_exp_f32 v149, v149
    v_exp_f32 v150, v150
    v_exp_f32 v151, v151
    v_pk_add_f32 v[132:133], v[132:133], 1.0 op_sel_hi:[1,0]
    v_pk_add_f32 v[134:135], v[134:135], 1.0 op_sel_hi:[1,0]
    v_pk_add_f32 v[136:137], v[136:137], 1.0 op_sel_hi:[1,0]
    v_pk_add_f32 v[138:139], v[138:139], 1.0 op_sel_hi:[1,0]
    v_pk_add_f32 v[140:141], v[140:141], 1.0 op_sel_hi:[1,0]
    v_pk_add_f32 v[142:143], v[142:143], 1.0 op_sel_hi:[1,0]
    v_pk_add_f32 v[144:145], v[144:145], 1.0 op_sel_hi:[1,0]
    v_pk_add_f32 v[146:147], v[146:147], 1.0 op_sel_hi:[1,0]
    v_pk_add_f32 v[148:149], v[148:149], 1.0 op_sel_hi:[1,0]
    v_pk_add_f32 v[150:151], v[150:151], 1.0 op_sel_hi:[1,0]
    v_rcp_f32 v132, v132
    v_rcp_f32 v133, v133
    v_rcp_f32 v134, v134
    v_rcp_f32 v135, v135
    v_rcp_f32 v136, v136
    v_rcp_f32 v137, v137
    s_waitcnt vmcnt(0)
    s_barrier
    ds_read_b64_tr_b16 v[88:89], v225 offset:0
    ds_read_b64_tr_b16 v[90:91], v225 offset:2048
    ds_read_b64_tr_b16 v[92:93], v225 offset:4096
    ds_read_b64_tr_b16 v[94:95], v225 offset:6144
    ds_read_b64_tr_b16 v[96:97], v225 offset:8192
    v_rcp_f32 v138, v138
    v_rcp_f32 v139, v139
    v_rcp_f32 v140, v140
    v_rcp_f32 v141, v141
    v_rcp_f32 v142, v142
    v_rcp_f32 v143, v143
    v_rcp_f32 v144, v144
    v_rcp_f32 v145, v145
    v_rcp_f32 v146, v146
    v_rcp_f32 v147, v147
    v_rcp_f32 v148, v148
    v_rcp_f32 v149, v149
    v_rcp_f32 v150, v150
    v_rcp_f32 v151, v151
    v_pk_mul_f32 v[152:153], v[152:153], v[132:133]
    v_pk_mul_f32 v[154:155], v[154:155], v[134:135]
    v_pk_mul_f32 v[156:157], v[156:157], v[136:137]
    v_pk_mul_f32 v[158:159], v[158:159], v[138:139]
    v_pk_mul_f32 v[160:161], v[160:161], v[140:141]
    v_pk_mul_f32 v[162:163], v[162:163], v[142:143]
    v_pk_mul_f32 v[164:165], v[164:165], v[144:145]
    v_pk_mul_f32 v[166:167], v[166:167], v[146:147]
    v_pk_mul_f32 v[168:169], v[168:169], v[148:149]
    v_pk_mul_f32 v[170:171], v[170:171], v[150:151]
    s_waitcnt lgkmcnt(0)
    v_lshlrev_b32 v68, 16, v88
    v_and_b32 v69, 0xffff0000, v88
    v_lshlrev_b32 v70, 16, v89
    v_and_b32 v71, 0xffff0000, v89
    v_lshlrev_b32 v72, 16, v90
    v_and_b32 v73, 0xffff0000, v90
    v_lshlrev_b32 v74, 16, v91
    v_and_b32 v75, 0xffff0000, v91
    v_lshlrev_b32 v76, 16, v92
    v_and_b32 v77, 0xffff0000, v92
    v_lshlrev_b32 v78, 16, v93
    v_and_b32 v79, 0xffff0000, v93
    v_lshlrev_b32 v80, 16, v94
    v_and_b32 v81, 0xffff0000, v94
    v_lshlrev_b32 v82, 16, v95
    v_and_b32 v83, 0xffff0000, v95
    v_lshlrev_b32 v84, 16, v96
    v_and_b32 v85, 0xffff0000, v96
    v_lshlrev_b32_e64 v86, 16, v97
    v_and_b32 v87, 0xffff0000, v97
    v_pk_fma_f32 v[152:153], v[152:153], v[68:69], v[4:5]
    v_pk_fma_f32 v[154:155], v[154:155], v[70:71], v[6:7]
    v_pk_fma_f32 v[156:157], v[156:157], v[72:73], v[8:9]
    v_pk_fma_f32 v[158:159], v[158:159], v[74:75], v[10:11]
    v_pk_fma_f32 v[160:161], v[160:161], v[76:77], v[12:13]
    v_pk_fma_f32 v[162:163], v[162:163], v[78:79], v[14:15]
    v_pk_fma_f32 v[164:165], v[164:165], v[80:81], v[16:17]
    v_pk_fma_f32 v[166:167], v[166:167], v[82:83], v[18:19]
    v_pk_fma_f32 v[168:169], v[168:169], v[84:85], v[20:21]
    v_pk_fma_f32 v[170:171], v[170:171], v[86:87], v[22:23]
    v_cvt_pk_bf16_f32 v88, v152, v153
    v_cvt_pk_bf16_f32 v89, v154, v155
    v_cvt_pk_bf16_f32 v90, v156, v157
    v_cvt_pk_bf16_f32 v91, v158, v159
    v_cvt_pk_bf16_f32 v92, v160, v161
    v_cvt_pk_bf16_f32 v93, v162, v163
    v_cvt_pk_bf16_f32 v94, v164, v165
    v_cvt_pk_bf16_f32 v95, v166, v167
    v_cvt_pk_bf16_f32 v96, v168, v169
    v_cvt_pk_bf16_f32 v97, v170, v171
    ds_write_b64 v224, v[88:89] offset:0
    ds_write_b64 v224, v[90:91] offset:32
    ds_write_b64 v224, v[92:93] offset:64
    ds_write_b64 v224, v[94:95] offset:96
    ds_write_b64 v224, v[96:97] offset:128
    ds_read_b128 v[100:103], v223 offset:0
    ds_read_b128 v[104:107], v223 offset:1024
    ds_read_b128 v[108:111], v223 offset:2048
    s_waitcnt lgkmcnt(2)
    buffer_store_dwordx4 v[100:103], v249, s[44:47], s79 offen offset:0
    s_waitcnt lgkmcnt(1)
    buffer_store_dwordx4 v[104:107], v2, s[44:47], s79 offen offset:1024
    s_waitcnt lgkmcnt(0)
    buffer_store_dwordx4 v[108:111], v3, s[44:47], s79 offen offset:2048
L_end:
    s_endpgm
L_slow_fc:
    s_mov_b32 s60, 0
L_spin_fc:
    s_sleep 2
    buffer_load_dwordx2 v[192:193], v234, s[40:43], s9 offen sc1
    s_waitcnt vmcnt(0)
    v_cmp_ne_u64 s[50:51], s[48:49], v[192:193]
    s_nop 1
    s_add_u32 s60, s60, 1
    s_cmp_gt_u32 s60, 200000
    s_cbranch_scc1 L_out_fc
    s_cmp_lg_u64 s[50:51], 0
    s_cbranch_scc1 L_spin_fc
L_out_fc:
    s_branch L_ok_fc
L_slow_f0:
    s_mov_b32 s60, 0
L_spin_f0:
L_padT2:
    s_cmp_lg_u32 s3, 0
    s_cbranch_scc1 L_wdone
    s_sleep 2
    buffer_load_dwordx2 v[192:193], v226, s[40:43], s8 offen sc1
    s_waitcnt vmcnt(0)
    v_cmp_ne_u64 s[50:51], s[48:49], v[192:193]
    s_nop 1
    s_add_u32 s60, s60, 1
    s_cmp_gt_u32 s60, 200000
    s_cbranch_scc1 L_out_f0
    s_cmp_lg_u64 s[50:51], 0
    s_cbranch_scc1 L_spin_f0
L_out_f0:
    s_branch L_ok_f0
L_slow_f0h:
    s_mov_b32 s60, 0
L_spin_f0h:
    s_sleep 2
    buffer_load_dwordx2 v[108:109], v100, s[40:43], s4 offen sc1
    s_waitcnt vmcnt(0)
    v_cmp_ne_u64 s[50:51], s[48:49], v[108:109]
    s_nop 1
    s_add_u32 s60, s60, 1
    s_cmp_gt_u32 s60, 200000
    s_cbranch_scc1 L_out_f0h
    s_cmp_lg_u64 s[50:51], 0
    s_cbranch_scc1 L_spin_f0h
L_out_f0h:
    s_branch L_ok_f0h
L_slow_fh0:
    s_mov_b32 s60, 0
    s_mov_b32 exec_lo, 0x1010101
    s_mov_b32 exec_hi, 0x101
L_spin_fh0:
    s_sleep 3
    v_mov_b32 v232, 0
    v_mov_b32 v233, 0
    buffer_atomic_or_x2 v[232:233], v238, s[40:43], s71 offen sc0
    s_waitcnt vmcnt(0)
    v_cmp_ne_u64 s[50:51], s[48:49], v[232:233]
    s_nop 1
    s_add_u32 s60, s60, 1
    s_cmp_gt_u32 s60, 200000
    s_cbranch_scc1 L_out_fh0
    s_cmp_lg_u64 s[50:51], 0
    s_cbranch_scc1 L_spin_fh0
L_out_fh0:
    s_mov_b64 exec, -1
    s_branch L_ok_fh0
L_ep0:
    s_mov_b32 s60, 0
    v_min_u32 v248, 47, v255
    v_lshlrev_b32 v248, 5, v248
    v_add_u32 v248, 4096, v248
L_eps0:
    buffer_load_dwordx4 v[68:71], v248, s[40:43], 0 offen sc1
    buffer_load_dwordx4 v[72:75], v248, s[40:43], 0 offen offset:16 sc1
    s_waitcnt vmcnt(0)
    v_cmp_ne_u64 s[50:51], s[48:49], v[68:69]
    s_nop 1
    v_cmp_ne_u64 s[52:53], s[48:49], v[70:71]
    s_nop 1
    s_or_b64 s[50:51], s[50:51], s[52:53]
    v_cmp_ne_u64 s[52:53], s[48:49], v[72:73]
    s_nop 1
    s_or_b64 s[50:51], s[50:51], s[52:53]
    v_cmp_ne_u64 s[52:53], s[48:49], v[74:75]
    s_nop 1
    s_or_b64 s[50:51], s[50:51], s[52:53]
    s_add_u32 s60, s60, 1
    s_cmp_gt_u32 s60, 200000
    s_cbranch_scc1 L_epr0
    s_cmp_lg_u64 s[50:51], 0
    s_cbranch_scc1 L_eps0
    s_atomic_swap_x2 s[48:49], s[40:41], 0x0
    s_branch L_epr0
L_slow_fh1:
    s_mov_b32 s60, 0
    s_mov_b32 exec_lo, 0x1010101
    s_mov_b32 exec_hi, 0x101
L_spin_fh1:
    s_sleep 3
    v_mov_b32 v232, 0
    v_mov_b32 v233, 0
    buffer_atomic_or_x2 v[232:233], v238, s[40:43], s71 offen sc0
    s_waitcnt vmcnt(0)
    v_cmp_ne_u64 s[50:51], s[48:49], v[232:233]
    s_nop 1
    s_add_u32 s60, s60, 1
    s_cmp_gt_u32 s60, 200000
    s_cbranch_scc1 L_out_fh1
    s_cmp_lg_u64 s[50:51], 0
    s_cbranch_scc1 L_spin_fh1
L_out_fh1:
    s_mov_b64 exec, -1
    s_branch L_ok_fh1
L_ep1:
    s_branch L_epr1
L_slow_f3:
    s_mov_b32 s60, 0
    s_mov_b32 exec_lo, 0x1010101
    s_mov_b32 exec_hi, 0x101
L_spin_f3:
    s_sleep 3
    v_mov_b32 v232, 0
    v_mov_b32 v233, 0
    buffer_atomic_or_x2 v[232:233], v238, s[40:43], s5 offen sc0
    s_waitcnt vmcnt(0)
    v_cmp_ne_u64 s[50:51], s[48:49], v[232:233]
    s_nop 1
    s_add_u32 s60, s60, 1
    s_cmp_gt_u32 s60, 200000
    s_cbranch_scc1 L_out_f3
    s_cmp_lg_u64 s[50:51], 0
    s_cbranch_scc1 L_spin_f3
L_out_f3:
    s_mov_b64 exec, -1
    s_branch L_ok_f3
L_slow_fs:
    s_mov_b32 s60, 0
    s_mov_b32 exec_lo, 0x11111111
    s_mov_b32 exec_hi, 0x11
L_spin_fs:
    s_sleep 3
    v_mov_b32 v226, 0
    v_mov_b32 v227, 0
    buffer_atomic_or_x2 v[226:227], v228, s[40:43], s7 offen sc0
    s_waitcnt vmcnt(0)
    v_cmp_ne_u64 s[50:51], s[48:49], v[226:227]
    s_nop 1
    s_add_u32 s60, s60, 1
    s_cmp_gt_u32 s60, 200000
    s_cbranch_scc1 L_out_fs
    s_cmp_lg_u64 s[50:51], 0
    s_cbranch_scc1 L_spin_fs
L_out_fs:
    s_mov_b64 exec, -1
    s_branch L_ok_fs
L_helper:
    s_sub_u32 s81, s56, 24
    s_lshl_b32 s82, s59, 5
    s_lshl_b32 s57, s60, 3
    s_add_u32 s82, s82, s57
    s_add_u32 s82, s82, s81
    v_lshrrev_b32 v149, 3, v255
    v_and_b32 v150, 7, v255
    v_mul_u32_u24 v148, 1280, v149
    v_lshl_add_u32 v148, v150, 4, v148
    s_lshl_b32 s62, s82, 2
    s_add_u32 s62, s62, s54
    s_mul_i32 s93, s62, 10240
    s_lshl_b32 s57, s81, 2
    s_add_u32 s83, s57, s54
    s_add_u32 s63, s63, s57
    s_add_u32 s63, s63, 48
    s_lshl_b32 s92, s55, 5
    s_add_u32 s92, s92, s83
    s_mul_i32 s79, s92, 52429
    s_lshr_b32 s79, s79, 18
    s_mul_i32 s57, s79, 5
    s_sub_u32 s80, s92, s57
    s_mul_i32 s94, s79, 40960
    s_lshl_b32 s57, s80, 8
    s_add_u32 s94, s94, s57
    s_add_u32 s95, s94, 20480
    s_lshl_b32 s96, s54, 13
    v_lshlrev_b32 v244, 1, v253
    v_xor_b32 v244, v244, v254
    v_mul_u32_u24 v245, 1280, v253
    v_lshl_add_u32 v152, v244, 4, v245
    v_xor_b32 v244, 128, v152
    v_add_u32 v153, 4096, v244
    v_add_u32 v154, 8192, v152
    v_add_u32 v155, 12288, v244
    s_mov_b32 s86, 1966080
    s_mov_b32 s87, 0x20000
    s_waitcnt lgkmcnt(0)
    s_mov_b32 s36, s4
    s_mov_b32 s37, s5
    s_nop 0
    buffer_load_dwordx4 v[84:87], v148, s[36:39], s93 offen offset:0
    buffer_load_dwordx4 v[88:91], v148, s[36:39], s93 offen offset:128
    buffer_load_dwordx4 v[92:95], v148, s[36:39], s93 offen offset:256
    buffer_load_dwordx4 v[96:99], v148, s[36:39], s93 offen offset:384
    buffer_load_dwordx4 v[100:103], v148, s[36:39], s93 offen offset:512
    buffer_load_dwordx4 v[104:107], v148, s[36:39], s93 offen offset:640
    buffer_load_dwordx4 v[108:111], v148, s[36:39], s93 offen offset:768
    buffer_load_dwordx4 v[112:115], v148, s[36:39], s93 offen offset:896
    buffer_load_dwordx4 v[116:119], v148, s[36:39], s93 offen offset:1024
    buffer_load_dwordx4 v[120:123], v148, s[36:39], s93 offen offset:1152
    s_mov_b32 s40, s34
    s_mov_b32 s41, s35
    s_mov_b32 s84, s28
    s_mov_b32 s85, s29
    s_lshl_b32 s93, s62, 6
    s_add_u32 s93, s93, 16384
    s_mov_b32 s44, s30
    s_mov_b32 s45, s31
    s_mov_b32 s46, 2621440
    s_mov_b32 s47, 0x20000
    s_bitcmp0_b32 s55, 0
    s_cselect_b32 s88, s24, s26
    s_cselect_b32 s89, s25, s27
    s_cmp_lt_u32 s83, 30
    s_cselect_b32 s90, 1966080, 0
    s_mov_b32 s91, 0x20000
    s_add_u32 s58, s63, s54
    s_mul_i32 s57, s58, 384
    v_lshl_add_u32 v1, v255, 1, s57
    s_lshl_b32 s57, s58, 1
    v_mov_b32 v147, s57
    v_mov_b32 v124, 0
    v_mov_b32 v125, 0
    v_mov_b32 v126, 0
    v_mov_b32 v127, 0
    v_mov_b32 v128, 0
    v_mov_b32 v129, 0
    v_mov_b32 v130, 0
    v_mov_b32 v131, 0
    v_mov_b32 v132, 0
    v_mov_b32 v133, 0
    v_mov_b32 v134, 0
    v_mov_b32 v135, 0
    v_mov_b32 v136, 0
    v_mov_b32 v137, 0
    v_mov_b32 v138, 0
    v_mov_b32 v139, 0
    v_mov_b32 v140, 0
    v_mov_b32 v141, 0
    v_mov_b32 v144, 0
    v_mov_b32 v3, 0
    s_mul_i32 s22, s83, 43
    s_lshr_b32 s22, s22, 8
    s_mul_i32 s57, s22, 6
    s_sub_u32 s57, s83, s57
    s_mul_i32 s23, s60, 6
    s_add_u32 s23, s23, s57
    s_mul_i32 s58, s59, 5
    s_add_u32 s58, s58, s22
    s_lshl_b32 s27, s23, 4
    s_add_u32 s27, s27, s58
    s_lshl_b32 s27, s27, 7
    s_add_u32 s27, s27, 196608
    s_mul_i32 s26, s58, 6144
    s_lshl_b32 s57, s23, 8
    s_add_u32 s26, s26, s57
    s_add_u32 s26, s26, 65536
    s_add_u32 s24, s22, 15
    s_mul_i32 s24, s24, 24576
    s_lshl_b32 s57, s23, 7
    s_add_u32 s24, s24, s57
    s_cmp_lt_u32 s83, 30
    s_cselect_b32 s26, s26, 1073741824
    s_cselect_b32 s27, s27, 1073741824
    s_mul_i32 s79, s79, 5
    s_lshl_b32 s80, s80, 3
    s_cmp_lt_u32 s92, 240
    s_cselect_b32 s92, 0, 1073741824
    s_add_u32 s92, s92, 4194304
    s_add_u32 s57, s80, 0
    s_mul_i32 s58, s57, 52
    s_lshr_b32 s58, s58, 8
    s_mul_i32 s58, s58, 235
    s_add_u32 s57, s57, s58
    s_add_u32 s57, s57, s79
    s_lshl_b32 s57, s57, 10
    s_add_u32 s28, s57, s92
    s_add_u32 s57, s80, 1
    s_mul_i32 s58, s57, 52
    s_lshr_b32 s58, s58, 8
    s_mul_i32 s58, s58, 235
    s_add_u32 s57, s57, s58
    s_add_u32 s57, s57, s79
    s_lshl_b32 s57, s57, 10
    s_add_u32 s29, s57, s92
    s_add_u32 s57, s80, 2
    s_mul_i32 s58, s57, 52
    s_lshr_b32 s58, s58, 8
    s_mul_i32 s58, s58, 235
    s_add_u32 s57, s57, s58
    s_add_u32 s57, s57, s79
    s_lshl_b32 s57, s57, 10
    s_add_u32 s30, s57, s92
    s_add_u32 s57, s80, 3
    s_mul_i32 s58, s57, 52
    s_lshr_b32 s58, s58, 8
    s_mul_i32 s58, s58, 235
    s_add_u32 s57, s57, s58
    s_add_u32 s57, s57, s79
    s_lshl_b32 s57, s57, 10
    s_add_u32 s31, s57, s92
    s_add_u32 s57, s80, 4
    s_mul_i32 s58, s57, 52
    s_lshr_b32 s58, s58, 8
    s_mul_i32 s58, s58, 235
    s_add_u32 s57, s57, s58
    s_add_u32 s57, s57, s79
    s_lshl_b32 s57, s57, 10
    s_add_u32 s32, s57, s92
    s_add_u32 s57, s80, 5
    s_mul_i32 s58, s57, 52
    s_lshr_b32 s58, s58, 8
    s_mul_i32 s58, s58, 235
    s_add_u32 s57, s57, s58
    s_add_u32 s57, s57, s79
    s_lshl_b32 s57, s57, 10
    s_add_u32 s33, s57, s92
    s_add_u32 s57, s80, 6
    s_mul_i32 s58, s57, 52
    s_lshr_b32 s58, s58, 8
    s_mul_i32 s58, s58, 235
    s_add_u32 s57, s57, s58
    s_add_u32 s57, s57, s79
    s_lshl_b32 s57, s57, 10
    s_add_u32 s34, s57, s92
    s_add_u32 s57, s80, 7
    s_mul_i32 s58, s57, 52
    s_lshr_b32 s58, s58, 8
    s_mul_i32 s58, s58, 235
    s_add_u32 s57, s57, s58
    s_add_u32 s57, s57, s79
    s_lshl_b32 s57, s57, 10
    s_add_u32 s35, s57, s92
    v_mul_u32_u24 v151, 3072, v149
    v_lshl_add_u32 v151, v150, 4, v151
    v_lshrrev_b32 v244, 2, v255
    v_and_b32 v245, 3, v255
    v_lshlrev_b32 v156, 8, v244
    v_lshl_add_u32 v156, v245, 3, v156
    s_add_u32 s57, s96, 94208
    v_add_u32 v156, s57, v156
    v_and_b32 v244, 7, v244
    v_lshl_add_u32 v156, v244, 5, v156
    v_mov_b32 v248, 1073741824
    v_and_b32 v246, 0x28, v255
    v_cmp_eq_u32 vcc, 0, v246
    v_lshlrev_b32 v247, 5, v150
    v_lshl_add_u32 v247, v253, 4, v247
    v_cndmask_b32 v161, v248, v247, vcc
    v_cmp_eq_u32 vcc, 0, v150
    s_mul_i32 s57, s54, 10368
    s_add_u32 s57, s57, 51200
    v_cndmask_b32 v162, v248, v255, vcc
    v_mul_u32_u24 v163, 1296, v149
    v_lshl_add_u32 v163, v150, 4, v163
    v_add_u32 v163, s57, v163
    v_lshrrev_b32 v244, 2, v254
    v_bfe_u32 v246, v255, 1, 1
    v_lshl_add_u32 v246, v246, 2, v244
    v_and_b32_e64 v247, 1, v255
    v_lshl_add_u32 v246, v246, 1, v247
    v_mul_u32_u24 v159, 2592, v246
    v_lshl_add_u32 v159, v253, 3, v159
    s_lshl_b32 s57, s54, 5
    s_add_u32 s57, s57, 51200
    v_add_u32 v159, s57, v159
    v_lshlrev_b32 v160, 14, v253
    v_lshl_add_u32 v160, v254, 4, v160
    s_lshl_b32 s25, s54, 8
    s_add_u32 s25, s25, s82
    s_lshl_b32 s25, s25, 8
    s_add_u32 s25, s25, 1048576
    s_and_b32 s61, s56, 3
    s_lshl_b32 s65, s55, 2
    s_add_u32 s65, s65, s61
    s_lshr_b32 s66, s56, 2
    s_lshl_b32 s62, s66, 2
    s_add_u32 s62, s62, s54
    s_mul_i32 s67, s62, 61440
    s_add_u32 s67, s67, 4194304
    s_and_b32 s69, s54, 1
    s_lshl_b32 s69, s69, 8
    s_min_u32 s64, s54, 1
    s_lshl_b32 s64, s64, 30
    v_lshrrev_b32 v244, 2, v254
    v_and_b32 v245, 3, v255
    v_sub_u32 v246, v245, v244
    v_lshlrev_b32 v246, 3, v246
    v_bfrev_b32 v245, v253
    v_lshrrev_b32 v245, 30, v245
    v_lshl_add_u32 v246, v245, 6, v246
    v_add_u32 v242, 51328, v246
    s_add_u32 s61, s69, 60032
    v_lshlrev_b32 v244, 7, v245
    v_lshlrev_b32 v246, 4, v254
    v_sub_u32 v246, v246, v244
    v_add_u32 v241, s61, v246
    buffer_load_dwordx2 v[142:143], v243, s[40:43], 0 offen sc1
    global_load_short_d16_hi v144, v147, s[18:19]
    global_load_short_d16_hi v124, v1, s[6:7] offset:0 nt
    global_load_short_d16_hi v125, v1, s[8:9] offset:0 nt
    global_load_short_d16_hi v126, v1, s[10:11] offset:0 nt
    global_load_short_d16_hi v127, v1, s[12:13] offset:0 nt
    global_load_short_d16_hi v128, v1, s[14:15] offset:0 nt
    global_load_short_d16_hi v129, v1, s[16:17] offset:0 nt
    s_mov_b32 s3, 2
    s_cmp_eq_u32 s54, 0
    s_cbranch_scc1 L_padH3
    s_cmp_eq_u32 s54, 1
    s_cbranch_scc1 L_padH2
    s_cmp_eq_u32 s54, 2
    s_cbranch_scc1 L_padH1
    s_branch L_padH0
L_wdoneH:
    s_mov_b32 s3, 0
    s_waitcnt vmcnt(17)
    v_lshlrev_b32 v4, 16, v84
    v_and_b32 v5, 0xffff0000, v84
    v_lshlrev_b32 v6, 16, v85
    v_and_b32 v7, 0xffff0000, v85
    v_lshlrev_b32 v8, 16, v86
    v_and_b32 v9, 0xffff0000, v86
    v_lshlrev_b32 v10, 16, v87
    v_and_b32 v11, 0xffff0000, v87
    s_waitcnt vmcnt(16)
    v_lshlrev_b32 v12, 16, v88
    v_and_b32 v13, 0xffff0000, v88
    v_lshlrev_b32 v14, 16, v89
    v_and_b32 v15, 0xffff0000, v89
    v_lshlrev_b32 v16, 16, v90
    v_and_b32 v17, 0xffff0000, v90
    buffer_load_dwordx4 a[64:67], v151, s[88:91], s24 offen
    v_lshlrev_b32 v18, 16, v91
    v_and_b32 v19, 0xffff0000, v91
    s_waitcnt vmcnt(16)
    v_lshlrev_b32 v20, 16, v92
    v_and_b32 v21, 0xffff0000, v92
    v_lshlrev_b32 v22, 16, v93
    v_and_b32 v23, 0xffff0000, v93
    v_lshlrev_b32 v24, 16, v94
    v_and_b32 v25, 0xffff0000, v94
    v_lshlrev_b32 v26, 16, v95
    v_and_b32 v27, 0xffff0000, v95
    s_waitcnt vmcnt(15)
    v_lshlrev_b32 v28, 16, v96
    v_and_b32 v29, 0xffff0000, v96
    v_lshlrev_b32_e64 v30, 16, v97
    s_add_u32 s24, s24, 122880
    v_and_b32 v31, 0xffff0000, v97
    buffer_load_dwordx4 a[68:71], v151, s[88:91], s24 offen
    v_lshlrev_b32 v32, 16, v98
    v_and_b32 v33, 0xffff0000, v98
    v_lshlrev_b32 v34, 16, v99
    v_and_b32 v35, 0xffff0000, v99
    s_waitcnt vmcnt(15)
    v_lshlrev_b32 v36, 16, v100
    v_and_b32 v37, 0xffff0000, v100
    v_lshlrev_b32 v38, 16, v101
    v_and_b32 v39, 0xffff0000, v101
    v_lshlrev_b32 v40, 16, v102
    v_and_b32 v41, 0xffff0000, v102
    v_lshlrev_b32 v42, 16, v103
    v_and_b32 v43, 0xffff0000, v103
    s_waitcnt vmcnt(14)
    v_lshlrev_b32_e64 v44, 16, v104
    s_add_u32 s24, s24, 122880
    v_and_b32 v45, 0xffff0000, v104
    buffer_load_dwordx4 a[72:75], v151, s[88:91], s24 offen
    v_lshlrev_b32 v46, 16, v105
    v_and_b32 v47, 0xffff0000, v105
    v_lshlrev_b32 v48, 16, v106
    v_and_b32 v49, 0xffff0000, v106
    v_lshlrev_b32 v50, 16, v107
    v_and_b32 v51, 0xffff0000, v107
    s_waitcnt vmcnt(14)
    v_lshlrev_b32 v52, 16, v108
    v_and_b32 v53, 0xffff0000, v108
    v_lshlrev_b32 v54, 16, v109
    v_and_b32 v55, 0xffff0000, v109
    v_lshlrev_b32 v56, 16, v110
    v_and_b32 v57, 0xffff0000, v110
    v_lshlrev_b32 v58, 16, v111
    s_add_u32 s24, s24, 122880
    v_and_b32 v59, 0xffff0000, v111
    buffer_load_dwordx4 a[76:79], v151, s[88:91], s24 offen
    s_waitcnt vmcnt(14)
    v_lshlrev_b32 v60, 16, v112
    v_and_b32 v61, 0xffff0000, v112
    v_lshlrev_b32 v62, 16, v113
    v_and_b32 v63, 0xffff0000, v113
    v_lshlrev_b32 v64, 16, v114
    v_and_b32 v65, 0xffff0000, v114
    v_lshlrev_b32 v66, 16, v115
    v_and_b32 v67, 0xffff0000, v115
    s_waitcnt vmcnt(13)
    v_lshlrev_b32 v68, 16, v116
    v_and_b32 v69, 0xffff0000, v116
    v_lshlrev_b32 v70, 16, v117
    v_and_b32 v71, 0xffff0000, v117
    v_lshlrev_b32_e64 v72, 16, v118
    s_add_u32 s24, s24, 122880
    v_and_b32 v73, 0xffff0000, v118
    buffer_load_dwordx4 a[80:83], v151, s[88:91], s24 offen
    v_lshlrev_b32 v74, 16, v119
    v_and_b32 v75, 0xffff0000, v119
    s_waitcnt vmcnt(13)
    v_lshlrev_b32 v76, 16, v120
    v_and_b32 v77, 0xffff0000, v120
    v_lshlrev_b32 v78, 16, v121
    v_and_b32 v79, 0xffff0000, v121
    v_lshlrev_b32 v80, 16, v122
    v_and_b32 v81, 0xffff0000, v122
    v_lshlrev_b32 v82, 16, v123
    v_and_b32 v83, 0xffff0000, v123
    v_pk_add_f32 v[164:165], v[4:5], v[6:7]
    v_pk_add_f32 v[164:165], v[164:165], v[8:9]
    v_pk_add_f32 v[164:165], v[164:165], v[10:11]
    s_add_u32 s24, s24, 122880
    v_pk_add_f32 v[164:165], v[164:165], v[12:13]
    buffer_load_dwordx4 a[84:87], v151, s[88:91], s24 offen
    v_pk_add_f32 v[164:165], v[164:165], v[14:15]
    v_pk_add_f32 v[164:165], v[164:165], v[16:17]
    v_pk_add_f32 v[164:165], v[164:165], v[18:19]
    v_pk_add_f32 v[164:165], v[164:165], v[20:21]
    v_pk_add_f32 v[164:165], v[164:165], v[22:23]
    v_pk_add_f32 v[164:165], v[164:165], v[24:25]
    v_pk_add_f32 v[164:165], v[164:165], v[26:27]
    v_pk_add_f32 v[164:165], v[164:165], v[28:29]
    v_pk_add_f32 v[164:165], v[164:165], v[30:31]
    v_pk_add_f32 v[164:165], v[164:165], v[32:33]
    v_pk_add_f32 v[164:165], v[164:165], v[34:35]
    v_pk_add_f32 v[164:165], v[164:165], v[36:37]
    v_pk_add_f32 v[164:165], v[164:165], v[38:39]
    s_add_u32 s24, s24, 122880
    v_pk_add_f32 v[164:165], v[164:165], v[40:41]
    buffer_load_dwordx4 a[88:91], v151, s[88:91], s24 offen
    v_pk_add_f32 v[164:165], v[164:165], v[42:43]
    v_pk_add_f32 v[164:165], v[164:165], v[44:45]
    v_pk_add_f32 v[164:165], v[164:165], v[46:47]
    v_pk_add_f32 v[164:165], v[164:165], v[48:49]
    v_pk_add_f32 v[164:165], v[164:165], v[50:51]
    v_pk_add_f32 v[164:165], v[164:165], v[52:53]
    v_pk_add_f32 v[164:165], v[164:165], v[54:55]
    v_pk_add_f32 v[164:165], v[164:165], v[56:57]
    v_pk_add_f32 v[164:165], v[164:165], v[58:59]
    v_pk_add_f32 v[164:165], v[164:165], v[60:61]
    v_pk_add_f32 v[164:165], v[164:165], v[62:63]
    v_pk_add_f32 v[164:165], v[164:165], v[64:65]
    v_pk_add_f32 v[164:165], v[164:165], v[66:67]
    s_add_u32 s24, s24, 122880
    v_pk_add_f32 v[164:165], v[164:165], v[68:69]
    buffer_load_dwordx4 a[92:95], v151, s[88:91], s24 offen
    v_pk_add_f32 v[164:165], v[164:165], v[70:71]
    v_pk_add_f32 v[164:165], v[164:165], v[72:73]
    v_pk_add_f32 v[164:165], v[164:165], v[74:75]
    v_pk_add_f32 v[164:165], v[164:165], v[76:77]
    v_pk_add_f32 v[164:165], v[164:165], v[78:79]
    v_pk_add_f32 v[164:165], v[164:165], v[80:81]
    v_pk_add_f32 v[164:165], v[164:165], v[82:83]
    v_add_f32 v166, v164, v165
    s_nop 1
    v_add_f32_dpp v166, v166, v166 quad_perm:[1,0,3,2] row_mask:0xf bank_mask:0xf bound_ctrl:0
    s_nop 1
    v_add_f32_dpp v166, v166, v166 quad_perm:[2,3,0,1] row_mask:0xf bank_mask:0xf bound_ctrl:0
    s_nop 1
    v_add_f32_dpp v166, v166, v166 row_half_mirror row_mask:0xf bank_mask:0xf bound_ctrl:0
    v_mul_f32 v168, 0xbacccccd, v166
    v_pk_add_f32 v[4:5], v[4:5], v[168:169] op_sel_hi:[1,0]
    s_add_u32 m0, s96, 94208
    v_pk_add_f32 v[6:7], v[6:7], v[168:169] op_sel_hi:[1,0]
    buffer_load_dwordx4 v152, s[84:87], s94 offen offset:0 nt lds
    v_pk_add_f32 v[8:9], v[8:9], v[168:169] op_sel_hi:[1,0]
    v_pk_add_f32 v[10:11], v[10:11], v[168:169] op_sel_hi:[1,0]
    v_pk_add_f32 v[12:13], v[12:13], v[168:169] op_sel_hi:[1,0]
    v_pk_add_f32 v[14:15], v[14:15], v[168:169] op_sel_hi:[1,0]
    v_pk_add_f32 v[16:17], v[16:17], v[168:169] op_sel_hi:[1,0]
    v_pk_add_f32 v[18:19], v[18:19], v[168:169] op_sel_hi:[1,0]
    v_pk_add_f32 v[20:21], v[20:21], v[168:169] op_sel_hi:[1,0]
    v_pk_add_f32 v[22:23], v[22:23], v[168:169] op_sel_hi:[1,0]
    v_pk_add_f32 v[24:25], v[24:25], v[168:169] op_sel_hi:[1,0]
    v_pk_add_f32 v[26:27], v[26:27], v[168:169] op_sel_hi:[1,0]
    v_pk_add_f32 v[28:29], v[28:29], v[168:169] op_sel_hi:[1,0]
    v_pk_add_f32 v[30:31], v[30:31], v[168:169] op_sel_hi:[1,0]
    v_pk_add_f32 v[32:33], v[32:33], v[168:169] op_sel_hi:[1,0]
    v_pk_add_f32 v[34:35], v[34:35], v[168:169] op_sel_hi:[1,0]
    buffer_load_dwordx4 v153, s[84:87], s94 offen offset:1024 nt lds
    v_pk_add_f32 v[36:37], v[36:37], v[168:169] op_sel_hi:[1,0]
    v_pk_add_f32 v[38:39], v[38:39], v[168:169] op_sel_hi:[1,0]
    v_pk_add_f32 v[40:41], v[40:41], v[168:169] op_sel_hi:[1,0]
    v_pk_add_f32 v[42:43], v[42:43], v[168:169] op_sel_hi:[1,0]
    v_pk_add_f32 v[44:45], v[44:45], v[168:169] op_sel_hi:[1,0]
    v_pk_add_f32 v[46:47], v[46:47], v[168:169] op_sel_hi:[1,0]
    v_pk_add_f32 v[48:49], v[48:49], v[168:169] op_sel_hi:[1,0]
    v_pk_add_f32 v[50:51], v[50:51], v[168:169] op_sel_hi:[1,0]
    v_pk_add_f32 v[52:53], v[52:53], v[168:169] op_sel_hi:[1,0]
    v_pk_add_f32 v[54:55], v[54:55], v[168:169] op_sel_hi:[1,0]
    v_pk_add_f32 v[56:57], v[56:57], v[168:169] op_sel_hi:[1,0]
    v_pk_add_f32 v[58:59], v[58:59], v[168:169] op_sel_hi:[1,0]
    v_pk_add_f32 v[60:61], v[60:61], v[168:169] op_sel_hi:[1,0]
    v_pk_add_f32 v[62:63], v[62:63], v[168:169] op_sel_hi:[1,0]
    buffer_load_dwordx4 v154, s[84:87], s94 offen offset:2048 nt lds
    v_pk_add_f32 v[64:65], v[64:65], v[168:169] op_sel_hi:[1,0]
    v_pk_add_f32 v[66:67], v[66:67], v[168:169] op_sel_hi:[1,0]
    v_pk_add_f32 v[68:69], v[68:69], v[168:169] op_sel_hi:[1,0]
    v_pk_add_f32 v[70:71], v[70:71], v[168:169] op_sel_hi:[1,0]
    v_pk_add_f32 v[72:73], v[72:73], v[168:169] op_sel_hi:[1,0]
    v_pk_add_f32 v[74:75], v[74:75], v[168:169] op_sel_hi:[1,0]
    v_pk_add_f32 v[76:77], v[76:77], v[168:169] op_sel_hi:[1,0]
    v_pk_add_f32 v[78:79], v[78:79], v[168:169] op_sel_hi:[1,0]
    v_pk_add_f32 v[80:81], v[80:81], v[168:169] op_sel_hi:[1,0]
    v_pk_add_f32 v[82:83], v[82:83], v[168:169] op_sel_hi:[1,0]
    v_pk_mul_f32 v[164:165], v[4:5], v[4:5]
    v_pk_fma_f32 v[164:165], v[6:7], v[6:7], v[164:165]
    v_pk_fma_f32 v[164:165], v[8:9], v[8:9], v[164:165]
    v_pk_fma_f32 v[164:165], v[10:11], v[10:11], v[164:165]
    buffer_load_dwordx4 v155, s[84:87], s94 offen offset:3072 nt lds
    v_pk_fma_f32 v[164:165], v[12:13], v[12:13], v[164:165]
    v_pk_fma_f32 v[164:165], v[14:15], v[14:15], v[164:165]
    v_pk_fma_f32 v[164:165], v[16:17], v[16:17], v[164:165]
    v_pk_fma_f32 v[164:165], v[18:19], v[18:19], v[164:165]
    v_pk_fma_f32 v[164:165], v[20:21], v[20:21], v[164:165]
    v_pk_fma_f32 v[164:165], v[22:23], v[22:23], v[164:165]
    v_pk_fma_f32 v[164:165], v[24:25], v[24:25], v[164:165]
    v_pk_fma_f32 v[164:165], v[26:27], v[26:27], v[164:165]
    v_pk_fma_f32 v[164:165], v[28:29], v[28:29], v[164:165]
    v_pk_fma_f32 v[164:165], v[30:31], v[30:31], v[164:165]
    v_pk_fma_f32 v[164:165], v[32:33], v[32:33], v[164:165]
    v_pk_fma_f32 v[164:165], v[34:35], v[34:35], v[164:165]
    v_pk_fma_f32 v[164:165], v[36:37], v[36:37], v[164:165]
    s_add_u32 m0, s96, 98304
    v_pk_fma_f32 v[164:165], v[38:39], v[38:39], v[164:165]
    buffer_load_dwordx4 v152, s[84:87], s95 offen offset:0 nt lds
    v_pk_fma_f32 v[164:165], v[40:41], v[40:41], v[164:165]
    v_pk_fma_f32 v[164:165], v[42:43], v[42:43], v[164:165]
    v_pk_fma_f32 v[164:165], v[44:45], v[44:45], v[164:165]
    v_pk_fma_f32 v[164:165], v[46:47], v[46:47], v[164:165]
    v_pk_fma_f32 v[164:165], v[48:49], v[48:49], v[164:165]
    v_pk_fma_f32 v[164:165], v[50:51], v[50:51], v[164:165]
    v_pk_fma_f32 v[164:165], v[52:53], v[52:53], v[164:165]
    v_pk_fma_f32 v[164:165], v[54:55], v[54:55], v[164:165]
    v_pk_fma_f32 v[164:165], v[56:57], v[56:57], v[164:165]
    v_pk_fma_f32 v[164:165], v[58:59], v[58:59], v[164:165]
    v_pk_fma_f32 v[164:165], v[60:61], v[60:61], v[164:165]
    v_pk_fma_f32 v[164:165], v[62:63], v[62:63], v[164:165]
    v_pk_fma_f32 v[164:165], v[64:65], v[64:65], v[164:165]
    v_pk_fma_f32 v[164:165], v[66:67], v[66:67], v[164:165]
    buffer_load_dwordx4 v153, s[84:87], s95 offen offset:1024 nt lds
    v_pk_fma_f32 v[164:165], v[68:69], v[68:69], v[164:165]
    v_pk_fma_f32 v[164:165], v[70:71], v[70:71], v[164:165]
    v_pk_fma_f32 v[164:165], v[72:73], v[72:73], v[164:165]
    v_pk_fma_f32 v[164:165], v[74:75], v[74:75], v[164:165]
    v_pk_fma_f32 v[164:165], v[76:77], v[76:77], v[164:165]
    v_pk_fma_f32 v[164:165], v[78:79], v[78:79], v[164:165]
    v_pk_fma_f32 v[164:165], v[80:81], v[80:81], v[164:165]
    v_pk_fma_f32 v[164:165], v[82:83], v[82:83], v[164:165]
    v_add_f32 v166, v164, v165
    s_nop 1
    v_add_f32_dpp v166, v166, v166 quad_perm:[1,0,3,2] row_mask:0xf bank_mask:0xf bound_ctrl:0
    s_nop 1
    v_add_f32_dpp v166, v166, v166 quad_perm:[2,3,0,1] row_mask:0xf bank_mask:0xf bound_ctrl:0
    s_nop 1
    v_add_f32_dpp v166, v166, v166 row_half_mirror row_mask:0xf bank_mask:0xf bound_ctrl:0
    v_mul_f32 v166, 0x3acccccd, v166
    v_cvt_pk_bf16_f32 v166, v166, v166
    buffer_load_dwordx4 v154, s[84:87], s95 offen offset:2048 nt lds
    v_lshlrev_b32 v166, 16, v166
    v_add_f32 v166, 0x3727c5ac, v166
    v_cvt_pk_bf16_f32 v166, v166, v166
    v_lshlrev_b32 v166, 16, v166
    v_sqrt_f32 v166, v166
    v_cvt_pk_bf16_f32 v172, v168, v168
    v_cvt_pk_bf16_f32 v166, v166, v166
    v_lshlrev_b32 v173, 16, v166
    v_rcp_f32 v170, v173
    v_lshlrev_b32 v169, 16, v172
    v_sub_f32 v169, v169, v168
    v_mul_f32 v171, v169, v170
    v_pk_fma_f32 v[4:5], v[4:5], v[170:171], v[170:171] op_sel:[0,0,1] op_sel_hi:[1,0,1]
    v_pk_fma_f32 v[6:7], v[6:7], v[170:171], v[170:171] op_sel:[0,0,1] op_sel_hi:[1,0,1]
    buffer_load_dwordx4 v155, s[84:87], s95 offen offset:3072 nt lds
    v_pk_fma_f32 v[8:9], v[8:9], v[170:171], v[170:171] op_sel:[0,0,1] op_sel_hi:[1,0,1]
    v_pk_fma_f32 v[10:11], v[10:11], v[170:171], v[170:171] op_sel:[0,0,1] op_sel_hi:[1,0,1]
    v_pk_fma_f32 v[12:13], v[12:13], v[170:171], v[170:171] op_sel:[0,0,1] op_sel_hi:[1,0,1]
    v_pk_fma_f32 v[14:15], v[14:15], v[170:171], v[170:171] op_sel:[0,0,1] op_sel_hi:[1,0,1]
    v_pk_fma_f32 v[16:17], v[16:17], v[170:171], v[170:171] op_sel:[0,0,1] op_sel_hi:[1,0,1]
    v_pk_fma_f32 v[18:19], v[18:19], v[170:171], v[170:171] op_sel:[0,0,1] op_sel_hi:[1,0,1]
    v_pk_fma_f32 v[20:21], v[20:21], v[170:171], v[170:171] op_sel:[0,0,1] op_sel_hi:[1,0,1]
    v_pk_fma_f32 v[22:23], v[22:23], v[170:171], v[170:171] op_sel:[0,0,1] op_sel_hi:[1,0,1]
    v_pk_fma_f32 v[24:25], v[24:25], v[170:171], v[170:171] op_sel:[0,0,1] op_sel_hi:[1,0,1]
    v_pk_fma_f32 v[26:27], v[26:27], v[170:171], v[170:171] op_sel:[0,0,1] op_sel_hi:[1,0,1]
    v_pk_fma_f32 v[28:29], v[28:29], v[170:171], v[170:171] op_sel:[0,0,1] op_sel_hi:[1,0,1]
    v_pk_fma_f32 v[30:31], v[30:31], v[170:171], v[170:171] op_sel:[0,0,1] op_sel_hi:[1,0,1]
    v_pk_fma_f32 v[32:33], v[32:33], v[170:171], v[170:171] op_sel:[0,0,1] op_sel_hi:[1,0,1]
    v_pk_fma_f32 v[34:35], v[34:35], v[170:171], v[170:171] op_sel:[0,0,1] op_sel_hi:[1,0,1]
    v_pk_fma_f32 v[36:37], v[36:37], v[170:171], v[170:171] op_sel:[0,0,1] op_sel_hi:[1,0,1]
    v_pk_fma_f32 v[38:39], v[38:39], v[170:171], v[170:171] op_sel:[0,0,1] op_sel_hi:[1,0,1]
    v_pk_fma_f32 v[40:41], v[40:41], v[170:171], v[170:171] op_sel:[0,0,1] op_sel_hi:[1,0,1]
    v_pk_fma_f32 v[42:43], v[42:43], v[170:171], v[170:171] op_sel:[0,0,1] op_sel_hi:[1,0,1]
    v_pk_fma_f32 v[44:45], v[44:45], v[170:171], v[170:171] op_sel:[0,0,1] op_sel_hi:[1,0,1]
    v_pk_fma_f32 v[46:47], v[46:47], v[170:171], v[170:171] op_sel:[0,0,1] op_sel_hi:[1,0,1]
    v_pk_fma_f32 v[48:49], v[48:49], v[170:171], v[170:171] op_sel:[0,0,1] op_sel_hi:[1,0,1]
    v_pk_fma_f32 v[50:51], v[50:51], v[170:171], v[170:171] op_sel:[0,0,1] op_sel_hi:[1,0,1]
    v_pk_fma_f32 v[52:53], v[52:53], v[170:171], v[170:171] op_sel:[0,0,1] op_sel_hi:[1,0,1]
    v_pk_fma_f32 v[54:55], v[54:55], v[170:171], v[170:171] op_sel:[0,0,1] op_sel_hi:[1,0,1]
    v_pk_fma_f32 v[56:57], v[56:57], v[170:171], v[170:171] op_sel:[0,0,1] op_sel_hi:[1,0,1]
    v_pk_fma_f32 v[58:59], v[58:59], v[170:171], v[170:171] op_sel:[0,0,1] op_sel_hi:[1,0,1]
    v_pk_fma_f32 v[60:61], v[60:61], v[170:171], v[170:171] op_sel:[0,0,1] op_sel_hi:[1,0,1]
    v_pk_fma_f32 v[62:63], v[62:63], v[170:171], v[170:171] op_sel:[0,0,1] op_sel_hi:[1,0,1]
    v_pk_fma_f32 v[64:65], v[64:65], v[170:171], v[170:171] op_sel:[0,0,1] op_sel_hi:[1,0,1]
    v_pk_fma_f32 v[66:67], v[66:67], v[170:171], v[170:171] op_sel:[0,0,1] op_sel_hi:[1,0,1]
    v_pk_fma_f32 v[68:69], v[68:69], v[170:171], v[170:171] op_sel:[0,0,1] op_sel_hi:[1,0,1]
L_padH0:
    s_cmp_lg_u32 s3, 0
    s_cbranch_scc1 L_padH4
    v_pk_fma_f32 v[70:71], v[70:71], v[170:171], v[170:171] op_sel:[0,0,1] op_sel_hi:[1,0,1]
    v_pk_fma_f32 v[72:73], v[72:73], v[170:171], v[170:171] op_sel:[0,0,1] op_sel_hi:[1,0,1]
    v_pk_fma_f32 v[74:75], v[74:75], v[170:171], v[170:171] op_sel:[0,0,1] op_sel_hi:[1,0,1]
    v_pk_fma_f32 v[76:77], v[76:77], v[170:171], v[170:171] op_sel:[0,0,1] op_sel_hi:[1,0,1]
    v_pk_fma_f32 v[78:79], v[78:79], v[170:171], v[170:171] op_sel:[0,0,1] op_sel_hi:[1,0,1]
    v_pk_fma_f32 v[80:81], v[80:81], v[170:171], v[170:171] op_sel:[0,0,1] op_sel_hi:[1,0,1]
    v_pk_fma_f32 v[82:83], v[82:83], v[170:171], v[170:171] op_sel:[0,0,1] op_sel_hi:[1,0,1]
    v_cvt_pk_bf16_f32 v84, v4, v5
    v_cvt_pk_bf16_f32 v85, v6, v7
    v_cvt_pk_bf16_f32 v86, v8, v9
    v_cvt_pk_bf16_f32 v87, v10, v11
    v_cvt_pk_bf16_f32 v88, v12, v13
    v_cvt_pk_bf16_f32 v89, v14, v15
    v_cvt_pk_bf16_f32 v90, v16, v17
    v_cvt_pk_bf16_f32 v91, v18, v19
    v_cvt_pk_bf16_f32 v92, v20, v21
    v_cvt_pk_bf16_f32 v93, v22, v23
    v_cvt_pk_bf16_f32 v94, v24, v25
    v_cvt_pk_bf16_f32 v95, v26, v27
    v_cvt_pk_bf16_f32 v96, v28, v29
    v_cvt_pk_bf16_f32 v97, v30, v31
    v_cvt_pk_bf16_f32 v98, v32, v33
    v_cvt_pk_bf16_f32 v99, v34, v35
    v_cvt_pk_bf16_f32 v100, v36, v37
    v_cvt_pk_bf16_f32 v101, v38, v39
    v_cvt_pk_bf16_f32 v102, v40, v41
    v_cvt_pk_bf16_f32 v103, v42, v43
    v_cvt_pk_bf16_f32 v104, v44, v45
    v_cvt_pk_bf16_f32 v105, v46, v47
    v_cvt_pk_bf16_f32 v106, v48, v49
    v_cvt_pk_bf16_f32 v107, v50, v51
    v_cvt_pk_bf16_f32 v108, v52, v53
    v_cvt_pk_bf16_f32 v109, v54, v55
    v_cvt_pk_bf16_f32 v110, v56, v57
    v_cvt_pk_bf16_f32 v111, v58, v59
    v_cvt_pk_bf16_f32 v112, v60, v61
    v_cvt_pk_bf16_f32 v113, v62, v63
    v_cvt_pk_bf16_f32 v114, v64, v65
    v_cvt_pk_bf16_f32 v115, v66, v67
    v_cvt_pk_bf16_f32 v116, v68, v69
    v_cvt_pk_bf16_f32 v117, v70, v71
    v_cvt_pk_bf16_f32 v118, v72, v73
    v_cvt_pk_bf16_f32 v119, v74, v75
    v_cvt_pk_bf16_f32 v120, v76, v77
    v_cvt_pk_bf16_f32 v121, v78, v79
    v_cvt_pk_bf16_f32 v122, v80, v81
    v_cvt_pk_bf16_f32 v123, v82, v83
    ds_write_b128 v163, v[84:87] offset:0
    ds_write_b128 v163, v[88:91] offset:128
    ds_write_b128 v163, v[92:95] offset:256
    ds_write_b128 v163, v[96:99] offset:384
    ds_write_b128 v163, v[100:103] offset:512
    ds_write_b128 v163, v[104:107] offset:640
    ds_write_b128 v163, v[108:111] offset:768
    ds_write_b128 v163, v[112:115] offset:896
    ds_write_b128 v163, v[116:119] offset:1024
    ds_write_b128 v163, v[120:123] offset:1152
    v_xor_b32 v76, 0, v156
    v_xor_b32 v77, 32, v156
    v_xor_b32_e64 v78, 64, v156
    v_xor_b32 v79, 96, v156
    v_xor_b32 v80, 128, v156
    v_xor_b32 v81, 160, v156
    v_xor_b32 v82, 192, v156
    v_xor_b32 v83, 224, v156
    s_waitcnt lgkmcnt(0)
    s_barrier
    ds_read_b64_tr_b16 v[84:85], v159 offset:0
    ds_read_b64_tr_b16 v[86:87], v159 offset:1296
    ds_read_b64_tr_b16 v[88:89], v159 offset:128
    ds_read_b64_tr_b16 v[90:91], v159 offset:1424
    ds_read_b64_tr_b16 v[92:93], v159 offset:256
    ds_read_b64_tr_b16 v[94:95], v159 offset:1552
    ds_read_b64_tr_b16 v[96:97], v159 offset:384
    ds_read_b64_tr_b16 v[98:99], v159 offset:1680
    ds_read_b64_tr_b16 v[100:101], v159 offset:512
    ds_read_b64_tr_b16 v[102:103], v159 offset:1808
    ds_read_b64_tr_b16 v[104:105], v159 offset:640
    ds_read_b64_tr_b16 v[106:107], v159 offset:1936
    ds_read_b64_tr_b16 v[108:109], v159 offset:768
    ds_read_b64_tr_b16 v[110:111], v159 offset:2064
    ds_read_b64_tr_b16 v[112:113], v159 offset:896
    ds_read_b64_tr_b16 v[114:115], v159 offset:2192
    ds_read_b64_tr_b16 v[116:117], v159 offset:1024
    ds_read_b64_tr_b16 v[118:119], v159 offset:2320
    ds_read_b64_tr_b16 v[120:121], v159 offset:1152
    ds_read_b64_tr_b16 v[122:123], v159 offset:2448
    s_mul_i32 s62, s54, 1536
    s_add_u32 s62, s62, 40960
    v_and_b32 v244, 31, v255
    v_lshrrev_b32 v245, 5, v255
    v_lshlrev_b32 v231, 4, v244
    v_lshl_add_u32 v231, v245, 3, v231
    v_add_u32 v231, s62, v231
    v_cmp_eq_u32 vcc, 0, v245
    s_waitcnt lgkmcnt(0)
    v_lshlrev_b32 v232, 3, v244
    v_add_u32 v232, 512, v232
    v_lshlrev_b32 v233, 2, v244
    v_add_u32 v233, 768, v233
    v_cndmask_b32 v232, v233, v232, vcc
    v_add_u32 v232, s62, v232
    v_mul_u32_u24 v233, 124, v245
    v_add3_u32 v233, v232, v233, 4
    v_lshlrev_b32 v234, 1, v244
    v_lshl_add_u32 v234, v245, 8, v234
    buffer_store_dwordx2 v[172:173], v162, s[40:43], s93 offen sc1
    v_add_u32 v234, s62, v234
    v_cmp_gt_u32 vcc, 32, v0
    s_movk_i32 s61, 0x202
    v_lshl_add_u32 v244, v0, 3, 0
    v_lshl_add_u32 v245, v0, 3, 1
    v_cvt_f32_u32 v246, v244
    v_cvt_f32_u32 v247, v245
    v_cvt_pk_bf16_f32 v246, v246, v247
    v_lshrrev_b32_e64 v247, 16, v246
    v_and_b32 v246, 0xffff, v246
    v_subrev_u32 v246, 17024, v246
    buffer_store_dwordx4 v[84:87], v160, s[40:43], s25 offen sc1
    v_subrev_u32 v247, 17024, v247
    v_cndmask_b32 v244, v246, v244, vcc
    v_cndmask_b32 v245, v247, v245, vcc
    v_and_b32 v248, -2, v244
    v_lshlrev_b32 v224, 1, v248
    v_add_u32 v224, 40960, v224
    v_sub_u32 v244, v244, v248
    v_sub_u32 v245, v245, v248
    v_lshl_add_u32 v244, v245, 16, v244
    s_add_u32 s25, s25, 262144
    v_mul_lo_u32 v244, v244, s61
    buffer_store_dwordx4 v[88:91], v160, s[40:43], s25 offen sc1
    v_add_u32 v227, 0x01000100, v244
    v_lshl_add_u32 v244, v0, 3, 2
    v_lshl_add_u32 v245, v0, 3, 3
    v_cvt_f32_u32 v246, v244
    v_cvt_f32_u32 v247, v245
    v_cvt_pk_bf16_f32 v246, v246, v247
    v_lshrrev_b32_e64 v247, 16, v246
    v_and_b32 v246, 0xffff, v246
    v_subrev_u32 v246, 17024, v246
    s_add_u32 s25, s25, 262144
    v_subrev_u32 v247, 17024, v247
    buffer_store_dwordx4 v[92:95], v160, s[40:43], s25 offen sc1
    v_cndmask_b32 v244, v246, v244, vcc
    v_cndmask_b32 v245, v247, v245, vcc
    v_sub_u32 v244, v244, v248
    v_sub_u32 v245, v245, v248
    v_lshl_add_u32 v244, v245, 16, v244
    v_mul_lo_u32 v244, v244, s61
    v_add_u32 v228, 0x01000100, v244
    v_lshl_add_u32 v244, v0, 3, 4
    v_lshl_add_u32 v245, v0, 3, 5
    s_add_u32 s25, s25, 262144
    v_cvt_f32_u32 v246, v244
    buffer_store_dwordx4 v[96:99], v160, s[40:43], s25 offen sc1
    v_cvt_f32_u32 v247, v245
    v_cvt_pk_bf16_f32 v246, v246, v247
    v_lshrrev_b32_e64 v247, 16, v246
    v_and_b32 v246, 0xffff, v246
    v_subrev_u32 v246, 17024, v246
    v_subrev_u32 v247, 17024, v247
    v_cndmask_b32 v244, v246, v244, vcc
    v_cndmask_b32 v245, v247, v245, vcc
    v_and_b32 v248, -2, v244
    s_add_u32 s25, s25, 262144
    v_lshlrev_b32 v225, 1, v248
    buffer_store_dwordx4 v[100:103], v160, s[40:43], s25 offen sc1
    v_add_u32 v225, 40960, v225
    v_sub_u32 v244, v244, v248
    v_sub_u32 v245, v245, v248
    v_lshl_add_u32 v244, v245, 16, v244
    v_mul_lo_u32 v244, v244, s61
    v_add_u32 v229, 0x01000100, v244
    v_lshl_add_u32 v244, v0, 3, 6
    v_lshl_add_u32 v245, v0, 3, 7
    v_cvt_f32_u32 v246, v244
    s_add_u32 s25, s25, 262144
    v_cvt_f32_u32 v247, v245
    buffer_store_dwordx4 v[104:107], v160, s[40:43], s25 offen sc1
    v_cvt_pk_bf16_f32 v246, v246, v247
    v_lshrrev_b32_e64 v247, 16, v246
    v_and_b32 v246, 0xffff, v246
    v_subrev_u32 v246, 17024, v246
    v_subrev_u32 v247, 17024, v247
    v_cndmask_b32 v244, v246, v244, vcc
    v_cndmask_b32 v245, v247, v245, vcc
    v_sub_u32 v244, v244, v248
    v_sub_u32 v245, v245, v248
    s_add_u32 s25, s25, 262144
    v_lshl_add_u32 v244, v245, 16, v244
    buffer_store_dwordx4 v[108:111], v160, s[40:43], s25 offen sc1
    v_mul_lo_u32 v244, v244, s61
    v_add_u32 v230, 0x01000100, v244
    s_lshr_b32 s57, s54, 1
    s_mul_i32 s57, s57, 63488
    s_add_u32 s57, s57, 51200
    s_and_b32 s58, s54, 1
    s_mul_i32 s61, s58, 8656
    s_add_u32 s61, s61, s57
    s_add_u32 s61, s61, 8832
    s_mul_i32 s62, s58, 4224
    s_add_u32 s62, s62, s57
    s_add_u32 s62, s62, 128
    s_sub_u32 s61, s61, 384
    v_lshl_add_u32 v220, v255, 3, s61
    s_sub_u32 s61, s61, 384
    v_lshl_add_u32 v244, v255, 4, s61
    v_cmp_lt_u32 vcc, 47, v255
    s_sub_u32 s62, s62, 448
    v_mov_b32 v246, 262144
    v_cndmask_b32 v220, v220, v244, vcc
    v_lshl_add_u32 v244, v255, 3, s62
    v_cmp_lt_u32 vcc, 51, v255
    s_nop 0
    s_nop 0
    v_cndmask_b32 v220, v220, v244, vcc
    v_cmp_lt_u32 vcc, 55, v255
    s_nop 0
    s_nop 0
    v_cndmask_b32 v220, v220, v246, vcc
    s_add_u32 s25, s25, 262144
    v_and_b32_e64 v244, 1, v255
    buffer_store_dwordx4 v[112:115], v160, s[40:43], s25 offen sc1
    v_mul_u32_u24 v221, 8656, v244
    v_bfe_u32 v244, v255, 1, 1
    v_mul_u32_u24 v244, 63488, v244
    v_add_u32 v221, v221, v244
    v_lshrrev_b32 v244, 2, v255
    v_lshl_add_u32 v221, v244, 5, v221
    s_lshl_b32 s57, s54, 11
    s_add_u32 s57, s57, 60032
    v_add_u32 v221, s57, v221
    v_lshlrev_b32_e64 v222, 4, v0
    v_add_u32 v223, 114816, v222
    s_add_u32 s25, s25, 262144
    buffer_store_dwordx4 v[116:119], v160, s[40:43], s25 offen sc1
    s_add_u32 s25, s25, 262144
    buffer_store_dwordx4 v[120:123], v160, s[40:43], s25 offen sc1
    s_waitcnt vmcnt(11)
    s_nop 0
    ds_read_b64_tr_b16 a[32:33], v76
    ds_read_b64_tr_b16 a[34:35], v76 offset:4096
    ds_read_b64_tr_b16 a[36:37], v77
    ds_read_b64_tr_b16 a[38:39], v77 offset:4096
    ds_read_b64_tr_b16 a[40:41], v78
    ds_read_b64_tr_b16 a[42:43], v78 offset:4096
    ds_read_b64_tr_b16 a[44:45], v79
    ds_read_b64_tr_b16 a[46:47], v79 offset:4096
    ds_read_b64_tr_b16 a[48:49], v80
    ds_read_b64_tr_b16 a[50:51], v80 offset:4096
    ds_read_b64_tr_b16 a[52:53], v81
    ds_read_b64_tr_b16 a[54:55], v81 offset:4096
    ds_read_b64_tr_b16 a[56:57], v82
    ds_read_b64_tr_b16 a[58:59], v82 offset:4096
    ds_read_b64_tr_b16 a[60:61], v83
    ds_read_b64_tr_b16 a[62:63], v83 offset:4096
    v_add_u32 v222, 51328, v222
    v_lshrrev_b32 v246, 1, v254
    v_and_b32 v247, 1, v255
    v_lshlrev_b32 v247, 4, v247
    v_mov_b32 v248, 0x3f80
    v_lshlrev_b32 v248, v247, v248
    v_cmp_eq_u32 vcc, 0, v246
    s_nop 1
    v_cndmask_b32 v20, 0, v248, vcc
    v_cmp_eq_u32 vcc, 1, v246
    s_nop 1
    v_cndmask_b32 v21, 0, v248, vcc
    s_waitcnt lgkmcnt(0)
    v_cmp_eq_u32 vcc, 2, v246
    s_nop 1
    v_cndmask_b32 v22, 0, v248, vcc
    v_cmp_eq_u32 vcc, 3, v246
    s_nop 1
    v_cndmask_b32 v23, 0, v248, vcc
    s_lshl_b32 s71, s65, 2
    s_add_u32 s71, s71, s54
    s_lshl_b32 s71, s71, 10
    s_add_u32 s71, s71, 262144
    s_mul_i32 s72, s65, 196608
    s_mul_i32 s61, s54, 12288
    s_add_u32 s72, s72, s61
    s_add_u32 s72, s72, 9437184
    s_movk_i32 s73, 4096
    s_movk_i32 s74, 8192
    s_add_u32 s61, s54, s66
    s_lshl_b32 s61, s61, 3
    s_lshr_b32 s61, 0xe4b47239, s61
    s_bfe_u32 s75, s61, 0x20000
    s_bfe_u32 s76, s61, 0x20002
    s_bfe_u32 s77, s61, 0x20004
    s_bfe_u32 s78, s61, 0x20006
    v_lshrrev_b32 v238, 3, v255
    v_min_u32 v238, 5, v238
    v_lshlrev_b32 v238, 7, v238
    v_lshlrev_b32 v235, 5, v0
    v_cmp_gt_u32 vcc, 8, v0
    v_add_u32 v236, 16128, v235
    buffer_store_dwordx4 a[32:35], v252, s[40:43], s28 offen sc1
    v_mov_b32 v246, 262144
    v_cndmask_b32 v236, v236, v246, vcc
    v_lshrrev_b32 v247, 3, v0
    v_and_b32_e64 v246, 7, v0
    v_mul_u32_u24 v247, 81920, v247
    v_lshl_add_u32 v237, v246, 4, v247
    s_mul_i32 s61, s75, 49152
    s_add_u32 s61, s61, s72
    v_add_u32 v239, s61, v252
    s_mov_b32 s68, 1073741824
    v_and_b32 v244, 31, v255
    v_lshrrev_b32_e64 v245, 5, v255
    v_mul_u32_u24 v148, 272, v244
    buffer_store_dwordx4 a[36:39], v252, s[40:43], s29 offen sc1
    v_lshl_add_u32 v148, v245, 4, v148
    v_add_u32 v148, s70, v148
    v_mul_f32 v144, 0x3fb8aa3b, v144
    v_exp_f32 v144, v144
    s_nop 0
    v_cvt_pk_bf16_f32 v144, v144, v144
    v_lshlrev_b32 v144, 16, v144
    v_mul_f32 v145, 0x3fb8aa3b, v144
    v_mul_f32 v146, 0x3e22f983, v144
    v_mul_f32 v124, v124, v145
    v_mul_f32_e64 v125, v125, v146
    buffer_store_dwordx4 a[40:43], v252, s[40:43], s30 offen sc1
    v_mul_f32 v196, 0x41000000, v124
    v_mul_f32 v197, 0x41000000, v125
    v_exp_f32 v196, v196
    v_fract_f32 v197, v197
    v_cos_f32 v198, v197
    v_sin_f32 v199, v197
    v_mul_f32 v126, v126, v144
    v_mul_f32 v166, v196, v198
    v_mul_f32 v167, v196, v199
    v_exp_f32 v196, v124
    buffer_store_dwordx4 a[44:47], v252, s[40:43], s31 offen sc1
    v_fract_f32 v197, v125
    v_cos_f32 v198, v197
    v_sin_f32 v199, v197
    v_mul_f32 v127, v127, v144
    v_mul_f32 v164, v196, v198
    v_mul_f32 v165, v196, v199
    v_mul_f32 v196, 0x43800000, v124
    v_mul_f32 v197, 0x43800000, v125
    v_exp_f32 v196, v196
    v_fract_f32 v197, v197
    buffer_store_dwordx4 a[48:51], v252, s[40:43], s32 offen sc1
    v_cos_f32 v198, v197
    v_sin_f32 v199, v197
    v_mul_f32 v170, v128, v126
    v_mul_f32 v168, v196, v198
    v_mul_f32 v169, v196, v199
    v_mul_f32 v171, v128, v127
    v_fma_f32 v170, -v129, v127, v170
    v_fma_f32 v171, v129, v126, v171
    v_mov_b32 v188, 0x3f80
    v_cvt_pk_bf16_f32 v189, v166, v167
    buffer_store_dwordx4 a[52:55], v252, s[40:43], s33 offen sc1
    v_pk_mul_f32 v[174:175], v[166:167], v[166:167] op_sel_hi:[1,0]
    v_pk_fma_f32 v[174:175], v[166:167], v[166:167], v[174:175] op_sel:[1,1,0] op_sel_hi:[0,1,1] neg_lo:[1,0,0]
    v_cvt_pk_bf16_f32 v190, v174, v175
    v_pk_mul_f32 v[176:177], v[174:175], v[166:167] op_sel_hi:[1,0]
    v_pk_fma_f32 v[176:177], v[174:175], v[166:167], v[176:177] op_sel:[1,1,0] op_sel_hi:[0,1,1] neg_lo:[1,0,0]
    v_cvt_pk_bf16_f32 v191, v176, v177
    v_pk_mul_f32 v[174:175], v[176:177], v[166:167] op_sel_hi:[1,0]
    v_pk_fma_f32 v[174:175], v[176:177], v[166:167], v[174:175] op_sel:[1,1,0] op_sel_hi:[0,1,1] neg_lo:[1,0,0]
    v_cvt_pk_bf16_f32 v192, v174, v175
    v_pk_mul_f32 v[176:177], v[174:175], v[166:167] op_sel_hi:[1,0]
    buffer_store_dwordx4 a[56:59], v252, s[40:43], s34 offen sc1
    v_pk_fma_f32 v[176:177], v[174:175], v[166:167], v[176:177] op_sel:[1,1,0] op_sel_hi:[0,1,1] neg_lo:[1,0,0]
    v_cvt_pk_bf16_f32 v193, v176, v177
    v_pk_mul_f32 v[174:175], v[176:177], v[166:167] op_sel_hi:[1,0]
    v_pk_fma_f32 v[174:175], v[176:177], v[166:167], v[174:175] op_sel:[1,1,0] op_sel_hi:[0,1,1] neg_lo:[1,0,0]
    v_cvt_pk_bf16_f32 v194, v174, v175
    v_pk_mul_f32 v[176:177], v[174:175], v[166:167] op_sel_hi:[1,0]
    v_pk_fma_f32 v[176:177], v[174:175], v[166:167], v[176:177] op_sel:[1,1,0] op_sel_hi:[0,1,1] neg_lo:[1,0,0]
    s_and_b32 m0, s70, 0xffff
    v_cvt_pk_bf16_f32 v195, v176, v177
    ds_write_addtid_b32 v188 offset:0
    ds_write_addtid_b32 v189 offset:272
    buffer_store_dwordx4 a[60:63], v252, s[40:43], s35 offen sc1
    ds_write_addtid_b32 v190 offset:544
    ds_write_addtid_b32 v191 offset:816
    ds_write_addtid_b32 v192 offset:1088
    ds_write_addtid_b32 v193 offset:1360
    ds_write_addtid_b32 v194 offset:1632
    ds_write_addtid_b32 v195 offset:1904
    v_pk_mul_f32 v[174:175], v[176:177], v[166:167] op_sel_hi:[1,0]
    v_pk_fma_f32 v[174:175], v[176:177], v[166:167], v[174:175] op_sel:[1,1,0] op_sel_hi:[0,1,1] neg_lo:[1,0,0]
    v_cvt_pk_bf16_f32 v188, v174, v175
    v_pk_mul_f32 v[176:177], v[174:175], v[166:167] op_sel_hi:[1,0]
    v_pk_fma_f32 v[176:177], v[174:175], v[166:167], v[176:177] op_sel:[1,1,0] op_sel_hi:[0,1,1] neg_lo:[1,0,0]
    v_cvt_pk_bf16_f32 v189, v176, v177
    v_pk_mul_f32 v[174:175], v[176:177], v[166:167] op_sel_hi:[1,0]
    v_pk_fma_f32 v[174:175], v[176:177], v[166:167], v[174:175] op_sel:[1,1,0] op_sel_hi:[0,1,1] neg_lo:[1,0,0]
    v_cvt_pk_bf16_f32 v190, v174, v175
    s_add_u32 s24, s24, 122880
    v_pk_mul_f32 v[176:177], v[174:175], v[166:167] op_sel_hi:[1,0]
    buffer_load_dwordx4 a[96:99], v151, s[88:91], s24 offen
    v_pk_fma_f32 v[176:177], v[174:175], v[166:167], v[176:177] op_sel:[1,1,0] op_sel_hi:[0,1,1] neg_lo:[1,0,0]
    v_cvt_pk_bf16_f32 v191, v176, v177
    v_pk_mul_f32 v[174:175], v[176:177], v[166:167] op_sel_hi:[1,0]
    v_pk_fma_f32 v[174:175], v[176:177], v[166:167], v[174:175] op_sel:[1,1,0] op_sel_hi:[0,1,1] neg_lo:[1,0,0]
    v_cvt_pk_bf16_f32 v192, v174, v175
    v_pk_mul_f32 v[176:177], v[174:175], v[166:167] op_sel_hi:[1,0]
    v_pk_fma_f32 v[176:177], v[174:175], v[166:167], v[176:177] op_sel:[1,1,0] op_sel_hi:[0,1,1] neg_lo:[1,0,0]
    v_cvt_pk_bf16_f32 v193, v176, v177
    v_pk_mul_f32 v[174:175], v[176:177], v[166:167] op_sel_hi:[1,0]
    s_add_u32 s24, s24, 122880
    v_pk_fma_f32 v[174:175], v[176:177], v[166:167], v[174:175] op_sel:[1,1,0] op_sel_hi:[0,1,1] neg_lo:[1,0,0]
    buffer_load_dwordx4 a[100:103], v151, s[88:91], s24 offen
    v_cvt_pk_bf16_f32 v194, v174, v175
    v_pk_mul_f32 v[176:177], v[174:175], v[166:167] op_sel_hi:[1,0]
    v_pk_fma_f32 v[176:177], v[174:175], v[166:167], v[176:177] op_sel:[1,1,0] op_sel_hi:[0,1,1] neg_lo:[1,0,0]
    v_cvt_pk_bf16_f32 v195, v176, v177
    ds_write_addtid_b32 v188 offset:2176
    ds_write_addtid_b32 v189 offset:2448
    ds_write_addtid_b32 v190 offset:2720
    ds_write_addtid_b32 v191 offset:2992
    ds_write_addtid_b32 v192 offset:3264
    ds_write_addtid_b32 v193 offset:3536
    ds_write_addtid_b32 v194 offset:3808
    ds_write_addtid_b32 v195 offset:4080
    v_pk_mul_f32 v[174:175], v[176:177], v[166:167] op_sel_hi:[1,0]
    v_pk_fma_f32 v[174:175], v[176:177], v[166:167], v[174:175] op_sel:[1,1,0] op_sel_hi:[0,1,1] neg_lo:[1,0,0]
    v_cvt_pk_bf16_f32 v188, v174, v175
    v_pk_mul_f32 v[176:177], v[174:175], v[166:167] op_sel_hi:[1,0]
    v_pk_fma_f32 v[176:177], v[174:175], v[166:167], v[176:177] op_sel:[1,1,0] op_sel_hi:[0,1,1] neg_lo:[1,0,0]
    s_add_u32 s24, s24, 122880
    v_cvt_pk_bf16_f32 v189, v176, v177
    buffer_load_dwordx4 a[104:107], v151, s[88:91], s24 offen
    v_pk_mul_f32 v[174:175], v[176:177], v[166:167] op_sel_hi:[1,0]
    v_pk_fma_f32 v[174:175], v[176:177], v[166:167], v[174:175] op_sel:[1,1,0] op_sel_hi:[0,1,1] neg_lo:[1,0,0]
    v_cvt_pk_bf16_f32 v190, v174, v175
    v_pk_mul_f32 v[176:177], v[174:175], v[166:167] op_sel_hi:[1,0]
    v_pk_fma_f32 v[176:177], v[174:175], v[166:167], v[176:177] op_sel:[1,1,0] op_sel_hi:[0,1,1] neg_lo:[1,0,0]
    v_cvt_pk_bf16_f32 v191, v176, v177
    v_pk_mul_f32 v[174:175], v[176:177], v[166:167] op_sel_hi:[1,0]
    v_pk_fma_f32 v[174:175], v[176:177], v[166:167], v[174:175] op_sel:[1,1,0] op_sel_hi:[0,1,1] neg_lo:[1,0,0]
    v_cvt_pk_bf16_f32 v192, v174, v175
    s_add_u32 s24, s24, 122880
    v_pk_mul_f32 v[176:177], v[174:175], v[166:167] op_sel_hi:[1,0]
    buffer_load_dwordx4 a[108:111], v151, s[88:91], s24 offen
    v_pk_fma_f32 v[176:177], v[174:175], v[166:167], v[176:177] op_sel:[1,1,0] op_sel_hi:[0,1,1] neg_lo:[1,0,0]
    v_cvt_pk_bf16_f32 v193, v176, v177
    v_pk_mul_f32 v[174:175], v[176:177], v[166:167] op_sel_hi:[1,0]
    v_pk_fma_f32 v[174:175], v[176:177], v[166:167], v[174:175] op_sel:[1,1,0] op_sel_hi:[0,1,1] neg_lo:[1,0,0]
    v_cvt_pk_bf16_f32 v194, v174, v175
    v_pk_mul_f32 v[176:177], v[174:175], v[166:167] op_sel_hi:[1,0]
    v_pk_fma_f32 v[176:177], v[174:175], v[166:167], v[176:177] op_sel:[1,1,0] op_sel_hi:[0,1,1] neg_lo:[1,0,0]
    v_cvt_pk_bf16_f32 v195, v176, v177
    ds_write_addtid_b32 v188 offset:4352
    ds_write_addtid_b32 v189 offset:4624
    ds_write_addtid_b32 v190 offset:4896
    ds_write_addtid_b32 v191 offset:5168
    ds_write_addtid_b32 v192 offset:5440
    ds_write_addtid_b32 v193 offset:5712
    ds_write_addtid_b32 v194 offset:5984
    ds_write_addtid_b32 v195 offset:6256
    v_pk_mul_f32 v[174:175], v[176:177], v[166:167] op_sel_hi:[1,0]
    s_add_u32 s24, s24, 122880
    v_pk_fma_f32 v[174:175], v[176:177], v[166:167], v[174:175] op_sel:[1,1,0] op_sel_hi:[0,1,1] neg_lo:[1,0,0]
    buffer_load_dwordx4 a[112:115], v151, s[88:91], s24 offen
    v_cvt_pk_bf16_f32 v188, v174, v175
    v_pk_mul_f32 v[176:177], v[174:175], v[166:167] op_sel_hi:[1,0]
    v_pk_fma_f32 v[176:177], v[174:175], v[166:167], v[176:177] op_sel:[1,1,0] op_sel_hi:[0,1,1] neg_lo:[1,0,0]
    v_cvt_pk_bf16_f32 v189, v176, v177
    v_pk_mul_f32 v[174:175], v[176:177], v[166:167] op_sel_hi:[1,0]
    v_pk_fma_f32 v[174:175], v[176:177], v[166:167], v[174:175] op_sel:[1,1,0] op_sel_hi:[0,1,1] neg_lo:[1,0,0]
    v_cvt_pk_bf16_f32 v190, v174, v175
    v_pk_mul_f32 v[176:177], v[174:175], v[166:167] op_sel_hi:[1,0]
    v_pk_fma_f32 v[176:177], v[174:175], v[166:167], v[176:177] op_sel:[1,1,0] op_sel_hi:[0,1,1] neg_lo:[1,0,0]
    s_sub_u32 s24, s24, 1843200
    v_cvt_pk_bf16_f32 v191, v176, v177
    buffer_load_dwordx4 a[116:119], v151, s[88:91], s24 offen
    v_pk_mul_f32 v[174:175], v[176:177], v[166:167] op_sel_hi:[1,0]
    v_pk_fma_f32 v[174:175], v[176:177], v[166:167], v[174:175] op_sel:[1,1,0] op_sel_hi:[0,1,1] neg_lo:[1,0,0]
    v_cvt_pk_bf16_f32 v192, v174, v175
    v_pk_mul_f32 v[176:177], v[174:175], v[166:167] op_sel_hi:[1,0]
    v_pk_fma_f32 v[176:177], v[174:175], v[166:167], v[176:177] op_sel:[1,1,0] op_sel_hi:[0,1,1] neg_lo:[1,0,0]
    v_cvt_pk_bf16_f32 v193, v176, v177
    v_pk_mul_f32 v[174:175], v[176:177], v[166:167] op_sel_hi:[1,0]
    v_pk_fma_f32 v[174:175], v[176:177], v[166:167], v[174:175] op_sel:[1,1,0] op_sel_hi:[0,1,1] neg_lo:[1,0,0]
    v_cvt_pk_bf16_f32 v194, v174, v175
    s_add_u32 s24, s24, 122880
    v_pk_mul_f32 v[176:177], v[174:175], v[166:167] op_sel_hi:[1,0]
    buffer_load_dwordx4 a[120:123], v151, s[88:91], s24 offen
    v_pk_fma_f32 v[176:177], v[174:175], v[166:167], v[176:177] op_sel:[1,1,0] op_sel_hi:[0,1,1] neg_lo:[1,0,0]
    v_cvt_pk_bf16_f32 v195, v176, v177
    ds_write_addtid_b32 v188 offset:6528
    ds_write_addtid_b32 v189 offset:6800
    ds_write_addtid_b32 v190 offset:7072
    ds_write_addtid_b32 v191 offset:7344
    ds_write_addtid_b32 v192 offset:7616
    ds_write_addtid_b32 v193 offset:7888
    ds_write_addtid_b32 v194 offset:8160
    ds_write_addtid_b32 v195 offset:8432
    ds_read_b128 a[176:179], v148 offset:0
    ds_read_b128 a[180:183], v148 offset:32
    ds_read_b128 a[184:187], v148 offset:64
    ds_read_b128 a[188:191], v148 offset:96
    ds_read_b128 a[192:195], v148 offset:128
    ds_read_b128 a[196:199], v148 offset:160
    ds_read_b128 a[200:203], v148 offset:192
    ds_read_b128 a[204:207], v148 offset:224
    v_cvt_pk_bf16_f32 v188, v170, -v171
    v_pk_mul_f32 v[174:175], v[170:171], v[164:165] op_sel_hi:[1,0]
    v_pk_fma_f32 v[174:175], v[170:171], v[164:165], v[174:175] op_sel:[1,1,0] op_sel_hi:[0,1,1] neg_lo:[1,0,0]
    v_cvt_pk_bf16_f32 v189, v174, -v175
    v_pk_mul_f32 v[182:183], v[174:175], v[164:165] op_sel_hi:[1,0]
    v_pk_fma_f32 v[182:183], v[174:175], v[164:165], v[182:183] op_sel:[1,1,0] op_sel_hi:[0,1,1] neg_lo:[1,0,0]
    v_cvt_pk_bf16_f32 v190, v182, -v183
    s_add_u32 s24, s24, 122880
    v_pk_mul_f32 v[174:175], v[182:183], v[164:165] op_sel_hi:[1,0]
    buffer_load_dwordx4 a[124:127], v151, s[88:91], s24 offen
    v_pk_fma_f32 v[174:175], v[182:183], v[164:165], v[174:175] op_sel:[1,1,0] op_sel_hi:[0,1,1] neg_lo:[1,0,0]
    v_cvt_pk_bf16_f32 v191, v174, -v175
    v_pk_mul_f32 v[184:185], v[174:175], v[164:165] op_sel_hi:[1,0]
    v_pk_fma_f32 v[184:185], v[174:175], v[164:165], v[184:185] op_sel:[1,1,0] op_sel_hi:[0,1,1] neg_lo:[1,0,0]
    v_cvt_pk_bf16_f32 v192, v184, -v185
    v_pk_mul_f32 v[174:175], v[184:185], v[164:165] op_sel_hi:[1,0]
    v_pk_fma_f32 v[174:175], v[184:185], v[164:165], v[174:175] op_sel:[1,1,0] op_sel_hi:[0,1,1] neg_lo:[1,0,0]
    v_cvt_pk_bf16_f32 v193, v174, -v175
    v_pk_mul_f32 v[186:187], v[174:175], v[164:165] op_sel_hi:[1,0]
    v_pk_fma_f32 v[186:187], v[174:175], v[164:165], v[186:187] op_sel:[1,1,0] op_sel_hi:[0,1,1] neg_lo:[1,0,0]
    v_readfirstlane_b32 s57, v142
    v_readfirstlane_b32 s58, v143
    s_mul_i32 s57, s57, 0x9E3779B1
    s_add_u32 s48, s57, 0x7F4A7C15
    s_mul_i32 s58, s58, 0x85EBCA6B
    s_xor_b32 s49, s58, s48
    s_lshl_b32 s57, s55, 3
    s_add_u32 s57, s57, s81
    s_lshl_b32 s57, s57, 7
    s_add_u32 s57, s57, 131072
    s_or_b32 s57, s57, s64
    s_waitcnt vmcnt(8)
    s_barrier
    s_bitcmp1_b32 s57, 30
    s_cbranch_scc1 L_nf2
    s_nop 0
    s_atomic_swap_x2 s[48:49], s[40:41], s57
L_nf2:
    v_cvt_pk_bf16_f32 v194, v186, -v187
    v_pk_mul_f32 v[174:175], v[186:187], v[164:165] op_sel_hi:[1,0]
    v_pk_fma_f32 v[174:175], v[186:187], v[164:165], v[174:175] op_sel:[1,1,0] op_sel_hi:[0,1,1] neg_lo:[1,0,0]
    v_cvt_pk_bf16_f32 v195, v174, -v175
    ds_write_addtid_b32 v188 offset:0
    ds_write_addtid_b32 v189 offset:272
    ds_write_addtid_b32 v190 offset:544
    ds_write_addtid_b32 v191 offset:816
    ds_write_addtid_b32 v192 offset:1088
    ds_write_addtid_b32 v193 offset:1360
    ds_write_addtid_b32 v194 offset:1632
    ds_write_addtid_b32 v195 offset:1904
    v_pk_mul_f32 v[180:181], v[170:171], v[168:169] op_sel_hi:[1,0]
    v_pk_fma_f32 v[180:181], v[170:171], v[168:169], v[180:181] op_sel:[1,1,0] op_sel_hi:[0,1,1] neg_lo:[1,0,0]
    global_load_short_d16_hi v130, v1, s[6:7] offset:128 nt
    v_cvt_pk_bf16_f32 v188, v180, -v181
    v_pk_mul_f32 v[174:175], v[182:183], v[168:169] op_sel_hi:[1,0]
    v_pk_fma_f32 v[174:175], v[182:183], v[168:169], v[174:175] op_sel:[1,1,0] op_sel_hi:[0,1,1] neg_lo:[1,0,0]
    v_cvt_pk_bf16_f32 v189, v174, -v175
    global_load_short_d16_hi v131, v1, s[8:9] offset:128 nt
    v_pk_mul_f32 v[182:183], v[184:185], v[168:169] op_sel_hi:[1,0]
    v_pk_fma_f32 v[182:183], v[184:185], v[168:169], v[182:183] op_sel:[1,1,0] op_sel_hi:[0,1,1] neg_lo:[1,0,0]
    v_cvt_pk_bf16_f32 v190, v182, -v183
    v_pk_mul_f32 v[174:175], v[186:187], v[168:169] op_sel_hi:[1,0]
    global_load_short_d16_hi v132, v1, s[10:11] offset:128 nt
    v_pk_fma_f32 v[174:175], v[186:187], v[168:169], v[174:175] op_sel:[1,1,0] op_sel_hi:[0,1,1] neg_lo:[1,0,0]
    v_cvt_pk_bf16_f32 v191, v174, -v175
    v_pk_mul_f32 v[184:185], v[180:181], v[168:169] op_sel_hi:[1,0]
    v_pk_fma_f32 v[184:185], v[180:181], v[168:169], v[184:185] op_sel:[1,1,0] op_sel_hi:[0,1,1] neg_lo:[1,0,0]
    global_load_short_d16_hi v133, v1, s[12:13] offset:128 nt
    v_cvt_pk_bf16_f32 v192, v184, -v185
    v_pk_mul_f32 v[186:187], v[182:183], v[168:169] op_sel_hi:[1,0]
    v_pk_fma_f32 v[186:187], v[182:183], v[168:169], v[186:187] op_sel:[1,1,0] op_sel_hi:[0,1,1] neg_lo:[1,0,0]
    v_cvt_pk_bf16_f32 v193, v186, -v187
    global_load_short_d16_hi v134, v1, s[14:15] offset:128 nt
    v_pk_mul_f32 v[180:181], v[184:185], v[168:169] op_sel_hi:[1,0]
    v_pk_fma_f32 v[180:181], v[184:185], v[168:169], v[180:181] op_sel:[1,1,0] op_sel_hi:[0,1,1] neg_lo:[1,0,0]
    v_cvt_pk_bf16_f32 v194, v180, -v181
    v_pk_mul_f32 v[174:175], v[186:187], v[168:169] op_sel_hi:[1,0]
    global_load_short_d16_hi v135, v1, s[16:17] offset:128 nt
L_padH1:
    s_cmp_lg_u32 s3, 0
    s_cbranch_scc1 L_padH5
    v_pk_fma_f32 v[174:175], v[186:187], v[168:169], v[174:175] op_sel:[1,1,0] op_sel_hi:[0,1,1] neg_lo:[1,0,0]
    v_cvt_pk_bf16_f32 v195, v174, -v175
    ds_write_addtid_b32 v188 offset:2176
    ds_write_addtid_b32 v189 offset:2448
    ds_write_addtid_b32 v190 offset:2720
    ds_write_addtid_b32 v191 offset:2992
    ds_write_addtid_b32 v192 offset:3264
    ds_write_addtid_b32 v193 offset:3536
    ds_write_addtid_b32 v194 offset:3808
    ds_write_addtid_b32 v195 offset:4080
    v_pk_mul_f32 v[174:175], v[180:181], v[168:169] op_sel_hi:[1,0]
    v_pk_fma_f32 v[174:175], v[180:181], v[168:169], v[174:175] op_sel:[1,1,0] op_sel_hi:[0,1,1] neg_lo:[1,0,0]
    global_load_short_d16_hi v136, v1, s[6:7] offset:256 nt
    v_cvt_pk_bf16_f32 v188, v174, -v175
    v_pk_mul_f32 v[176:177], v[174:175], v[168:169] op_sel_hi:[1,0]
    v_pk_fma_f32 v[176:177], v[174:175], v[168:169], v[176:177] op_sel:[1,1,0] op_sel_hi:[0,1,1] neg_lo:[1,0,0]
    v_cvt_pk_bf16_f32 v189, v176, -v177
    global_load_short_d16_hi v137, v1, s[8:9] offset:256 nt
    v_pk_mul_f32 v[174:175], v[176:177], v[168:169] op_sel_hi:[1,0]
    v_pk_fma_f32 v[174:175], v[176:177], v[168:169], v[174:175] op_sel:[1,1,0] op_sel_hi:[0,1,1] neg_lo:[1,0,0]
    v_cvt_pk_bf16_f32 v190, v174, -v175
    v_pk_mul_f32 v[176:177], v[174:175], v[168:169] op_sel_hi:[1,0]
    global_load_short_d16_hi v138, v1, s[10:11] offset:256 nt
    v_pk_fma_f32 v[176:177], v[174:175], v[168:169], v[176:177] op_sel:[1,1,0] op_sel_hi:[0,1,1] neg_lo:[1,0,0]
    v_cvt_pk_bf16_f32 v191, v176, -v177
    v_pk_mul_f32 v[174:175], v[176:177], v[168:169] op_sel_hi:[1,0]
    v_pk_fma_f32 v[174:175], v[176:177], v[168:169], v[174:175] op_sel:[1,1,0] op_sel_hi:[0,1,1] neg_lo:[1,0,0]
    v_cvt_pk_bf16_f32 v192, v174, -v175
    ds_write_addtid_b32 v188 offset:4352
    ds_write_addtid_b32 v189 offset:4624
    ds_write_addtid_b32 v190 offset:4896
    ds_write_addtid_b32 v191 offset:5168
    ds_write_addtid_b32 v192 offset:5440
    ds_read_b128 a[208:211], v148 offset:0
    ds_read_b128 a[212:215], v148 offset:32
    ds_read_b128 a[216:219], v148 offset:64
    ds_read_b128 a[220:223], v148 offset:96
    ds_read_b128 a[224:227], v148 offset:128
    ds_read_b128 a[228:231], v148 offset:160
    ds_read_b128 a[232:235], v148 offset:192
    ds_read_b128 a[236:239], v148 offset:224
    global_load_short_d16_hi v139, v1, s[12:13] offset:256 nt
    global_load_short_d16_hi v140, v1, s[14:15] offset:256 nt
    global_load_short_d16_hi v141, v1, s[16:17] offset:256 nt
    global_load_short_d16_hi v3, v147, s[20:21]
    s_waitcnt lgkmcnt(7)
    v_mfma_f32_32x32x16_bf16 v[4:19], a[208:211], a[176:179], 0
    s_waitcnt lgkmcnt(6)
    v_mfma_f32_32x32x16_bf16 v[4:19], a[212:215], a[180:183], v[4:19]
    s_waitcnt lgkmcnt(5)
    v_mfma_f32_32x32x16_bf16 v[4:19], a[216:219], a[184:187], v[4:19]
    s_waitcnt lgkmcnt(4)
    v_mfma_f32_32x32x16_bf16 v[4:19], a[220:223], a[188:191], v[4:19]
    s_waitcnt lgkmcnt(3)
    v_mfma_f32_32x32x16_bf16 v[4:19], a[224:227], a[192:195], v[4:19]
    s_waitcnt lgkmcnt(2)
    v_mfma_f32_32x32x16_bf16 v[4:19], a[228:231], a[196:199], v[4:19]
    s_waitcnt lgkmcnt(1)
    v_mfma_f32_32x32x16_bf16 v[4:19], a[232:235], a[200:203], v[4:19]
    s_waitcnt lgkmcnt(0)
    v_mfma_f32_32x32x16_bf16 v[4:19], a[236:239], a[204:207], v[4:19]
    v_mfma_f32_16x16x32_bf16 v[24:27], v[20:23], a[64:67], 0
    v_mfma_f32_16x16x32_bf16 v[24:27], v[20:23], a[68:71], v[24:27]
    v_mfma_f32_16x16x32_bf16 v[24:27], v[20:23], a[72:75], v[24:27]
    v_mfma_f32_16x16x32_bf16 v[24:27], v[20:23], a[76:79], v[24:27]
    v_mfma_f32_16x16x32_bf16 v[24:27], v[20:23], a[80:83], v[24:27]
    v_mfma_f32_16x16x32_bf16 v[24:27], v[20:23], a[84:87], v[24:27]
    v_mfma_f32_16x16x32_bf16 v[24:27], v[20:23], a[88:91], v[24:27]
    v_mfma_f32_16x16x32_bf16 v[24:27], v[20:23], a[92:95], v[24:27]
    s_waitcnt vmcnt(20)
    v_mfma_f32_16x16x32_bf16 v[24:27], v[20:23], a[96:99], v[24:27]
    s_waitcnt vmcnt(19)
    v_mfma_f32_16x16x32_bf16 v[24:27], v[20:23], a[100:103], v[24:27]
    s_waitcnt vmcnt(18)
    v_mfma_f32_16x16x32_bf16 v[24:27], v[20:23], a[104:107], v[24:27]
    s_waitcnt vmcnt(17)
    v_mfma_f32_16x16x32_bf16 v[24:27], v[20:23], a[108:111], v[24:27]
    s_waitcnt vmcnt(16)
    v_mfma_f32_16x16x32_bf16 v[24:27], v[20:23], a[112:115], v[24:27]
    s_waitcnt vmcnt(15)
    v_mfma_f32_16x16x32_bf16 v[24:27], v[20:23], a[116:119], v[24:27]
    s_waitcnt vmcnt(14)
    v_mfma_f32_16x16x32_bf16 v[24:27], v[20:23], a[120:123], v[24:27]
    s_waitcnt vmcnt(13)
    v_mfma_f32_16x16x32_bf16 v[24:27], v[20:23], a[124:127], v[24:27]
    s_waitcnt vmcnt(12)
    v_mul_f32 v130, v130, v145
    s_waitcnt vmcnt(11)
    v_mul_f32 v131, v131, v146
    v_mul_f32 v196, 0x41000000, v130
    v_mul_f32 v197, 0x41000000, v131
    v_exp_f32 v196, v196
    v_fract_f32 v197, v197
    v_cos_f32 v198, v197
    v_sin_f32 v199, v197
    s_waitcnt vmcnt(10)
    v_mul_f32 v132, v132, v144
    v_mul_f32 v166, v196, v198
    v_mul_f32 v167, v196, v199
    v_exp_f32 v196, v130
    v_fract_f32 v197, v131
    v_cos_f32 v198, v197
    v_sin_f32 v199, v197
    s_waitcnt vmcnt(9)
    v_mul_f32 v133, v133, v144
    v_mul_f32 v164, v196, v198
    v_mul_f32 v165, v196, v199
    v_mul_f32 v196, 0x43800000, v130
    v_mul_f32 v197, 0x43800000, v131
    v_exp_f32 v196, v196
    v_fract_f32 v197, v197
    v_cos_f32 v198, v197
    v_sin_f32 v199, v197
    s_waitcnt vmcnt(8)
    v_mul_f32 v170, v134, v132
    v_mul_f32 v168, v196, v198
    v_mul_f32 v169, v196, v199
    v_mul_f32 v171, v134, v133
    s_waitcnt vmcnt(7)
    v_fma_f32 v170, -v135, v133, v170
    v_fma_f32 v171, v135, v132, v171
    v_add_f32_dpp v24, v24, v24 row_ror:8 row_mask:0xf bank_mask:0xf bound_ctrl:0
    v_add_f32_dpp v25, v25, v25 row_ror:8 row_mask:0xf bank_mask:0xf bound_ctrl:0
    v_add_f32_dpp v26, v26, v26 row_ror:8 row_mask:0xf bank_mask:0xf bound_ctrl:0
    v_add_f32_dpp v27, v27, v27 row_ror:8 row_mask:0xf bank_mask:0xf bound_ctrl:0
    buffer_store_dwordx4 v[24:27], v161, s[40:43], s26 offen sc1
    v_add_u32 v92, 0, v224
    v_add_u32 v93, 0, v225
    v_add_u32 v94, 1536, v224
    v_add_u32 v95, 1536, v225
    v_add_u32 v96, 3072, v224
    v_add_u32 v97, 3072, v225
    v_add_u32 v98, 4608, v224
    v_add_u32 v99, 4608, v225
    v_mov_b32 v106, 0
    v_mov_b32 v107, 0
    s_add_u32 s5, s63, s54
    s_lshl_b32 s5, s5, 12
    s_add_u32 s5, s5, 1048576
    s_mov_b32 s4, 131072
    v_lshlrev_b32_e64 v100, 7, v255
    v_mov_b32 v188, 0x3f80
    v_cvt_pk_bf16_f32 v189, v166, v167
    v_pk_mul_f32 v[174:175], v[166:167], v[166:167] op_sel_hi:[1,0]
    v_pk_fma_f32 v[174:175], v[166:167], v[166:167], v[174:175] op_sel:[1,1,0] op_sel_hi:[0,1,1] neg_lo:[1,0,0]
    v_cvt_pk_bf16_f32 v190, v174, v175
    v_pk_mul_f32 v[176:177], v[174:175], v[166:167] op_sel_hi:[1,0]
    v_pk_fma_f32 v[176:177], v[174:175], v[166:167], v[176:177] op_sel:[1,1,0] op_sel_hi:[0,1,1] neg_lo:[1,0,0]
    v_cvt_pk_bf16_f32 v191, v176, v177
    v_pk_mul_f32 v[174:175], v[176:177], v[166:167] op_sel_hi:[1,0]
    v_pk_fma_f32 v[174:175], v[176:177], v[166:167], v[174:175] op_sel:[1,1,0] op_sel_hi:[0,1,1] neg_lo:[1,0,0]
    v_cvt_pk_bf16_f32 v192, v174, v175
    v_pk_mul_f32 v[176:177], v[174:175], v[166:167] op_sel_hi:[1,0]
    v_pk_fma_f32 v[176:177], v[174:175], v[166:167], v[176:177] op_sel:[1,1,0] op_sel_hi:[0,1,1] neg_lo:[1,0,0]
    v_cvt_pk_bf16_f32 v193, v176, v177
    v_pk_mul_f32 v[174:175], v[176:177], v[166:167] op_sel_hi:[1,0]
    v_pk_fma_f32 v[174:175], v[176:177], v[166:167], v[174:175] op_sel:[1,1,0] op_sel_hi:[0,1,1] neg_lo:[1,0,0]
    v_cvt_pk_bf16_f32 v194, v174, v175
    v_pk_mul_f32 v[176:177], v[174:175], v[166:167] op_sel_hi:[1,0]
    v_pk_fma_f32 v[176:177], v[174:175], v[166:167], v[176:177] op_sel:[1,1,0] op_sel_hi:[0,1,1] neg_lo:[1,0,0]
    v_cvt_pk_bf16_f32 v195, v176, v177
    ds_write_addtid_b32 v188 offset:0
    ds_write_addtid_b32 v189 offset:272
    ds_write_addtid_b32 v190 offset:544
    ds_write_addtid_b32 v191 offset:816
    ds_write_addtid_b32 v192 offset:1088
    ds_write_addtid_b32 v193 offset:1360
    ds_write_addtid_b32 v194 offset:1632
    ds_write_addtid_b32 v195 offset:1904
    v_pk_mul_f32 v[174:175], v[176:177], v[166:167] op_sel_hi:[1,0]
    v_pk_fma_f32 v[174:175], v[176:177], v[166:167], v[174:175] op_sel:[1,1,0] op_sel_hi:[0,1,1] neg_lo:[1,0,0]
    v_cvt_pk_bf16_f32 v188, v174, v175
    v_pk_mul_f32 v[176:177], v[174:175], v[166:167] op_sel_hi:[1,0]
    v_pk_fma_f32 v[176:177], v[174:175], v[166:167], v[176:177] op_sel:[1,1,0] op_sel_hi:[0,1,1] neg_lo:[1,0,0]
    v_cvt_pk_bf16_f32 v189, v176, v177
    v_pk_mul_f32 v[174:175], v[176:177], v[166:167] op_sel_hi:[1,0]
    v_pk_fma_f32 v[174:175], v[176:177], v[166:167], v[174:175] op_sel:[1,1,0] op_sel_hi:[0,1,1] neg_lo:[1,0,0]
    v_cvt_pk_bf16_f32 v190, v174, v175
    v_pk_mul_f32 v[176:177], v[174:175], v[166:167] op_sel_hi:[1,0]
    v_pk_fma_f32 v[176:177], v[174:175], v[166:167], v[176:177] op_sel:[1,1,0] op_sel_hi:[0,1,1] neg_lo:[1,0,0]
    v_cvt_pk_bf16_f32 v191, v176, v177
    v_pk_mul_f32 v[174:175], v[176:177], v[166:167] op_sel_hi:[1,0]
    v_pk_fma_f32 v[174:175], v[176:177], v[166:167], v[174:175] op_sel:[1,1,0] op_sel_hi:[0,1,1] neg_lo:[1,0,0]
    v_cvt_pk_bf16_f32 v192, v174, v175
    v_pk_mul_f32 v[176:177], v[174:175], v[166:167] op_sel_hi:[1,0]
    v_pk_fma_f32 v[176:177], v[174:175], v[166:167], v[176:177] op_sel:[1,1,0] op_sel_hi:[0,1,1] neg_lo:[1,0,0]
    v_cvt_pk_bf16_f32 v193, v176, v177
    v_pk_mul_f32 v[174:175], v[176:177], v[166:167] op_sel_hi:[1,0]
    v_pk_fma_f32 v[174:175], v[176:177], v[166:167], v[174:175] op_sel:[1,1,0] op_sel_hi:[0,1,1] neg_lo:[1,0,0]
    v_cvt_pk_bf16_f32 v194, v174, v175
    v_pk_mul_f32 v[176:177], v[174:175], v[166:167] op_sel_hi:[1,0]
    v_pk_fma_f32 v[176:177], v[174:175], v[166:167], v[176:177] op_sel:[1,1,0] op_sel_hi:[0,1,1] neg_lo:[1,0,0]
    v_cvt_pk_bf16_f32 v195, v176, v177
    ds_write_addtid_b32 v188 offset:2176
    ds_write_addtid_b32 v189 offset:2448
    ds_write_addtid_b32 v190 offset:2720
    ds_write_addtid_b32 v191 offset:2992
    ds_write_addtid_b32 v192 offset:3264
    ds_write_addtid_b32 v193 offset:3536
    ds_write_addtid_b32 v194 offset:3808
    ds_write_addtid_b32 v195 offset:4080
    v_pk_mul_f32 v[174:175], v[176:177], v[166:167] op_sel_hi:[1,0]
    v_pk_fma_f32 v[174:175], v[176:177], v[166:167], v[174:175] op_sel:[1,1,0] op_sel_hi:[0,1,1] neg_lo:[1,0,0]
    v_cvt_pk_bf16_f32 v188, v174, v175
    v_pk_mul_f32 v[176:177], v[174:175], v[166:167] op_sel_hi:[1,0]
    v_pk_fma_f32 v[176:177], v[174:175], v[166:167], v[176:177] op_sel:[1,1,0] op_sel_hi:[0,1,1] neg_lo:[1,0,0]
    v_cvt_pk_bf16_f32 v189, v176, v177
    v_pk_mul_f32 v[174:175], v[176:177], v[166:167] op_sel_hi:[1,0]
    v_pk_fma_f32 v[174:175], v[176:177], v[166:167], v[174:175] op_sel:[1,1,0] op_sel_hi:[0,1,1] neg_lo:[1,0,0]
    v_cvt_pk_bf16_f32 v190, v174, v175
    v_pk_mul_f32 v[176:177], v[174:175], v[166:167] op_sel_hi:[1,0]
    v_pk_fma_f32 v[176:177], v[174:175], v[166:167], v[176:177] op_sel:[1,1,0] op_sel_hi:[0,1,1] neg_lo:[1,0,0]
    v_cvt_pk_bf16_f32 v191, v176, v177
    v_pk_mul_f32 v[174:175], v[176:177], v[166:167] op_sel_hi:[1,0]
    v_pk_fma_f32 v[174:175], v[176:177], v[166:167], v[174:175] op_sel:[1,1,0] op_sel_hi:[0,1,1] neg_lo:[1,0,0]
    v_cvt_pk_bf16_f32 v192, v174, v175
    v_pk_mul_f32 v[176:177], v[174:175], v[166:167] op_sel_hi:[1,0]
    v_pk_fma_f32 v[176:177], v[174:175], v[166:167], v[176:177] op_sel:[1,1,0] op_sel_hi:[0,1,1] neg_lo:[1,0,0]
    v_cvt_pk_bf16_f32 v193, v176, v177
    v_pk_mul_f32 v[174:175], v[176:177], v[166:167] op_sel_hi:[1,0]
    v_pk_fma_f32 v[174:175], v[176:177], v[166:167], v[174:175] op_sel:[1,1,0] op_sel_hi:[0,1,1] neg_lo:[1,0,0]
    v_cvt_pk_bf16_f32 v194, v174, v175
    v_pk_mul_f32 v[176:177], v[174:175], v[166:167] op_sel_hi:[1,0]
    v_pk_fma_f32 v[176:177], v[174:175], v[166:167], v[176:177] op_sel:[1,1,0] op_sel_hi:[0,1,1] neg_lo:[1,0,0]
    v_cvt_pk_bf16_f32 v195, v176, v177
    ds_write_addtid_b32 v188 offset:4352
    ds_write_addtid_b32 v189 offset:4624
    ds_write_addtid_b32 v190 offset:4896
    ds_write_addtid_b32 v191 offset:5168
    ds_write_addtid_b32 v192 offset:5440
    ds_write_addtid_b32 v193 offset:5712
    ds_write_addtid_b32 v194 offset:5984
    ds_write_addtid_b32 v195 offset:6256
    v_pk_mul_f32 v[174:175], v[176:177], v[166:167] op_sel_hi:[1,0]
    v_pk_fma_f32 v[174:175], v[176:177], v[166:167], v[174:175] op_sel:[1,1,0] op_sel_hi:[0,1,1] neg_lo:[1,0,0]
    v_cvt_pk_bf16_f32 v188, v174, v175
    v_pk_mul_f32 v[176:177], v[174:175], v[166:167] op_sel_hi:[1,0]
    v_pk_fma_f32 v[176:177], v[174:175], v[166:167], v[176:177] op_sel:[1,1,0] op_sel_hi:[0,1,1] neg_lo:[1,0,0]
    v_cvt_pk_bf16_f32 v189, v176, v177
    v_pk_mul_f32 v[174:175], v[176:177], v[166:167] op_sel_hi:[1,0]
    v_pk_fma_f32 v[174:175], v[176:177], v[166:167], v[174:175] op_sel:[1,1,0] op_sel_hi:[0,1,1] neg_lo:[1,0,0]
    v_cvt_pk_bf16_f32 v190, v174, v175
    v_pk_mul_f32 v[176:177], v[174:175], v[166:167] op_sel_hi:[1,0]
    v_pk_fma_f32 v[176:177], v[174:175], v[166:167], v[176:177] op_sel:[1,1,0] op_sel_hi:[0,1,1] neg_lo:[1,0,0]
    v_cvt_pk_bf16_f32 v191, v176, v177
    v_pk_mul_f32 v[174:175], v[176:177], v[166:167] op_sel_hi:[1,0]
    v_pk_fma_f32 v[174:175], v[176:177], v[166:167], v[174:175] op_sel:[1,1,0] op_sel_hi:[0,1,1] neg_lo:[1,0,0]
    v_cvt_pk_bf16_f32 v192, v174, v175
    v_pk_mul_f32 v[176:177], v[174:175], v[166:167] op_sel_hi:[1,0]
    v_pk_fma_f32 v[176:177], v[174:175], v[166:167], v[176:177] op_sel:[1,1,0] op_sel_hi:[0,1,1] neg_lo:[1,0,0]
    v_cvt_pk_bf16_f32 v193, v176, v177
    v_pk_mul_f32 v[174:175], v[176:177], v[166:167] op_sel_hi:[1,0]
    v_pk_fma_f32 v[174:175], v[176:177], v[166:167], v[174:175] op_sel:[1,1,0] op_sel_hi:[0,1,1] neg_lo:[1,0,0]
    v_cvt_pk_bf16_f32 v194, v174, v175
    v_pk_mul_f32 v[176:177], v[174:175], v[166:167] op_sel_hi:[1,0]
    v_pk_fma_f32 v[176:177], v[174:175], v[166:167], v[176:177] op_sel:[1,1,0] op_sel_hi:[0,1,1] neg_lo:[1,0,0]
    v_cvt_pk_bf16_f32 v195, v176, v177
    ds_write_addtid_b32 v188 offset:6528
    ds_write_addtid_b32 v189 offset:6800
    ds_write_addtid_b32 v190 offset:7072
    ds_write_addtid_b32 v191 offset:7344
    ds_write_addtid_b32 v192 offset:7616
    ds_write_addtid_b32 v193 offset:7888
    ds_write_addtid_b32 v194 offset:8160
    ds_write_addtid_b32 v195 offset:8432
    ds_read_b128 a[176:179], v148 offset:0
    ds_read_b128 a[180:183], v148 offset:32
    ds_read_b128 a[184:187], v148 offset:64
    ds_read_b128 a[188:191], v148 offset:96
    ds_read_b128 a[192:195], v148 offset:128
    ds_read_b128 a[196:199], v148 offset:160
    ds_read_b128 a[200:203], v148 offset:192
    ds_read_b128 a[204:207], v148 offset:224
    buffer_load_dwordx2 v[108:109], v100, s[40:43], s4 offen sc1
    v_cvt_pk_bf16_f32 v188, v170, -v171
    v_pk_mul_f32 v[174:175], v[170:171], v[164:165] op_sel_hi:[1,0]
    v_pk_fma_f32 v[174:175], v[170:171], v[164:165], v[174:175] op_sel:[1,1,0] op_sel_hi:[0,1,1] neg_lo:[1,0,0]
    v_cvt_pk_bf16_f32 v189, v174, -v175
    v_pk_mul_f32 v[182:183], v[174:175], v[164:165] op_sel_hi:[1,0]
    v_pk_fma_f32 v[182:183], v[174:175], v[164:165], v[182:183] op_sel:[1,1,0] op_sel_hi:[0,1,1] neg_lo:[1,0,0]
    v_cvt_pk_bf16_f32 v190, v182, -v183
    v_pk_mul_f32 v[174:175], v[182:183], v[164:165] op_sel_hi:[1,0]
    v_pk_fma_f32 v[174:175], v[182:183], v[164:165], v[174:175] op_sel:[1,1,0] op_sel_hi:[0,1,1] neg_lo:[1,0,0]
    v_cvt_pk_bf16_f32 v191, v174, -v175
    v_pk_mul_f32 v[184:185], v[174:175], v[164:165] op_sel_hi:[1,0]
    v_pk_fma_f32 v[184:185], v[174:175], v[164:165], v[184:185] op_sel:[1,1,0] op_sel_hi:[0,1,1] neg_lo:[1,0,0]
    v_cvt_pk_bf16_f32 v192, v184, -v185
    v_pk_mul_f32 v[174:175], v[184:185], v[164:165] op_sel_hi:[1,0]
    v_pk_fma_f32 v[174:175], v[184:185], v[164:165], v[174:175] op_sel:[1,1,0] op_sel_hi:[0,1,1] neg_lo:[1,0,0]
    v_cvt_pk_bf16_f32 v193, v174, -v175
    v_pk_mul_f32 v[186:187], v[174:175], v[164:165] op_sel_hi:[1,0]
    v_pk_fma_f32 v[186:187], v[174:175], v[164:165], v[186:187] op_sel:[1,1,0] op_sel_hi:[0,1,1] neg_lo:[1,0,0]
    v_cvt_pk_bf16_f32 v194, v186, -v187
    v_pk_mul_f32 v[174:175], v[186:187], v[164:165] op_sel_hi:[1,0]
    v_pk_fma_f32 v[174:175], v[186:187], v[164:165], v[174:175] op_sel:[1,1,0] op_sel_hi:[0,1,1] neg_lo:[1,0,0]
    v_cvt_pk_bf16_f32 v195, v174, -v175
    ds_write_addtid_b32 v188 offset:0
    ds_write_addtid_b32 v189 offset:272
    ds_write_addtid_b32 v190 offset:544
    ds_write_addtid_b32 v191 offset:816
    ds_write_addtid_b32 v192 offset:1088
    ds_write_addtid_b32 v193 offset:1360
    ds_write_addtid_b32 v194 offset:1632
    ds_write_addtid_b32 v195 offset:1904
    v_pk_mul_f32 v[180:181], v[170:171], v[168:169] op_sel_hi:[1,0]
    v_pk_fma_f32 v[180:181], v[170:171], v[168:169], v[180:181] op_sel:[1,1,0] op_sel_hi:[0,1,1] neg_lo:[1,0,0]
    v_cvt_pk_bf16_f32 v188, v180, -v181
    v_pk_mul_f32 v[174:175], v[182:183], v[168:169] op_sel_hi:[1,0]
    v_pk_fma_f32 v[174:175], v[182:183], v[168:169], v[174:175] op_sel:[1,1,0] op_sel_hi:[0,1,1] neg_lo:[1,0,0]
    v_cvt_pk_bf16_f32 v189, v174, -v175
    v_pk_mul_f32 v[182:183], v[184:185], v[168:169] op_sel_hi:[1,0]
    v_pk_fma_f32 v[182:183], v[184:185], v[168:169], v[182:183] op_sel:[1,1,0] op_sel_hi:[0,1,1] neg_lo:[1,0,0]
    v_cvt_pk_bf16_f32 v190, v182, -v183
    v_pk_mul_f32 v[174:175], v[186:187], v[168:169] op_sel_hi:[1,0]
    v_pk_fma_f32 v[174:175], v[186:187], v[168:169], v[174:175] op_sel:[1,1,0] op_sel_hi:[0,1,1] neg_lo:[1,0,0]
    v_cvt_pk_bf16_f32 v191, v174, -v175
    v_pk_mul_f32 v[184:185], v[180:181], v[168:169] op_sel_hi:[1,0]
    v_pk_fma_f32 v[184:185], v[180:181], v[168:169], v[184:185] op_sel:[1,1,0] op_sel_hi:[0,1,1] neg_lo:[1,0,0]
    v_cvt_pk_bf16_f32 v192, v184, -v185
    v_pk_mul_f32 v[186:187], v[182:183], v[168:169] op_sel_hi:[1,0]
    v_pk_fma_f32 v[186:187], v[182:183], v[168:169], v[186:187] op_sel:[1,1,0] op_sel_hi:[0,1,1] neg_lo:[1,0,0]
    v_cvt_pk_bf16_f32 v193, v186, -v187
    v_pk_mul_f32 v[180:181], v[184:185], v[168:169] op_sel_hi:[1,0]
    v_pk_fma_f32 v[180:181], v[184:185], v[168:169], v[180:181] op_sel:[1,1,0] op_sel_hi:[0,1,1] neg_lo:[1,0,0]
    v_cvt_pk_bf16_f32 v194, v180, -v181
    v_pk_mul_f32 v[174:175], v[186:187], v[168:169] op_sel_hi:[1,0]
    v_pk_fma_f32 v[174:175], v[186:187], v[168:169], v[174:175] op_sel:[1,1,0] op_sel_hi:[0,1,1] neg_lo:[1,0,0]
    v_cvt_pk_bf16_f32 v195, v174, -v175
    ds_write_addtid_b32 v188 offset:2176
    ds_write_addtid_b32 v189 offset:2448
    ds_write_addtid_b32 v190 offset:2720
    ds_write_addtid_b32 v191 offset:2992
    ds_write_addtid_b32 v192 offset:3264
    ds_write_addtid_b32 v193 offset:3536
    ds_write_addtid_b32 v194 offset:3808
    ds_write_addtid_b32 v195 offset:4080
    v_pk_mul_f32 v[174:175], v[180:181], v[168:169] op_sel_hi:[1,0]
    v_pk_fma_f32 v[174:175], v[180:181], v[168:169], v[174:175] op_sel:[1,1,0] op_sel_hi:[0,1,1] neg_lo:[1,0,0]
    v_cvt_pk_bf16_f32 v188, v174, -v175
    v_pk_mul_f32 v[176:177], v[174:175], v[168:169] op_sel_hi:[1,0]
    v_pk_fma_f32 v[176:177], v[174:175], v[168:169], v[176:177] op_sel:[1,1,0] op_sel_hi:[0,1,1] neg_lo:[1,0,0]
    v_cvt_pk_bf16_f32 v189, v176, -v177
    v_pk_mul_f32 v[174:175], v[176:177], v[168:169] op_sel_hi:[1,0]
    v_pk_fma_f32 v[174:175], v[176:177], v[168:169], v[174:175] op_sel:[1,1,0] op_sel_hi:[0,1,1] neg_lo:[1,0,0]
    v_cvt_pk_bf16_f32 v190, v174, -v175
    v_pk_mul_f32 v[176:177], v[174:175], v[168:169] op_sel_hi:[1,0]
    v_pk_fma_f32 v[176:177], v[174:175], v[168:169], v[176:177] op_sel:[1,1,0] op_sel_hi:[0,1,1] neg_lo:[1,0,0]
    v_cvt_pk_bf16_f32 v191, v176, -v177
    v_pk_mul_f32 v[174:175], v[176:177], v[168:169] op_sel_hi:[1,0]
    v_pk_fma_f32 v[174:175], v[176:177], v[168:169], v[174:175] op_sel:[1,1,0] op_sel_hi:[0,1,1] neg_lo:[1,0,0]
    v_cvt_pk_bf16_f32 v192, v174, -v175
    ds_write_addtid_b32 v188 offset:4352
    ds_write_addtid_b32 v189 offset:4624
    ds_write_addtid_b32 v190 offset:4896
    ds_write_addtid_b32 v191 offset:5168
    ds_write_addtid_b32 v192 offset:5440
    ds_read_b128 a[208:211], v148 offset:0
    ds_read_b128 a[212:215], v148 offset:32
    ds_read_b128 a[216:219], v148 offset:64
    ds_read_b128 a[220:223], v148 offset:96
    ds_read_b128 a[224:227], v148 offset:128
    ds_read_b128 a[228:231], v148 offset:160
    ds_read_b128 a[232:235], v148 offset:192
    ds_read_b128 a[236:239], v148 offset:224
    s_waitcnt lgkmcnt(0) vmcnt(1)
    s_bitcmp1_b32 s27, 30
    s_cbranch_scc1 L_nf3
    s_atomic_swap_x2 s[48:49], s[40:41], s27
L_nf3:
    v_mfma_f32_32x32x16_bf16 v[4:19], a[208:211], a[176:179], v[4:19]
    v_mul_f32 v136, v136, v145
    v_mul_f32 v137, v137, v146
    v_mul_f32 v196, 0x41000000, v136
    v_mul_f32 v197, 0x41000000, v137
    v_exp_f32 v196, v196
    v_mfma_f32_32x32x16_bf16 v[4:19], a[212:215], a[180:183], v[4:19]
    v_fract_f32 v197, v197
    v_cos_f32 v198, v197
    v_sin_f32 v199, v197
    v_mul_f32 v138, v138, v144
    v_mul_f32 v166, v196, v198
    v_mfma_f32_32x32x16_bf16 v[4:19], a[216:219], a[184:187], v[4:19]
    v_mul_f32 v167, v196, v199
    v_exp_f32 v196, v136
    v_fract_f32 v197, v137
    v_cos_f32 v198, v197
    v_sin_f32 v199, v197
    v_mfma_f32_32x32x16_bf16 v[4:19], a[220:223], a[188:191], v[4:19]
    v_mul_f32 v139, v139, v144
    v_mul_f32 v164, v196, v198
    v_mul_f32 v165, v196, v199
    v_mul_f32 v196, 0x43800000, v136
    v_mul_f32 v197, 0x43800000, v137
    v_mfma_f32_32x32x16_bf16 v[4:19], a[224:227], a[192:195], v[4:19]
    v_exp_f32 v196, v196
    v_fract_f32 v197, v197
    v_cos_f32 v198, v197
    v_sin_f32 v199, v197
    v_mul_f32 v170, v140, v138
    v_mfma_f32_32x32x16_bf16 v[4:19], a[228:231], a[196:199], v[4:19]
    v_mul_f32 v168, v196, v198
    v_mul_f32 v169, v196, v199
    v_mul_f32 v171, v140, v139
    v_fma_f32 v170, -v141, v139, v170
    v_fma_f32 v171, v141, v138, v171
    v_mfma_f32_32x32x16_bf16 v[4:19], a[232:235], a[200:203], v[4:19]
    v_mfma_f32_32x32x16_bf16 v[4:19], a[236:239], a[204:207], v[4:19]
    s_waitcnt vmcnt(0)
    v_cmp_ne_u64 s[50:51], s[48:49], v[108:109]
    s_nop 0
    s_cmp_lg_u64 s[50:51], 0
    s_cbranch_scc1 L_slow_f0h
L_ok_f0h:
    v_cmp_eq_u32 s[52:53], 0, v255
    s_nop 0
    s_nop 0
    v_cndmask_b32 v3, 0, v3, s[52:53]
    s_nop 2
    v_add_f32_e64 v4, v4, v3
    v_mov_b32 v188, 0x3f80
    v_cvt_pk_bf16_f32 v189, v166, v167
    v_pk_mul_f32 v[174:175], v[166:167], v[166:167] op_sel_hi:[1,0]
    v_pk_fma_f32 v[174:175], v[166:167], v[166:167], v[174:175] op_sel:[1,1,0] op_sel_hi:[0,1,1] neg_lo:[1,0,0]
    v_cvt_pk_bf16_f32 v190, v174, v175
    v_pk_mul_f32 v[176:177], v[174:175], v[166:167] op_sel_hi:[1,0]
    v_pk_fma_f32 v[176:177], v[174:175], v[166:167], v[176:177] op_sel:[1,1,0] op_sel_hi:[0,1,1] neg_lo:[1,0,0]
    v_cvt_pk_bf16_f32 v191, v176, v177
    v_pk_mul_f32 v[174:175], v[176:177], v[166:167] op_sel_hi:[1,0]
    v_pk_fma_f32 v[174:175], v[176:177], v[166:167], v[174:175] op_sel:[1,1,0] op_sel_hi:[0,1,1] neg_lo:[1,0,0]
    v_cvt_pk_bf16_f32 v192, v174, v175
    buffer_load_dwordx4 v[36:39], v252, s[40:43], s5 offen offset:0 sc1
    v_pk_mul_f32 v[176:177], v[174:175], v[166:167] op_sel_hi:[1,0]
    v_pk_fma_f32 v[176:177], v[174:175], v[166:167], v[176:177] op_sel:[1,1,0] op_sel_hi:[0,1,1] neg_lo:[1,0,0]
    v_cvt_pk_bf16_f32 v193, v176, v177
    v_pk_mul_f32 v[174:175], v[176:177], v[166:167] op_sel_hi:[1,0]
    v_pk_fma_f32 v[174:175], v[176:177], v[166:167], v[174:175] op_sel:[1,1,0] op_sel_hi:[0,1,1] neg_lo:[1,0,0]
    v_cvt_pk_bf16_f32 v194, v174, v175
    v_pk_mul_f32 v[176:177], v[174:175], v[166:167] op_sel_hi:[1,0]
    v_pk_fma_f32 v[176:177], v[174:175], v[166:167], v[176:177] op_sel:[1,1,0] op_sel_hi:[0,1,1] neg_lo:[1,0,0]
    v_cvt_pk_bf16_f32 v195, v176, v177
    ds_write_addtid_b32 v188 offset:0
    ds_write_addtid_b32 v189 offset:272
    ds_write_addtid_b32 v190 offset:544
    ds_write_addtid_b32 v191 offset:816
    ds_write_addtid_b32 v192 offset:1088
    ds_write_addtid_b32 v193 offset:1360
    ds_write_addtid_b32 v194 offset:1632
    ds_write_addtid_b32 v195 offset:1904
    v_pk_mul_f32 v[174:175], v[176:177], v[166:167] op_sel_hi:[1,0]
    v_pk_fma_f32 v[174:175], v[176:177], v[166:167], v[174:175] op_sel:[1,1,0] op_sel_hi:[0,1,1] neg_lo:[1,0,0]
    buffer_load_dwordx4 v[40:43], v252, s[40:43], s5 offen offset:1024 sc1
    v_cvt_pk_bf16_f32 v188, v174, v175
    v_pk_mul_f32 v[176:177], v[174:175], v[166:167] op_sel_hi:[1,0]
    v_pk_fma_f32 v[176:177], v[174:175], v[166:167], v[176:177] op_sel:[1,1,0] op_sel_hi:[0,1,1] neg_lo:[1,0,0]
    v_cvt_pk_bf16_f32 v189, v176, v177
    v_pk_mul_f32 v[174:175], v[176:177], v[166:167] op_sel_hi:[1,0]
    v_pk_fma_f32 v[174:175], v[176:177], v[166:167], v[174:175] op_sel:[1,1,0] op_sel_hi:[0,1,1] neg_lo:[1,0,0]
    v_cvt_pk_bf16_f32 v190, v174, v175
    v_pk_mul_f32 v[176:177], v[174:175], v[166:167] op_sel_hi:[1,0]
    v_pk_fma_f32 v[176:177], v[174:175], v[166:167], v[176:177] op_sel:[1,1,0] op_sel_hi:[0,1,1] neg_lo:[1,0,0]
    v_cvt_pk_bf16_f32 v191, v176, v177
    v_pk_mul_f32 v[174:175], v[176:177], v[166:167] op_sel_hi:[1,0]
    buffer_load_dwordx4 v[44:47], v252, s[40:43], s5 offen offset:2048 sc1
    v_pk_fma_f32 v[174:175], v[176:177], v[166:167], v[174:175] op_sel:[1,1,0] op_sel_hi:[0,1,1] neg_lo:[1,0,0]
    v_cvt_pk_bf16_f32 v192, v174, v175
    v_pk_mul_f32 v[176:177], v[174:175], v[166:167] op_sel_hi:[1,0]
    v_pk_fma_f32 v[176:177], v[174:175], v[166:167], v[176:177] op_sel:[1,1,0] op_sel_hi:[0,1,1] neg_lo:[1,0,0]
    v_cvt_pk_bf16_f32 v193, v176, v177
    v_pk_mul_f32 v[174:175], v[176:177], v[166:167] op_sel_hi:[1,0]
    v_pk_fma_f32 v[174:175], v[176:177], v[166:167], v[174:175] op_sel:[1,1,0] op_sel_hi:[0,1,1] neg_lo:[1,0,0]
    v_cvt_pk_bf16_f32 v194, v174, v175
    v_pk_mul_f32 v[176:177], v[174:175], v[166:167] op_sel_hi:[1,0]
    v_pk_fma_f32 v[176:177], v[174:175], v[166:167], v[176:177] op_sel:[1,1,0] op_sel_hi:[0,1,1] neg_lo:[1,0,0]
    v_cvt_pk_bf16_f32 v195, v176, v177
    ds_write_addtid_b32 v188 offset:2176
    ds_write_addtid_b32 v189 offset:2448
    ds_write_addtid_b32 v190 offset:2720
    ds_write_addtid_b32 v191 offset:2992
    ds_write_addtid_b32 v192 offset:3264
    ds_write_addtid_b32 v193 offset:3536
    ds_write_addtid_b32 v194 offset:3808
    ds_write_addtid_b32 v195 offset:4080
    v_pk_mul_f32 v[174:175], v[176:177], v[166:167] op_sel_hi:[1,0]
    v_pk_fma_f32 v[174:175], v[176:177], v[166:167], v[174:175] op_sel:[1,1,0] op_sel_hi:[0,1,1] neg_lo:[1,0,0]
    buffer_load_dwordx4 v[48:51], v252, s[40:43], s5 offen offset:3072 sc1
    v_cvt_pk_bf16_f32 v188, v174, v175
    v_pk_mul_f32 v[176:177], v[174:175], v[166:167] op_sel_hi:[1,0]
    v_pk_fma_f32 v[176:177], v[174:175], v[166:167], v[176:177] op_sel:[1,1,0] op_sel_hi:[0,1,1] neg_lo:[1,0,0]
    v_cvt_pk_bf16_f32 v189, v176, v177
    v_pk_mul_f32 v[174:175], v[176:177], v[166:167] op_sel_hi:[1,0]
    v_pk_fma_f32 v[174:175], v[176:177], v[166:167], v[174:175] op_sel:[1,1,0] op_sel_hi:[0,1,1] neg_lo:[1,0,0]
    v_cvt_pk_bf16_f32 v190, v174, v175
    v_pk_mul_f32 v[176:177], v[174:175], v[166:167] op_sel_hi:[1,0]
    v_pk_fma_f32 v[176:177], v[174:175], v[166:167], v[176:177] op_sel:[1,1,0] op_sel_hi:[0,1,1] neg_lo:[1,0,0]
    v_cvt_pk_bf16_f32 v191, v176, v177
    v_pk_mul_f32 v[174:175], v[176:177], v[166:167] op_sel_hi:[1,0]
    buffer_load_dwordx4 a[0:3], v252, s[40:43], s67 offen offset:0 sc1
    v_pk_fma_f32 v[174:175], v[176:177], v[166:167], v[174:175] op_sel:[1,1,0] op_sel_hi:[0,1,1] neg_lo:[1,0,0]
    v_cvt_pk_bf16_f32 v192, v174, v175
    v_pk_mul_f32 v[176:177], v[174:175], v[166:167] op_sel_hi:[1,0]
    v_pk_fma_f32 v[176:177], v[174:175], v[166:167], v[176:177] op_sel:[1,1,0] op_sel_hi:[0,1,1] neg_lo:[1,0,0]
    v_cvt_pk_bf16_f32 v193, v176, v177
    v_pk_mul_f32 v[174:175], v[176:177], v[166:167] op_sel_hi:[1,0]
    v_pk_fma_f32 v[174:175], v[176:177], v[166:167], v[174:175] op_sel:[1,1,0] op_sel_hi:[0,1,1] neg_lo:[1,0,0]
    v_cvt_pk_bf16_f32 v194, v174, v175
    v_pk_mul_f32 v[176:177], v[174:175], v[166:167] op_sel_hi:[1,0]
    v_pk_fma_f32 v[176:177], v[174:175], v[166:167], v[176:177] op_sel:[1,1,0] op_sel_hi:[0,1,1] neg_lo:[1,0,0]
    v_cvt_pk_bf16_f32 v195, v176, v177
    ds_write_addtid_b32 v188 offset:4352
    ds_write_addtid_b32 v189 offset:4624
    ds_write_addtid_b32 v190 offset:4896
    ds_write_addtid_b32 v191 offset:5168
    ds_write_addtid_b32 v192 offset:5440
    ds_write_addtid_b32 v193 offset:5712
    ds_write_addtid_b32 v194 offset:5984
    ds_write_addtid_b32 v195 offset:6256
    v_pk_mul_f32 v[174:175], v[176:177], v[166:167] op_sel_hi:[1,0]
    v_pk_fma_f32 v[174:175], v[176:177], v[166:167], v[174:175] op_sel:[1,1,0] op_sel_hi:[0,1,1] neg_lo:[1,0,0]
    buffer_load_dwordx4 a[4:7], v252, s[40:43], s67 offen offset:1024 sc1
    v_cvt_pk_bf16_f32 v188, v174, v175
    v_pk_mul_f32 v[176:177], v[174:175], v[166:167] op_sel_hi:[1,0]
    v_pk_fma_f32 v[176:177], v[174:175], v[166:167], v[176:177] op_sel:[1,1,0] op_sel_hi:[0,1,1] neg_lo:[1,0,0]
    v_cvt_pk_bf16_f32 v189, v176, v177
    v_pk_mul_f32 v[174:175], v[176:177], v[166:167] op_sel_hi:[1,0]
    v_pk_fma_f32 v[174:175], v[176:177], v[166:167], v[174:175] op_sel:[1,1,0] op_sel_hi:[0,1,1] neg_lo:[1,0,0]
    v_cvt_pk_bf16_f32 v190, v174, v175
    v_pk_mul_f32 v[176:177], v[174:175], v[166:167] op_sel_hi:[1,0]
    v_pk_fma_f32 v[176:177], v[174:175], v[166:167], v[176:177] op_sel:[1,1,0] op_sel_hi:[0,1,1] neg_lo:[1,0,0]
    v_cvt_pk_bf16_f32 v191, v176, v177
    v_pk_mul_f32 v[174:175], v[176:177], v[166:167] op_sel_hi:[1,0]
    buffer_load_dwordx4 a[8:11], v252, s[40:43], s67 offen offset:2048 sc1
    v_pk_fma_f32 v[174:175], v[176:177], v[166:167], v[174:175] op_sel:[1,1,0] op_sel_hi:[0,1,1] neg_lo:[1,0,0]
    v_cvt_pk_bf16_f32 v192, v174, v175
    v_pk_mul_f32 v[176:177], v[174:175], v[166:167] op_sel_hi:[1,0]
    v_pk_fma_f32 v[176:177], v[174:175], v[166:167], v[176:177] op_sel:[1,1,0] op_sel_hi:[0,1,1] neg_lo:[1,0,0]
    v_cvt_pk_bf16_f32 v193, v176, v177
    v_pk_mul_f32 v[174:175], v[176:177], v[166:167] op_sel_hi:[1,0]
    v_pk_fma_f32 v[174:175], v[176:177], v[166:167], v[174:175] op_sel:[1,1,0] op_sel_hi:[0,1,1] neg_lo:[1,0,0]
    v_cvt_pk_bf16_f32 v194, v174, v175
    v_pk_mul_f32 v[176:177], v[174:175], v[166:167] op_sel_hi:[1,0]
    v_pk_fma_f32 v[176:177], v[174:175], v[166:167], v[176:177] op_sel:[1,1,0] op_sel_hi:[0,1,1] neg_lo:[1,0,0]
    v_cvt_pk_bf16_f32 v195, v176, v177
    ds_write_addtid_b32 v188 offset:6528
    ds_write_addtid_b32 v189 offset:6800
    ds_write_addtid_b32 v190 offset:7072
    ds_write_addtid_b32 v191 offset:7344
    ds_write_addtid_b32 v192 offset:7616
    ds_write_addtid_b32 v193 offset:7888
    ds_write_addtid_b32 v194 offset:8160
    ds_write_addtid_b32 v195 offset:8432
    ds_read_b128 a[176:179], v148 offset:0
    ds_read_b128 a[180:183], v148 offset:32
    ds_read_b128 a[184:187], v148 offset:64
    ds_read_b128 a[188:191], v148 offset:96
    ds_read_b128 a[192:195], v148 offset:128
    ds_read_b128 a[196:199], v148 offset:160
L_padH2:
    s_cmp_lg_u32 s3, 0
    s_cbranch_scc1 L_padT1
    ds_read_b128 a[200:203], v148 offset:192
    ds_read_b128 a[204:207], v148 offset:224
    v_cvt_pk_bf16_f32 v188, v170, -v171
    v_pk_mul_f32 v[174:175], v[170:171], v[164:165] op_sel_hi:[1,0]
    buffer_load_dwordx4 a[12:15], v252, s[40:43], s67 offen offset:3072 sc1
    v_pk_fma_f32 v[174:175], v[170:171], v[164:165], v[174:175] op_sel:[1,1,0] op_sel_hi:[0,1,1] neg_lo:[1,0,0]
    v_cvt_pk_bf16_f32 v189, v174, -v175
    v_pk_mul_f32 v[182:183], v[174:175], v[164:165] op_sel_hi:[1,0]
    v_pk_fma_f32 v[182:183], v[174:175], v[164:165], v[182:183] op_sel:[1,1,0] op_sel_hi:[0,1,1] neg_lo:[1,0,0]
    v_cvt_pk_bf16_f32 v190, v182, -v183
    v_pk_mul_f32 v[174:175], v[182:183], v[164:165] op_sel_hi:[1,0]
    v_pk_fma_f32 v[174:175], v[182:183], v[164:165], v[174:175] op_sel:[1,1,0] op_sel_hi:[0,1,1] neg_lo:[1,0,0]
    v_cvt_pk_bf16_f32 v191, v174, -v175
    v_pk_mul_f32 v[184:185], v[174:175], v[164:165] op_sel_hi:[1,0]
    v_pk_fma_f32 v[184:185], v[174:175], v[164:165], v[184:185] op_sel:[1,1,0] op_sel_hi:[0,1,1] neg_lo:[1,0,0]
    s_add_u32 s67, s67, 4096
    v_cvt_pk_bf16_f32 v192, v184, -v185
    buffer_load_dwordx4 a[16:19], v252, s[40:43], s67 offen offset:0 sc1
    v_pk_mul_f32 v[174:175], v[184:185], v[164:165] op_sel_hi:[1,0]
    v_pk_fma_f32 v[174:175], v[184:185], v[164:165], v[174:175] op_sel:[1,1,0] op_sel_hi:[0,1,1] neg_lo:[1,0,0]
    v_cvt_pk_bf16_f32 v193, v174, -v175
    v_pk_mul_f32 v[186:187], v[174:175], v[164:165] op_sel_hi:[1,0]
    v_pk_fma_f32 v[186:187], v[174:175], v[164:165], v[186:187] op_sel:[1,1,0] op_sel_hi:[0,1,1] neg_lo:[1,0,0]
    v_cvt_pk_bf16_f32 v194, v186, -v187
    v_pk_mul_f32 v[174:175], v[186:187], v[164:165] op_sel_hi:[1,0]
    v_pk_fma_f32 v[174:175], v[186:187], v[164:165], v[174:175] op_sel:[1,1,0] op_sel_hi:[0,1,1] neg_lo:[1,0,0]
    v_cvt_pk_bf16_f32 v195, v174, -v175
    ds_write_addtid_b32 v188 offset:0
    ds_write_addtid_b32 v189 offset:272
    ds_write_addtid_b32 v190 offset:544
    ds_write_addtid_b32 v191 offset:816
    ds_write_addtid_b32 v192 offset:1088
    ds_write_addtid_b32 v193 offset:1360
    ds_write_addtid_b32 v194 offset:1632
    ds_write_addtid_b32 v195 offset:1904
    v_pk_mul_f32 v[180:181], v[170:171], v[168:169] op_sel_hi:[1,0]
    v_pk_fma_f32 v[180:181], v[170:171], v[168:169], v[180:181] op_sel:[1,1,0] op_sel_hi:[0,1,1] neg_lo:[1,0,0]
    buffer_load_dwordx4 a[20:23], v252, s[40:43], s67 offen offset:1024 sc1
    v_cvt_pk_bf16_f32 v188, v180, -v181
    v_pk_mul_f32 v[174:175], v[182:183], v[168:169] op_sel_hi:[1,0]
    v_pk_fma_f32 v[174:175], v[182:183], v[168:169], v[174:175] op_sel:[1,1,0] op_sel_hi:[0,1,1] neg_lo:[1,0,0]
    v_cvt_pk_bf16_f32 v189, v174, -v175
    v_pk_mul_f32 v[182:183], v[184:185], v[168:169] op_sel_hi:[1,0]
    v_pk_fma_f32 v[182:183], v[184:185], v[168:169], v[182:183] op_sel:[1,1,0] op_sel_hi:[0,1,1] neg_lo:[1,0,0]
    v_cvt_pk_bf16_f32 v190, v182, -v183
    v_pk_mul_f32 v[174:175], v[186:187], v[168:169] op_sel_hi:[1,0]
    v_pk_fma_f32 v[174:175], v[186:187], v[168:169], v[174:175] op_sel:[1,1,0] op_sel_hi:[0,1,1] neg_lo:[1,0,0]
    v_cvt_pk_bf16_f32 v191, v174, -v175
    v_pk_mul_f32 v[184:185], v[180:181], v[168:169] op_sel_hi:[1,0]
    buffer_load_dwordx4 a[24:27], v252, s[40:43], s67 offen offset:2048 sc1
    v_pk_fma_f32 v[184:185], v[180:181], v[168:169], v[184:185] op_sel:[1,1,0] op_sel_hi:[0,1,1] neg_lo:[1,0,0]
    v_cvt_pk_bf16_f32 v192, v184, -v185
    v_pk_mul_f32 v[186:187], v[182:183], v[168:169] op_sel_hi:[1,0]
    v_pk_fma_f32 v[186:187], v[182:183], v[168:169], v[186:187] op_sel:[1,1,0] op_sel_hi:[0,1,1] neg_lo:[1,0,0]
    v_cvt_pk_bf16_f32 v193, v186, -v187
    v_pk_mul_f32 v[180:181], v[184:185], v[168:169] op_sel_hi:[1,0]
    v_pk_fma_f32 v[180:181], v[184:185], v[168:169], v[180:181] op_sel:[1,1,0] op_sel_hi:[0,1,1] neg_lo:[1,0,0]
    v_cvt_pk_bf16_f32 v194, v180, -v181
    v_pk_mul_f32 v[174:175], v[186:187], v[168:169] op_sel_hi:[1,0]
    v_pk_fma_f32 v[174:175], v[186:187], v[168:169], v[174:175] op_sel:[1,1,0] op_sel_hi:[0,1,1] neg_lo:[1,0,0]
    v_cvt_pk_bf16_f32 v195, v174, -v175
    ds_write_addtid_b32 v188 offset:2176
    ds_write_addtid_b32 v189 offset:2448
    ds_write_addtid_b32 v190 offset:2720
    ds_write_addtid_b32 v191 offset:2992
    ds_write_addtid_b32 v192 offset:3264
    ds_write_addtid_b32 v193 offset:3536
    ds_write_addtid_b32 v194 offset:3808
    ds_write_addtid_b32 v195 offset:4080
    v_pk_mul_f32 v[174:175], v[180:181], v[168:169] op_sel_hi:[1,0]
    v_pk_fma_f32 v[174:175], v[180:181], v[168:169], v[174:175] op_sel:[1,1,0] op_sel_hi:[0,1,1] neg_lo:[1,0,0]
    buffer_load_dwordx4 a[28:31], v252, s[40:43], s67 offen offset:3072 sc1
    v_cvt_pk_bf16_f32 v188, v174, -v175
    v_pk_mul_f32 v[176:177], v[174:175], v[168:169] op_sel_hi:[1,0]
    v_pk_fma_f32 v[176:177], v[174:175], v[168:169], v[176:177] op_sel:[1,1,0] op_sel_hi:[0,1,1] neg_lo:[1,0,0]
    v_cvt_pk_bf16_f32 v189, v176, -v177
    v_pk_mul_f32 v[174:175], v[176:177], v[168:169] op_sel_hi:[1,0]
    v_pk_fma_f32 v[174:175], v[176:177], v[168:169], v[174:175] op_sel:[1,1,0] op_sel_hi:[0,1,1] neg_lo:[1,0,0]
    v_cvt_pk_bf16_f32 v190, v174, -v175
    v_pk_mul_f32 v[176:177], v[174:175], v[168:169] op_sel_hi:[1,0]
    v_pk_fma_f32 v[176:177], v[174:175], v[168:169], v[176:177] op_sel:[1,1,0] op_sel_hi:[0,1,1] neg_lo:[1,0,0]
    v_cvt_pk_bf16_f32 v191, v176, -v177
    s_add_u32 s67, s67, 4096
    v_pk_mul_f32 v[174:175], v[176:177], v[168:169] op_sel_hi:[1,0]
    buffer_load_dwordx4 a[32:35], v252, s[40:43], s67 offen offset:0 sc1
    v_pk_fma_f32 v[174:175], v[176:177], v[168:169], v[174:175] op_sel:[1,1,0] op_sel_hi:[0,1,1] neg_lo:[1,0,0]
    v_cvt_pk_bf16_f32 v192, v174, -v175
    ds_write_addtid_b32 v188 offset:4352
    ds_write_addtid_b32 v189 offset:4624
    ds_write_addtid_b32 v190 offset:4896
    ds_write_addtid_b32 v191 offset:5168
    ds_write_addtid_b32 v192 offset:5440
    ds_read_b128 a[208:211], v148 offset:0
    ds_read_b128 a[212:215], v148 offset:32
    ds_read_b128 a[216:219], v148 offset:64
    ds_read_b128 a[220:223], v148 offset:96
    ds_read_b128 a[224:227], v148 offset:128
    ds_read_b128 a[228:231], v148 offset:160
    ds_read_b128 a[232:235], v148 offset:192
    ds_read_b128 a[236:239], v148 offset:224
    s_waitcnt lgkmcnt(0)
    v_mfma_f32_32x32x16_bf16 v[4:19], a[208:211], a[176:179], v[4:19]
    s_waitcnt vmcnt(12)
    ds_write2_b64 v221, v[36:37], v[36:37] offset0:1 offset1:8
    v_mfma_f32_32x32x16_bf16 v[4:19], a[212:215], a[180:183], v[4:19]
    ds_write2_b64 v221, v[38:39], v[38:39] offset0:3 offset1:10
    v_mfma_f32_32x32x16_bf16 v[4:19], a[216:219], a[184:187], v[4:19]
    s_waitcnt vmcnt(11)
    ds_write2_b64 v221, v[40:41], v[40:41] offset0:65 offset1:72
    v_mfma_f32_32x32x16_bf16 v[4:19], a[220:223], a[188:191], v[4:19]
    ds_write2_b64 v221, v[42:43], v[42:43] offset0:67 offset1:74
    v_mfma_f32_32x32x16_bf16 v[4:19], a[224:227], a[192:195], v[4:19]
    s_waitcnt vmcnt(10)
    ds_write2_b64 v221, v[44:45], v[44:45] offset0:129 offset1:136
    v_mfma_f32_32x32x16_bf16 v[4:19], a[228:231], a[196:199], v[4:19]
    ds_write2_b64 v221, v[46:47], v[46:47] offset0:131 offset1:138
    v_mfma_f32_32x32x16_bf16 v[4:19], a[232:235], a[200:203], v[4:19]
    s_waitcnt vmcnt(9)
    ds_write2_b64 v221, v[48:49], v[48:49] offset0:193 offset1:200
    v_mfma_f32_32x32x16_bf16 v[4:19], a[236:239], a[204:207], v[4:19]
    ds_write2_b64 v221, v[50:51], v[50:51] offset0:195 offset1:202
    ds_write_b64 v220, v[106:107]
    buffer_load_dwordx4 a[36:39], v252, s[40:43], s67 offen offset:1024 sc1
    buffer_load_dwordx4 a[40:43], v252, s[40:43], s67 offen offset:2048 sc1
    s_nop 7
    v_cvt_pk_bf16_f32 v68, v4, v5
    v_cvt_pk_bf16_f32 v69, v6, v7
    v_cvt_pk_bf16_f32 v70, v8, v9
    v_cvt_pk_bf16_f32 v71, v10, v11
    v_cvt_pk_bf16_f32 v72, v12, v13
    v_cvt_pk_bf16_f32 v73, v14, v15
    ds_write_b64 v231, v[68:69]
    ds_write_b32 v232, v70
    ds_write_b32 v233, v71
    ds_write_b16 v234, v72 offset:1024
    ds_write_b16_d16_hi v234, v72 offset:1088
    ds_write_b16 v234, v73 offset:1152
    ds_write_b16_d16_hi v234, v73 offset:1216
    buffer_load_dwordx4 a[44:47], v252, s[40:43], s67 offen offset:3072 sc1
    s_add_u32 s67, s67, 4096
    buffer_load_dwordx4 a[48:51], v252, s[40:43], s67 offen offset:0 sc1
    s_waitcnt lgkmcnt(0)
    s_barrier
    ds_read2_b32 v[20:21], v92 offset0:0 offset1:1
    ds_read2_b32 v[22:23], v93 offset0:0 offset1:1
    ds_read2_b32 v[24:25], v94 offset0:0 offset1:1
    ds_read2_b32 v[26:27], v95 offset0:0 offset1:1
    ds_read2_b32 v[28:29], v96 offset0:0 offset1:1
    ds_read2_b32 v[30:31], v97 offset0:0 offset1:1
    ds_read2_b32 v[32:33], v98 offset0:0 offset1:1
    ds_read2_b32 v[34:35], v99 offset0:0 offset1:1
    buffer_load_dwordx4 a[52:55], v252, s[40:43], s67 offen offset:1024 sc1
    buffer_load_dwordx4 a[56:59], v252, s[40:43], s67 offen offset:2048 sc1
    s_waitcnt lgkmcnt(7)
    v_perm_b32 v52, v21, v20, v227
    v_perm_b32 v53, v21, v20, v228
    s_waitcnt lgkmcnt(6)
    v_perm_b32 v54, v23, v22, v229
    v_perm_b32 v55, v23, v22, v230
    ds_write_b128 v222, v[52:55] offset:0
    s_waitcnt lgkmcnt(6)
    v_perm_b32 v56, v25, v24, v227
    v_perm_b32 v57, v25, v24, v228
    s_waitcnt lgkmcnt(5)
    v_perm_b32 v58, v27, v26, v229
    v_perm_b32 v59, v27, v26, v230
    ds_write_b128 v222, v[56:59] offset:4224
    s_waitcnt lgkmcnt(5)
    v_perm_b32 v60, v29, v28, v227
    v_perm_b32 v61, v29, v28, v228
    s_waitcnt lgkmcnt(4)
    v_perm_b32 v62, v31, v30, v229
    v_perm_b32 v63, v31, v30, v230
    ds_write_b128 v223, v[60:63] offset:0
    s_waitcnt lgkmcnt(4)
    v_perm_b32 v64, v33, v32, v227
    v_perm_b32 v65, v33, v32, v228
    s_waitcnt lgkmcnt(3)
    v_perm_b32 v66, v35, v34, v229
    v_perm_b32 v67, v35, v34, v230
    ds_write_b128 v223, v[64:67] offset:4224
    buffer_load_dwordx4 a[60:63], v252, s[40:43], s67 offen offset:3072 sc1
    s_add_u32 s67, s67, 4096
    buffer_load_dwordx4 a[64:67], v252, s[40:43], s67 offen offset:0 sc1
    s_mov_b32 m0, s69
    s_waitcnt lgkmcnt(0)
    s_barrier
    s_nop 0
    ds_read_b64_tr_b16 v[4:5], v242 offset:32
    ds_read_b64_tr_b16 v[6:7], v242 offset:0
    ds_read_b128 v[8:11], v241 offset:0
    ds_read_b64_tr_b16 v[12:13], v242 offset:288
    ds_read_b64_tr_b16 v[14:15], v242 offset:256
    ds_read_b128 v[16:19], v241 offset:512
    ds_read_b64_tr_b16 v[20:21], v242 offset:544
    ds_read_b64_tr_b16 v[22:23], v242 offset:512
    ds_read_b128 v[24:27], v241 offset:1024
    ds_read_b64_tr_b16 v[28:29], v242 offset:800
    ds_read_b64_tr_b16 v[30:31], v242 offset:768
    ds_read_b128 v[32:35], v241 offset:1536
    ds_read_b64_tr_b16 v[36:37], v242 offset:1056
    ds_read_b64_tr_b16 v[38:39], v242 offset:1024
    ds_read_b128 v[40:43], v241 offset:2048
    ds_read_b64_tr_b16 v[44:45], v242 offset:1312
    ds_read_b64_tr_b16 v[46:47], v242 offset:1280
    ds_read_b128 v[48:51], v241 offset:2560
    ds_read_b64_tr_b16 v[52:53], v242 offset:1568
    ds_read_b64_tr_b16 v[54:55], v242 offset:1536
    ds_read_b128 v[56:59], v241 offset:3072
    ds_read_b64_tr_b16 v[60:61], v242 offset:1824
    ds_read_b64_tr_b16 v[62:63], v242 offset:1792
    ds_read_b128 v[64:67], v241 offset:3584
    v_add_u32 v244, 0, v255
    v_mul_u32_u24 v245, 6554, v244
    v_lshrrev_b32 v245, 16, v245
    v_mul_u32_u24 v245, 1120, v245
    v_add_u32 v249, v245, v252
    v_add_u32 v244, 64, v255
    v_mul_u32_u24 v245, 6554, v244
    v_lshrrev_b32 v245, 16, v245
    v_mul_u32_u24 v245, 1120, v245
    v_add_u32 v2, v245, v252
    v_add_u32 v244, 128, v255
    v_mul_u32_u24 v245, 6554, v244
    v_lshrrev_b32 v245, 16, v245
    v_mul_u32_u24 v245, 1120, v245
    v_add_u32 v3, v245, v252
    v_lshlrev_b32 v244, 25, v255
    v_and_b32 v244, 1073741824, v244
    v_or_b32 v3, v3, v244
    s_lshl_b32 s79, s65, 2
    s_add_u32 s79, s79, s78
    s_mul_i32 s79, s79, 20480
    s_mul_i32 s61, s66, 160
    s_add_u32 s79, s79, s61
    s_xor_b32 s80, s2, 192
    s_or_b32 s80, s80, s54
    s_nop 0
    s_bitcmp1_b32 s54, 1
    s_cbranch_scc1 L_cvBh
    s_waitcnt lgkmcnt(15)
    v_mfma_f32_16x16x32_bf16 v[196:199], v[8:11], v[4:7], 0
    buffer_load_dwordx4 a[68:71], v252, s[40:43], s67 offen offset:1024 sc1
    s_waitcnt lgkmcnt(12)
    v_mfma_f32_16x16x32_bf16 v[200:203], v[24:27], v[12:15], 0
    ds_read_b64_tr_b16 v[68:69], v242 offset:2080
    v_mfma_f32_16x16x32_bf16 v[200:203], v[16:19], v[20:23], v[200:203]
    ds_read_b64_tr_b16 v[70:71], v242 offset:2048
    v_mfma_f32_16x16x32_bf16 v[200:203], v[32:35], v[4:7], v[200:203]
    ds_read_b128 v[72:75], v241 offset:4096
    v_mfma_f32_16x16x32_bf16 v[200:203], v[8:11], v[28:31], v[200:203]
    ds_read_b64_tr_b16 v[76:77], v242 offset:2336
    v_add_f32_dpp v212, v199, v198 wave_ror:1 row_mask:0xf bank_mask:0xf bound_ctrl:0
    s_waitcnt lgkmcnt(13)
    v_mfma_f32_16x16x32_bf16 v[204:207], v[24:27], v[20:23], 0
    buffer_load_dwordx4 a[72:75], v252, s[40:43], s67 offen offset:2048 sc1
    v_mfma_f32_16x16x32_bf16 v[204:207], v[32:35], v[12:15], v[204:207]
    ds_read_b64_tr_b16 v[78:79], v242 offset:2304
    v_add_f32_dpp v198, v199, v198 wave_shr:1 row_mask:0xf bank_mask:0xf bound_ctrl:0
    v_mfma_f32_16x16x32_bf16 v[204:207], v[16:19], v[28:31], v[204:207]
    ds_read_b128 v[80:83], v241 offset:4608
    v_add_f32_dpp v213, v212, v197 wave_ror:1 row_mask:0xf bank_mask:0xf bound_ctrl:0
    v_mfma_f32_16x16x32_bf16 v[204:207], v[40:43], v[4:7], v[204:207]
    ds_read_b64_tr_b16 v[84:85], v242 offset:2592
    v_add_f32_dpp v197, v198, v197 wave_shr:1 row_mask:0xf bank_mask:0xf bound_ctrl:0
    v_mfma_f32_16x16x32_bf16 v[204:207], v[8:11], v[36:39], v[204:207]
    ds_read_b64_tr_b16 v[86:87], v242 offset:2560
    v_add_f32_dpp v214, v213, v196 wave_ror:1 row_mask:0xf bank_mask:0xf bound_ctrl:0
    s_waitcnt lgkmcnt(11)
    v_mfma_f32_16x16x32_bf16 v[208:211], v[40:43], v[28:31], 0
    buffer_load_dwordx4 a[76:79], v252, s[40:43], s67 offen offset:3072 sc1
    v_mfma_f32_16x16x32_bf16 v[208:211], v[32:35], v[36:39], v[208:211]
    ds_read_b128 v[88:91], v241 offset:5120
    s_add_u32 s67, s67, 4096
    v_mfma_f32_16x16x32_bf16 v[208:211], v[48:51], v[20:23], v[208:211]
    ds_read_b64_tr_b16 v[92:93], v242 offset:2848
    v_add_f32_dpp v196, v197, v196 wave_shr:1 row_mask:0xf bank_mask:0xf bound_ctrl:0
    v_mfma_f32_16x16x32_bf16 v[208:211], v[24:27], v[44:47], v[208:211]
    ds_read_b64_tr_b16 v[94:95], v242 offset:2816
    v_sub_f32 v197, v214, v196
    v_mfma_f32_16x16x32_bf16 v[208:211], v[56:59], v[12:15], v[208:211]
    ds_write_addtid_b32 v196 offset:0
    v_mfma_f32_16x16x32_bf16 v[208:211], v[16:19], v[52:55], v[208:211]
    buffer_load_dwordx4 a[80:83], v252, s[40:43], s67 offen offset:0 sc1
    s_waitcnt lgkmcnt(12)
    v_mfma_f32_16x16x32_bf16 v[208:211], v[64:67], v[4:7], v[208:211]
    ds_write_addtid_b32 v197 offset:16384
    v_add_f32_dpp v212, v203, v202 wave_ror:1 row_mask:0xf bank_mask:0xf bound_ctrl:0
    v_mfma_f32_16x16x32_bf16 v[208:211], v[8:11], v[60:63], v[208:211]
    ds_read_b128 v[96:99], v241 offset:5632
    v_add_f32_dpp v202, v203, v202 wave_shr:1 row_mask:0xf bank_mask:0xf bound_ctrl:0
    v_mfma_f32_16x16x32_bf16 v[216:219], v[40:43], v[36:39], 0
    ds_read_b64_tr_b16 v[100:101], v242 offset:3104
    v_add_f32_dpp v213, v212, v201 wave_ror:1 row_mask:0xf bank_mask:0xf bound_ctrl:0
    v_mfma_f32_16x16x32_bf16 v[216:219], v[48:51], v[28:31], v[216:219]
    ds_read_b64_tr_b16 v[102:103], v242 offset:3072
    v_add_f32_dpp v201, v202, v201 wave_shr:1 row_mask:0xf bank_mask:0xf bound_ctrl:0
    v_mfma_f32_16x16x32_bf16 v[216:219], v[32:35], v[44:47], v[216:219]
    buffer_load_dwordx4 a[84:87], v252, s[40:43], s67 offen offset:1024 sc1
    v_mfma_f32_16x16x32_bf16 v[216:219], v[56:59], v[20:23], v[216:219]
    ds_read_b128 v[104:107], v241 offset:6144
    v_add_f32_dpp v214, v213, v200 wave_ror:1 row_mask:0xf bank_mask:0xf bound_ctrl:0
    v_mfma_f32_16x16x32_bf16 v[216:219], v[24:27], v[52:55], v[216:219]
    ds_read_b64_tr_b16 v[108:109], v242 offset:3360
    v_add_f32_dpp v200, v201, v200 wave_shr:1 row_mask:0xf bank_mask:0xf bound_ctrl:0
    v_mfma_f32_16x16x32_bf16 v[216:219], v[64:67], v[12:15], v[216:219]
    ds_read_b64_tr_b16 v[110:111], v242 offset:3328
    v_sub_f32 v201, v214, v200
    v_mfma_f32_16x16x32_bf16 v[216:219], v[16:19], v[60:63], v[216:219]
    ds_write_addtid_b32 v200 offset:1536
    s_waitcnt lgkmcnt(15)
    v_mfma_f32_16x16x32_bf16 v[216:219], v[72:75], v[4:7], v[216:219]
    buffer_load_dwordx4 a[88:91], v252, s[40:43], s67 offen offset:2048 sc1
    v_mfma_f32_16x16x32_bf16 v[216:219], v[8:11], v[68:71], v[216:219]
    ds_write_addtid_b32 v201 offset:17920
    v_add_f32_dpp v212, v207, v206 wave_ror:1 row_mask:0xf bank_mask:0xf bound_ctrl:0
    v_mfma_f32_16x16x32_bf16 v[220:223], v[56:59], v[44:47], 0
    ds_read_b128 v[112:115], v241 offset:6656
    v_add_f32_dpp v206, v207, v206 wave_shr:1 row_mask:0xf bank_mask:0xf bound_ctrl:0
    v_mfma_f32_16x16x32_bf16 v[220:223], v[48:51], v[52:55], v[220:223]
    ds_read_b64_tr_b16 v[116:117], v242 offset:3616
    v_add_f32_dpp v213, v212, v205 wave_ror:1 row_mask:0xf bank_mask:0xf bound_ctrl:0
    v_mfma_f32_16x16x32_bf16 v[220:223], v[64:67], v[36:39], v[220:223]
    ds_read_b64_tr_b16 v[118:119], v242 offset:3584
    v_add_f32_dpp v205, v206, v205 wave_shr:1 row_mask:0xf bank_mask:0xf bound_ctrl:0
    v_mfma_f32_16x16x32_bf16 v[220:223], v[40:43], v[60:63], v[220:223]
    buffer_load_dwordx4 a[92:95], v252, s[40:43], s67 offen offset:3072 sc1
    v_mfma_f32_16x16x32_bf16 v[220:223], v[72:75], v[28:31], v[220:223]
    ds_read_b128 v[120:123], v241 offset:7168
    s_add_u32 s67, s67, 4096
    v_mfma_f32_16x16x32_bf16 v[220:223], v[32:35], v[68:71], v[220:223]
    ds_read_b64_tr_b16 v[124:125], v242 offset:3872
    v_add_f32_dpp v214, v213, v204 wave_ror:1 row_mask:0xf bank_mask:0xf bound_ctrl:0
    s_waitcnt lgkmcnt(15)
    v_mfma_f32_16x16x32_bf16 v[220:223], v[80:83], v[20:23], v[220:223]
    ds_read_b64_tr_b16 v[126:127], v242 offset:3840
    v_add_f32_dpp v204, v205, v204 wave_shr:1 row_mask:0xf bank_mask:0xf bound_ctrl:0
    v_mfma_f32_16x16x32_bf16 v[220:223], v[24:27], v[76:79], v[220:223]
    ds_read_b128 v[128:131], v241 offset:7680
    v_sub_f32 v205, v214, v204
    v_mfma_f32_16x16x32_bf16 v[220:223], v[88:91], v[12:15], v[220:223]
    buffer_load_dwordx4 a[96:99], v252, s[40:43], s67 offen offset:0 sc1
    v_mfma_f32_16x16x32_bf16 v[220:223], v[16:19], v[84:87], v[220:223]
    ds_write_addtid_b32 v204 offset:2048
    s_waitcnt lgkmcnt(15)
    v_mfma_f32_16x16x32_bf16 v[220:223], v[96:99], v[4:7], v[220:223]
    ds_write_addtid_b32 v205 offset:18432
    v_add_f32_dpp v212, v211, v210 wave_ror:1 row_mask:0xf bank_mask:0xf bound_ctrl:0
    v_mfma_f32_16x16x32_bf16 v[220:223], v[8:11], v[92:95], v[220:223]
    ds_read_b64_tr_b16 v[132:133], v242 offset:4256
    v_add_f32_dpp v210, v211, v210 wave_shr:1 row_mask:0xf bank_mask:0xf bound_ctrl:0
    v_mfma_f32_16x16x32_bf16 v[224:227], v[56:59], v[52:55], 0
    ds_read_b64_tr_b16 v[134:135], v242 offset:4224
    v_add_f32_dpp v213, v212, v209 wave_ror:1 row_mask:0xf bank_mask:0xf bound_ctrl:0
    v_mfma_f32_16x16x32_bf16 v[224:227], v[64:67], v[44:47], v[224:227]
    buffer_load_dwordx4 a[100:103], v252, s[40:43], s67 offen offset:1024 sc1
    v_mfma_f32_16x16x32_bf16 v[224:227], v[48:51], v[60:63], v[224:227]
    ds_read_b128 v[136:139], v241 offset:8656
    v_add_f32_dpp v209, v210, v209 wave_shr:1 row_mask:0xf bank_mask:0xf bound_ctrl:0
    v_mfma_f32_16x16x32_bf16 v[224:227], v[72:75], v[36:39], v[224:227]
    ds_read_b64_tr_b16 v[140:141], v242 offset:4512
    v_add_f32_dpp v214, v213, v208 wave_ror:1 row_mask:0xf bank_mask:0xf bound_ctrl:0
    v_mfma_f32_16x16x32_bf16 v[224:227], v[40:43], v[68:71], v[224:227]
    ds_read_b64_tr_b16 v[142:143], v242 offset:4480
    v_add_f32_dpp v208, v209, v208 wave_shr:1 row_mask:0xf bank_mask:0xf bound_ctrl:0
    v_mfma_f32_16x16x32_bf16 v[224:227], v[80:83], v[28:31], v[224:227]
    ds_read_b128 v[144:147], v241 offset:9168
    v_sub_f32 v209, v214, v208
    v_mfma_f32_16x16x32_bf16 v[224:227], v[32:35], v[76:79], v[224:227]
    buffer_load_dwordx4 a[104:107], v252, s[40:43], s67 offen offset:2048 sc1
    v_mfma_f32_16x16x32_bf16 v[224:227], v[88:91], v[20:23], v[224:227]
    ds_write_addtid_b32 v208 offset:3584
    v_mfma_f32_16x16x32_bf16 v[224:227], v[24:27], v[84:87], v[224:227]
    ds_write_addtid_b32 v209 offset:19968
    v_add_f32_dpp v212, v219, v218 wave_ror:1 row_mask:0xf bank_mask:0xf bound_ctrl:0
    v_mfma_f32_16x16x32_bf16 v[224:227], v[96:99], v[12:15], v[224:227]
    ds_read_b64_tr_b16 v[148:149], v242 offset:4768
    v_add_f32_dpp v218, v219, v218 wave_shr:1 row_mask:0xf bank_mask:0xf bound_ctrl:0
    v_mfma_f32_16x16x32_bf16 v[224:227], v[16:19], v[92:95], v[224:227]
    ds_read_b64_tr_b16 v[150:151], v242 offset:4736
    v_add_f32_dpp v213, v212, v217 wave_ror:1 row_mask:0xf bank_mask:0xf bound_ctrl:0
    s_waitcnt lgkmcnt(15)
    v_mfma_f32_16x16x32_bf16 v[224:227], v[104:107], v[4:7], v[224:227]
    buffer_load_dwordx4 a[108:111], v252, s[40:43], s67 offen offset:3072 sc1
    v_mfma_f32_16x16x32_bf16 v[224:227], v[8:11], v[100:103], v[224:227]
    ds_read_b128 v[152:155], v241 offset:9680
    s_add_u32 s67, s67, 4096
    v_mfma_f32_16x16x32_bf16 v[196:199], v[72:75], v[60:63], 0
    ds_read_b64_tr_b16 v[156:157], v242 offset:5024
    v_add_f32_dpp v217, v218, v217 wave_shr:1 row_mask:0xf bank_mask:0xf bound_ctrl:0
    v_mfma_f32_16x16x32_bf16 v[196:199], v[64:67], v[68:71], v[196:199]
    ds_read_b64_tr_b16 v[158:159], v242 offset:4992
    v_add_f32_dpp v214, v213, v216 wave_ror:1 row_mask:0xf bank_mask:0xf bound_ctrl:0
    v_mfma_f32_16x16x32_bf16 v[196:199], v[80:83], v[52:55], v[196:199]
    ds_read_b128 v[160:163], v241 offset:10192
    v_add_f32_dpp v216, v217, v216 wave_shr:1 row_mask:0xf bank_mask:0xf bound_ctrl:0
    v_mfma_f32_16x16x32_bf16 v[196:199], v[56:59], v[76:79], v[196:199]
    buffer_load_dwordx4 a[112:115], v252, s[40:43], s67 offen offset:0 sc1
    v_mfma_f32_16x16x32_bf16 v[196:199], v[88:91], v[44:47], v[196:199]
    ds_read_b64_tr_b16 v[164:165], v242 offset:5280
    v_sub_f32 v217, v214, v216
    v_mfma_f32_16x16x32_bf16 v[196:199], v[48:51], v[84:87], v[196:199]
    ds_write_addtid_b32 v216 offset:4096
    v_mfma_f32_16x16x32_bf16 v[196:199], v[96:99], v[36:39], v[196:199]
    ds_write_addtid_b32 v217 offset:20480
    v_add_f32_dpp v212, v223, v222 wave_ror:1 row_mask:0xf bank_mask:0xf bound_ctrl:0
    v_mfma_f32_16x16x32_bf16 v[196:199], v[40:43], v[92:95], v[196:199]
    ds_read_b64_tr_b16 v[166:167], v242 offset:5248
    v_add_f32_dpp v222, v223, v222 wave_shr:1 row_mask:0xf bank_mask:0xf bound_ctrl:0
    v_mfma_f32_16x16x32_bf16 v[196:199], v[104:107], v[28:31], v[196:199]
    buffer_load_dwordx4 a[116:119], v252, s[40:43], s67 offen offset:1024 sc1
    v_mfma_f32_16x16x32_bf16 v[196:199], v[32:35], v[100:103], v[196:199]
    ds_read_b128 v[168:171], v241 offset:10704
    v_add_f32_dpp v213, v212, v221 wave_ror:1 row_mask:0xf bank_mask:0xf bound_ctrl:0
    v_mfma_f32_16x16x32_bf16 v[196:199], v[112:115], v[20:23], v[196:199]
    ds_read_b64_tr_b16 v[172:173], v242 offset:5536
    v_add_f32_dpp v221, v222, v221 wave_shr:1 row_mask:0xf bank_mask:0xf bound_ctrl:0
    v_mfma_f32_16x16x32_bf16 v[196:199], v[24:27], v[108:111], v[196:199]
    ds_read_b64_tr_b16 v[174:175], v242 offset:5504
    v_add_f32_dpp v214, v213, v220 wave_ror:1 row_mask:0xf bank_mask:0xf bound_ctrl:0
    v_mfma_f32_16x16x32_bf16 v[196:199], v[120:123], v[12:15], v[196:199]
    ds_read_b128 v[176:179], v241 offset:11216
    v_add_f32_dpp v220, v221, v220 wave_shr:1 row_mask:0xf bank_mask:0xf bound_ctrl:0
    v_mfma_f32_16x16x32_bf16 v[196:199], v[16:19], v[116:119], v[196:199]
    buffer_load_dwordx4 a[120:123], v252, s[40:43], s67 offen offset:2048 sc1
    s_waitcnt lgkmcnt(15)
    v_mfma_f32_16x16x32_bf16 v[196:199], v[128:131], v[4:7], v[196:199]
    ds_read_b64_tr_b16 v[180:181], v242 offset:5792
    v_sub_f32 v221, v214, v220
    v_mfma_f32_16x16x32_bf16 v[196:199], v[8:11], v[124:127], v[196:199]
    ds_write_addtid_b32 v220 offset:5632
    ds_read_b64_tr_b16 v[182:183], v242 offset:5760
    ds_read_b128 v[184:187], v241 offset:11728
    ds_read_b64_tr_b16 v[188:189], v242 offset:6048
    ds_read_b64_tr_b16 v[190:191], v242 offset:6016
    ds_read_b128 v[192:195], v241 offset:12240
    v_mfma_f32_16x16x32_bf16 v[200:203], v[136:139], v[132:135], 0
    ds_write_addtid_b32 v221 offset:22016
    v_add_f32_dpp v212, v227, v226 wave_ror:1 row_mask:0xf bank_mask:0xf bound_ctrl:0
    s_waitcnt lgkmcnt(15)
    v_mfma_f32_16x16x32_bf16 v[204:207], v[152:155], v[140:143], 0
    ds_read_b64_tr_b16 v[4:5], v242 offset:6304
    v_add_f32_dpp v226, v227, v226 wave_shr:1 row_mask:0xf bank_mask:0xf bound_ctrl:0
    v_mfma_f32_16x16x32_bf16 v[204:207], v[144:147], v[148:151], v[204:207]
    buffer_load_dwordx4 a[124:127], v252, s[40:43], s67 offen offset:3072 sc1
    v_mfma_f32_16x16x32_bf16 v[204:207], v[160:163], v[132:135], v[204:207]
    ds_read_b64_tr_b16 v[6:7], v242 offset:6272
    s_add_u32 s67, s67, 4096
    v_mfma_f32_16x16x32_bf16 v[204:207], v[136:139], v[156:159], v[204:207]
    ds_read_b128 v[8:11], v241 offset:12752
    v_add_f32_dpp v213, v212, v225 wave_ror:1 row_mask:0xf bank_mask:0xf bound_ctrl:0
    s_waitcnt lgkmcnt(14)
    v_mfma_f32_16x16x32_bf16 v[208:211], v[152:155], v[148:151], 0
    ds_read_b64_tr_b16 v[12:13], v242 offset:6560
    v_add_f32_dpp v225, v226, v225 wave_shr:1 row_mask:0xf bank_mask:0xf bound_ctrl:0
    v_mfma_f32_16x16x32_bf16 v[208:211], v[160:163], v[140:143], v[208:211]
    ds_read_b64_tr_b16 v[14:15], v242 offset:6528
    v_add_f32_dpp v214, v213, v224 wave_ror:1 row_mask:0xf bank_mask:0xf bound_ctrl:0
    v_mfma_f32_16x16x32_bf16 v[208:211], v[144:147], v[156:159], v[208:211]
    buffer_load_dwordx4 a[128:131], v252, s[40:43], s67 offen offset:0 sc1
    v_mfma_f32_16x16x32_bf16 v[208:211], v[168:171], v[132:135], v[208:211]
    ds_read_b128 v[16:19], v241 offset:13264
    v_add_f32_dpp v224, v225, v224 wave_shr:1 row_mask:0xf bank_mask:0xf bound_ctrl:0
    v_mfma_f32_16x16x32_bf16 v[208:211], v[136:139], v[164:167], v[208:211]
    ds_read_b64_tr_b16 v[20:21], v242 offset:6816
    v_sub_f32 v225, v214, v224
    s_waitcnt lgkmcnt(11)
    v_mfma_f32_16x16x32_bf16 v[216:219], v[168:171], v[156:159], 0
    ds_write_addtid_b32 v224 offset:6144
    v_mfma_f32_16x16x32_bf16 v[216:219], v[160:163], v[164:167], v[216:219]
    ds_write_addtid_b32 v225 offset:22528
    v_add_f32_dpp v212, v199, v198 wave_ror:1 row_mask:0xf bank_mask:0xf bound_ctrl:0
    v_mfma_f32_16x16x32_bf16 v[216:219], v[176:179], v[148:151], v[216:219]
    buffer_load_dwordx4 a[132:135], v252, s[40:43], s67 offen offset:1024 sc1
    v_mfma_f32_16x16x32_bf16 v[216:219], v[152:155], v[172:175], v[216:219]
    ds_read_b64_tr_b16 v[22:23], v242 offset:6784
    v_add_f32_dpp v198, v199, v198 wave_shr:1 row_mask:0xf bank_mask:0xf bound_ctrl:0
    v_mfma_f32_16x16x32_bf16 v[216:219], v[184:187], v[140:143], v[216:219]
    ds_read_b128 v[24:27], v241 offset:13776
    v_add_f32_dpp v213, v212, v197 wave_ror:1 row_mask:0xf bank_mask:0xf bound_ctrl:0
    v_mfma_f32_16x16x32_bf16 v[216:219], v[144:147], v[180:183], v[216:219]
    ds_read_b64_tr_b16 v[28:29], v242 offset:7072
    v_add_f32_dpp v197, v198, v197 wave_shr:1 row_mask:0xf bank_mask:0xf bound_ctrl:0
    s_waitcnt lgkmcnt(13)
    v_mfma_f32_16x16x32_bf16 v[216:219], v[192:195], v[132:135], v[216:219]
    ds_read_b64_tr_b16 v[30:31], v242 offset:7040
    v_add_f32_dpp v214, v213, v196 wave_ror:1 row_mask:0xf bank_mask:0xf bound_ctrl:0
    v_mfma_f32_16x16x32_bf16 v[216:219], v[136:139], v[188:191], v[216:219]
    buffer_load_dwordx4 a[136:139], v252, s[40:43], s67 offen offset:2048 sc1
    v_mfma_f32_16x16x32_bf16 v[220:223], v[168:171], v[164:167], 0
    ds_read_b128 v[32:35], v241 offset:14288
    v_add_f32_dpp v196, v197, v196 wave_shr:1 row_mask:0xf bank_mask:0xf bound_ctrl:0
    v_mfma_f32_16x16x32_bf16 v[220:223], v[176:179], v[156:159], v[220:223]
    ds_read_b64_tr_b16 v[36:37], v242 offset:7328
    v_sub_f32 v197, v214, v196
    v_mfma_f32_16x16x32_bf16 v[220:223], v[160:163], v[172:175], v[220:223]
    ds_write_addtid_b32 v196 offset:7680
    v_mfma_f32_16x16x32_bf16 v[220:223], v[184:187], v[148:151], v[220:223]
    ds_write_addtid_b32 v197 offset:24064
    v_add_f32_dpp v212, v203, v202 wave_ror:1 row_mask:0xf bank_mask:0xf bound_ctrl:0
    v_mfma_f32_16x16x32_bf16 v[220:223], v[152:155], v[180:183], v[220:223]
    buffer_load_dwordx4 a[140:143], v252, s[40:43], s67 offen offset:3072 sc1
    v_mfma_f32_16x16x32_bf16 v[220:223], v[192:195], v[140:143], v[220:223]
    ds_read_b64_tr_b16 v[38:39], v242 offset:7296
    s_add_u32 s67, s67, 4096
    v_mfma_f32_16x16x32_bf16 v[220:223], v[144:147], v[188:191], v[220:223]
    ds_read_b128 v[40:43], v241 offset:14800
    v_add_f32_dpp v202, v203, v202 wave_shr:1 row_mask:0xf bank_mask:0xf bound_ctrl:0
    s_waitcnt lgkmcnt(15)
    v_mfma_f32_16x16x32_bf16 v[220:223], v[8:11], v[132:135], v[220:223]
    ds_read_b64_tr_b16 v[44:45], v242 offset:7584
    v_add_f32_dpp v213, v212, v201 wave_ror:1 row_mask:0xf bank_mask:0xf bound_ctrl:0
    v_mfma_f32_16x16x32_bf16 v[220:223], v[136:139], v[4:7], v[220:223]
    ds_read_b64_tr_b16 v[46:47], v242 offset:7552
    v_add_f32_dpp v201, v202, v201 wave_shr:1 row_mask:0xf bank_mask:0xf bound_ctrl:0
    v_mfma_f32_16x16x32_bf16 v[224:227], v[184:187], v[172:175], 0
    buffer_load_dwordx4 a[144:147], v252, s[40:43], s67 offen offset:0 sc1
    v_mfma_f32_16x16x32_bf16 v[224:227], v[176:179], v[180:183], v[224:227]
    ds_read_b128 v[48:51], v241 offset:15312
    v_add_f32_dpp v214, v213, v200 wave_ror:1 row_mask:0xf bank_mask:0xf bound_ctrl:0
    v_mfma_f32_16x16x32_bf16 v[224:227], v[192:195], v[164:167], v[224:227]
    ds_read_b64_tr_b16 v[52:53], v242 offset:7840
    v_add_f32_dpp v200, v201, v200 wave_shr:1 row_mask:0xf bank_mask:0xf bound_ctrl:0
    v_mfma_f32_16x16x32_bf16 v[224:227], v[168:171], v[188:191], v[224:227]
    ds_read_b64_tr_b16 v[54:55], v242 offset:7808
    v_sub_f32 v201, v214, v200
    v_mfma_f32_16x16x32_bf16 v[224:227], v[8:11], v[156:159], v[224:227]
    ds_write_addtid_b32 v200 offset:8192
    v_mfma_f32_16x16x32_bf16 v[224:227], v[160:163], v[4:7], v[224:227]
    buffer_load_dwordx4 a[148:151], v252, s[40:43], s67 offen offset:1024 sc1
    s_waitcnt lgkmcnt(15)
    v_mfma_f32_16x16x32_bf16 v[224:227], v[16:19], v[148:151], v[224:227]
    ds_write_addtid_b32 v201 offset:24576
    v_add_f32_dpp v212, v207, v206 wave_ror:1 row_mask:0xf bank_mask:0xf bound_ctrl:0
    v_mfma_f32_16x16x32_bf16 v[224:227], v[152:155], v[12:15], v[224:227]
    ds_read_b128 v[56:59], v241 offset:15824
    v_add_f32_dpp v206, v207, v206 wave_shr:1 row_mask:0xf bank_mask:0xf bound_ctrl:0
    s_waitcnt lgkmcnt(15)
    v_mfma_f32_16x16x32_bf16 v[224:227], v[24:27], v[140:143], v[224:227]
    ds_read_b64_tr_b16 v[60:61], v242 offset:8096
    v_add_f32_dpp v213, v212, v205 wave_ror:1 row_mask:0xf bank_mask:0xf bound_ctrl:0
    v_mfma_f32_16x16x32_bf16 v[224:227], v[144:147], v[20:23], v[224:227]
    ds_read_b64_tr_b16 v[62:63], v242 offset:8064
L_padH3:
    s_cmp_lg_u32 s3, 0
    s_cbranch_scc1 L_padT0
    v_add_f32_dpp v205, v206, v205 wave_shr:1 row_mask:0xf bank_mask:0xf bound_ctrl:0
    s_waitcnt lgkmcnt(15)
    v_mfma_f32_16x16x32_bf16 v[224:227], v[32:35], v[132:135], v[224:227]
    buffer_load_dwordx4 a[152:155], v252, s[40:43], s67 offen offset:2048 sc1
    v_mfma_f32_16x16x32_bf16 v[224:227], v[136:139], v[28:31], v[224:227]
    ds_read_b128 v[64:67], v241 offset:16336
    v_add_f32_dpp v214, v213, v204 wave_ror:1 row_mask:0xf bank_mask:0xf bound_ctrl:0
    v_mfma_f32_16x16x32_bf16 v[196:199], v[184:187], v[180:183], 0
    v_add_f32_dpp v204, v205, v204 wave_shr:1 row_mask:0xf bank_mask:0xf bound_ctrl:0
    v_sub_f32 v205, v214, v204
    v_mfma_f32_16x16x32_bf16 v[196:199], v[192:195], v[172:175], v[196:199]
    ds_write_addtid_b32 v204 offset:9728
    v_mfma_f32_16x16x32_bf16 v[196:199], v[176:179], v[188:191], v[196:199]
    ds_write_addtid_b32 v205 offset:26112
    v_add_f32_dpp v212, v211, v210 wave_ror:1 row_mask:0xf bank_mask:0xf bound_ctrl:0
    v_mfma_f32_16x16x32_bf16 v[196:199], v[8:11], v[164:167], v[196:199]
    buffer_load_dwordx4 a[156:159], v252, s[40:43], s67 offen offset:3072 sc1
    v_mfma_f32_16x16x32_bf16 v[196:199], v[168:171], v[4:7], v[196:199]
    s_add_u32 s67, s67, 4096
    v_add_f32_dpp v210, v211, v210 wave_shr:1 row_mask:0xf bank_mask:0xf bound_ctrl:0
    v_mfma_f32_16x16x32_bf16 v[196:199], v[16:19], v[156:159], v[196:199]
    v_add_f32_dpp v213, v212, v209 wave_ror:1 row_mask:0xf bank_mask:0xf bound_ctrl:0
    v_add_f32_dpp v209, v210, v209 wave_shr:1 row_mask:0xf bank_mask:0xf bound_ctrl:0
    v_mfma_f32_16x16x32_bf16 v[196:199], v[160:163], v[12:15], v[196:199]
    v_add_f32_dpp v214, v213, v208 wave_ror:1 row_mask:0xf bank_mask:0xf bound_ctrl:0
    v_add_f32_dpp v208, v209, v208 wave_shr:1 row_mask:0xf bank_mask:0xf bound_ctrl:0
    v_mfma_f32_16x16x32_bf16 v[196:199], v[24:27], v[148:151], v[196:199]
    v_sub_f32 v209, v214, v208
    v_mfma_f32_16x16x32_bf16 v[196:199], v[152:155], v[20:23], v[196:199]
    buffer_load_dwordx4 a[160:163], v252, s[40:43], s67 offen offset:0 sc1
    v_mfma_f32_16x16x32_bf16 v[196:199], v[32:35], v[140:143], v[196:199]
    ds_write_addtid_b32 v208 offset:10240
    v_mfma_f32_16x16x32_bf16 v[196:199], v[144:147], v[28:31], v[196:199]
    ds_write_addtid_b32 v209 offset:26624
    v_add_f32_dpp v212, v219, v218 wave_ror:1 row_mask:0xf bank_mask:0xf bound_ctrl:0
    s_waitcnt lgkmcnt(15)
    v_mfma_f32_16x16x32_bf16 v[196:199], v[40:43], v[132:135], v[196:199]
    v_add_f32_dpp v218, v219, v218 wave_shr:1 row_mask:0xf bank_mask:0xf bound_ctrl:0
    v_add_f32_dpp v213, v212, v217 wave_ror:1 row_mask:0xf bank_mask:0xf bound_ctrl:0
    v_mfma_f32_16x16x32_bf16 v[196:199], v[136:139], v[36:39], v[196:199]
    v_add_f32_dpp v217, v218, v217 wave_shr:1 row_mask:0xf bank_mask:0xf bound_ctrl:0
    v_add_f32_dpp v214, v213, v216 wave_ror:1 row_mask:0xf bank_mask:0xf bound_ctrl:0
    v_mfma_f32_16x16x32_bf16 v[200:203], v[8:11], v[188:191], 0
    v_add_f32_dpp v216, v217, v216 wave_shr:1 row_mask:0xf bank_mask:0xf bound_ctrl:0
    v_sub_f32 v217, v214, v216
    v_mfma_f32_16x16x32_bf16 v[200:203], v[192:195], v[4:7], v[200:203]
    ds_write_addtid_b32 v216 offset:11776
    v_mfma_f32_16x16x32_bf16 v[200:203], v[16:19], v[180:183], v[200:203]
    ds_write_addtid_b32 v217 offset:28160
    v_add_f32_dpp v212, v223, v222 wave_ror:1 row_mask:0xf bank_mask:0xf bound_ctrl:0
    v_mfma_f32_16x16x32_bf16 v[200:203], v[184:187], v[12:15], v[200:203]
    v_add_f32_dpp v222, v223, v222 wave_shr:1 row_mask:0xf bank_mask:0xf bound_ctrl:0
    v_add_f32_dpp v213, v212, v221 wave_ror:1 row_mask:0xf bank_mask:0xf bound_ctrl:0
    v_mfma_f32_16x16x32_bf16 v[200:203], v[24:27], v[172:175], v[200:203]
    v_add_f32_dpp v221, v222, v221 wave_shr:1 row_mask:0xf bank_mask:0xf bound_ctrl:0
    v_add_f32_dpp v214, v213, v220 wave_ror:1 row_mask:0xf bank_mask:0xf bound_ctrl:0
    v_mfma_f32_16x16x32_bf16 v[200:203], v[176:179], v[20:23], v[200:203]
    v_add_f32_dpp v220, v221, v220 wave_shr:1 row_mask:0xf bank_mask:0xf bound_ctrl:0
    v_sub_f32 v221, v214, v220
    v_mfma_f32_16x16x32_bf16 v[200:203], v[32:35], v[164:167], v[200:203]
    ds_write_addtid_b32 v220 offset:12288
    v_mfma_f32_16x16x32_bf16 v[200:203], v[168:171], v[28:31], v[200:203]
    ds_write_addtid_b32 v221 offset:28672
    v_add_f32_dpp v212, v227, v226 wave_ror:1 row_mask:0xf bank_mask:0xf bound_ctrl:0
    v_mfma_f32_16x16x32_bf16 v[200:203], v[40:43], v[156:159], v[200:203]
    v_add_f32_dpp v226, v227, v226 wave_shr:1 row_mask:0xf bank_mask:0xf bound_ctrl:0
    v_add_f32_dpp v213, v212, v225 wave_ror:1 row_mask:0xf bank_mask:0xf bound_ctrl:0
    v_mfma_f32_16x16x32_bf16 v[200:203], v[160:163], v[36:39], v[200:203]
    v_add_f32_dpp v225, v226, v225 wave_shr:1 row_mask:0xf bank_mask:0xf bound_ctrl:0
    v_add_f32_dpp v214, v213, v224 wave_ror:1 row_mask:0xf bank_mask:0xf bound_ctrl:0
    s_waitcnt lgkmcnt(15)
    v_mfma_f32_16x16x32_bf16 v[200:203], v[48:51], v[148:151], v[200:203]
    v_add_f32_dpp v224, v225, v224 wave_shr:1 row_mask:0xf bank_mask:0xf bound_ctrl:0
    v_sub_f32 v225, v214, v224
    v_mfma_f32_16x16x32_bf16 v[200:203], v[152:155], v[44:47], v[200:203]
    ds_write_addtid_b32 v224 offset:13824
    s_waitcnt lgkmcnt(12)
    v_mfma_f32_16x16x32_bf16 v[200:203], v[56:59], v[140:143], v[200:203]
    ds_write_addtid_b32 v225 offset:30208
    v_add_f32_dpp v212, v199, v198 wave_ror:1 row_mask:0xf bank_mask:0xf bound_ctrl:0
    v_mfma_f32_16x16x32_bf16 v[200:203], v[144:147], v[52:55], v[200:203]
    v_add_f32_dpp v198, v199, v198 wave_shr:1 row_mask:0xf bank_mask:0xf bound_ctrl:0
    v_add_f32_dpp v213, v212, v197 wave_ror:1 row_mask:0xf bank_mask:0xf bound_ctrl:0
    s_waitcnt lgkmcnt(10)
    v_mfma_f32_16x16x32_bf16 v[200:203], v[64:67], v[132:135], v[200:203]
    v_add_f32_dpp v197, v198, v197 wave_shr:1 row_mask:0xf bank_mask:0xf bound_ctrl:0
    v_add_f32_dpp v214, v213, v196 wave_ror:1 row_mask:0xf bank_mask:0xf bound_ctrl:0
    v_mfma_f32_16x16x32_bf16 v[200:203], v[136:139], v[60:63], v[200:203]
    v_add_f32_dpp v196, v197, v196 wave_shr:1 row_mask:0xf bank_mask:0xf bound_ctrl:0
    v_sub_f32 v197, v214, v196
    ds_write_addtid_b32 v196 offset:14336
    ds_write_addtid_b32 v197 offset:30720
    s_nop 3
    v_add_f32_dpp v212, v203, v202 wave_ror:1 row_mask:0xf bank_mask:0xf bound_ctrl:0
    v_add_f32_dpp v202, v203, v202 wave_shr:1 row_mask:0xf bank_mask:0xf bound_ctrl:0
    s_nop 0
    v_add_f32_dpp v213, v212, v201 wave_ror:1 row_mask:0xf bank_mask:0xf bound_ctrl:0
    v_add_f32_dpp v201, v202, v201 wave_shr:1 row_mask:0xf bank_mask:0xf bound_ctrl:0
    s_nop 0
    v_add_f32_dpp v214, v213, v200 wave_ror:1 row_mask:0xf bank_mask:0xf bound_ctrl:0
    v_add_f32_dpp v200, v201, v200 wave_shr:1 row_mask:0xf bank_mask:0xf bound_ctrl:0
    v_sub_f32 v201, v214, v200
    ds_write_addtid_b32 v200 offset:15872
    ds_write_addtid_b32 v201 offset:32256
    s_waitcnt lgkmcnt(0)
    s_branch L_cvEh
.p2align 3
L_cvBh:
L_padH4:
    s_cmp_lg_u32 s3, 0
    s_cbranch_scc1 L_wdone
    s_waitcnt lgkmcnt(15)
    v_mfma_f32_16x16x32_bf16 v[196:199], v[16:19], v[4:7], 0
    buffer_load_dwordx4 a[68:71], v252, s[40:43], s67 offen offset:1024 sc1
    v_mfma_f32_16x16x32_bf16 v[196:199], v[8:11], v[12:15], v[196:199]
    ds_read_b64_tr_b16 v[68:69], v242 offset:2080
    v_mfma_f32_16x16x32_bf16 v[200:203], v[16:19], v[12:15], 0
    ds_read_b64_tr_b16 v[70:71], v242 offset:2048
    v_mfma_f32_16x16x32_bf16 v[200:203], v[24:27], v[4:7], v[200:203]
    ds_read_b128 v[72:75], v241 offset:4096
    v_mfma_f32_16x16x32_bf16 v[200:203], v[8:11], v[20:23], v[200:203]
    ds_read_b64_tr_b16 v[76:77], v242 offset:2336
    s_waitcnt lgkmcnt(10)
    v_mfma_f32_16x16x32_bf16 v[204:207], v[32:35], v[20:23], 0
    buffer_load_dwordx4 a[72:75], v252, s[40:43], s67 offen offset:2048 sc1
    v_mfma_f32_16x16x32_bf16 v[204:207], v[24:27], v[28:31], v[204:207]
    ds_read_b64_tr_b16 v[78:79], v242 offset:2304
    v_add_f32_dpp v212, v199, v198 wave_ror:1 row_mask:0xf bank_mask:0xf bound_ctrl:0
    v_mfma_f32_16x16x32_bf16 v[204:207], v[40:43], v[12:15], v[204:207]
    ds_read_b128 v[80:83], v241 offset:4608
    v_add_f32_dpp v198, v199, v198 wave_shr:1 row_mask:0xf bank_mask:0xf bound_ctrl:0
    v_mfma_f32_16x16x32_bf16 v[204:207], v[16:19], v[36:39], v[204:207]
    ds_read_b64_tr_b16 v[84:85], v242 offset:2592
    v_add_f32_dpp v213, v212, v197 wave_ror:1 row_mask:0xf bank_mask:0xf bound_ctrl:0
    v_mfma_f32_16x16x32_bf16 v[204:207], v[48:51], v[4:7], v[204:207]
    ds_read_b64_tr_b16 v[86:87], v242 offset:2560
    v_add_f32_dpp v197, v198, v197 wave_shr:1 row_mask:0xf bank_mask:0xf bound_ctrl:0
    v_mfma_f32_16x16x32_bf16 v[204:207], v[8:11], v[44:47], v[204:207]
    buffer_load_dwordx4 a[76:79], v252, s[40:43], s67 offen offset:3072 sc1
    s_waitcnt lgkmcnt(11)
    v_mfma_f32_16x16x32_bf16 v[208:211], v[32:35], v[28:31], 0
    ds_read_b128 v[88:91], v241 offset:5120
    s_add_u32 s67, s67, 4096
    v_mfma_f32_16x16x32_bf16 v[208:211], v[40:43], v[20:23], v[208:211]
    ds_read_b64_tr_b16 v[92:93], v242 offset:2848
    v_add_f32_dpp v214, v213, v196 wave_ror:1 row_mask:0xf bank_mask:0xf bound_ctrl:0
    v_mfma_f32_16x16x32_bf16 v[208:211], v[24:27], v[36:39], v[208:211]
    ds_read_b64_tr_b16 v[94:95], v242 offset:2816
    v_add_f32_dpp v196, v197, v196 wave_shr:1 row_mask:0xf bank_mask:0xf bound_ctrl:0
    v_mfma_f32_16x16x32_bf16 v[208:211], v[48:51], v[12:15], v[208:211]
    ds_read_b128 v[96:99], v241 offset:5632
    v_sub_f32 v197, v214, v196
    v_mfma_f32_16x16x32_bf16 v[208:211], v[16:19], v[44:47], v[208:211]
    buffer_load_dwordx4 a[80:83], v252, s[40:43], s67 offen offset:0 sc1
    v_mfma_f32_16x16x32_bf16 v[208:211], v[56:59], v[4:7], v[208:211]
    ds_write_addtid_b32 v196 offset:512
    v_mfma_f32_16x16x32_bf16 v[208:211], v[8:11], v[52:55], v[208:211]
    ds_write_addtid_b32 v197 offset:16896
    v_add_f32_dpp v212, v203, v202 wave_ror:1 row_mask:0xf bank_mask:0xf bound_ctrl:0
    s_waitcnt lgkmcnt(14)
    v_mfma_f32_16x16x32_bf16 v[216:219], v[48:51], v[36:39], 0
    ds_read_b64_tr_b16 v[100:101], v242 offset:3104
    v_add_f32_dpp v202, v203, v202 wave_shr:1 row_mask:0xf bank_mask:0xf bound_ctrl:0
    v_mfma_f32_16x16x32_bf16 v[216:219], v[40:43], v[44:47], v[216:219]
    ds_read_b64_tr_b16 v[102:103], v242 offset:3072
    v_add_f32_dpp v213, v212, v201 wave_ror:1 row_mask:0xf bank_mask:0xf bound_ctrl:0
    v_mfma_f32_16x16x32_bf16 v[216:219], v[56:59], v[28:31], v[216:219]
    buffer_load_dwordx4 a[84:87], v252, s[40:43], s67 offen offset:1024 sc1
    v_mfma_f32_16x16x32_bf16 v[216:219], v[32:35], v[52:55], v[216:219]
    ds_read_b128 v[104:107], v241 offset:6144
    v_add_f32_dpp v201, v202, v201 wave_shr:1 row_mask:0xf bank_mask:0xf bound_ctrl:0
    v_mfma_f32_16x16x32_bf16 v[216:219], v[64:67], v[20:23], v[216:219]
    ds_read_b64_tr_b16 v[108:109], v242 offset:3360
    v_add_f32_dpp v214, v213, v200 wave_ror:1 row_mask:0xf bank_mask:0xf bound_ctrl:0
    v_mfma_f32_16x16x32_bf16 v[216:219], v[24:27], v[60:63], v[216:219]
    ds_read_b64_tr_b16 v[110:111], v242 offset:3328
    v_add_f32_dpp v200, v201, v200 wave_shr:1 row_mask:0xf bank_mask:0xf bound_ctrl:0
    s_waitcnt lgkmcnt(15)
    v_mfma_f32_16x16x32_bf16 v[216:219], v[72:75], v[12:15], v[216:219]
    ds_read_b128 v[112:115], v241 offset:6656
    v_sub_f32 v201, v214, v200
    v_mfma_f32_16x16x32_bf16 v[216:219], v[16:19], v[68:71], v[216:219]
    buffer_load_dwordx4 a[88:91], v252, s[40:43], s67 offen offset:2048 sc1
    s_waitcnt lgkmcnt(14)
    v_mfma_f32_16x16x32_bf16 v[216:219], v[80:83], v[4:7], v[216:219]
    ds_write_addtid_b32 v200 offset:1024
    v_mfma_f32_16x16x32_bf16 v[216:219], v[8:11], v[76:79], v[216:219]
    ds_write_addtid_b32 v201 offset:17408
    v_add_f32_dpp v212, v207, v206 wave_ror:1 row_mask:0xf bank_mask:0xf bound_ctrl:0
    v_mfma_f32_16x16x32_bf16 v[220:223], v[48:51], v[44:47], 0
    ds_read_b64_tr_b16 v[116:117], v242 offset:3616
    v_add_f32_dpp v206, v207, v206 wave_shr:1 row_mask:0xf bank_mask:0xf bound_ctrl:0
    v_mfma_f32_16x16x32_bf16 v[220:223], v[56:59], v[36:39], v[220:223]
    ds_read_b64_tr_b16 v[118:119], v242 offset:3584
    v_add_f32_dpp v213, v212, v205 wave_ror:1 row_mask:0xf bank_mask:0xf bound_ctrl:0
    v_mfma_f32_16x16x32_bf16 v[220:223], v[40:43], v[52:55], v[220:223]
    buffer_load_dwordx4 a[92:95], v252, s[40:43], s67 offen offset:3072 sc1
    v_mfma_f32_16x16x32_bf16 v[220:223], v[64:67], v[28:31], v[220:223]
    ds_read_b128 v[120:123], v241 offset:7168
    s_add_u32 s67, s67, 4096
    v_mfma_f32_16x16x32_bf16 v[220:223], v[32:35], v[60:63], v[220:223]
    ds_read_b64_tr_b16 v[132:133], v242 offset:4256
    v_add_f32_dpp v205, v206, v205 wave_shr:1 row_mask:0xf bank_mask:0xf bound_ctrl:0
    v_mfma_f32_16x16x32_bf16 v[220:223], v[72:75], v[20:23], v[220:223]
    ds_read_b64_tr_b16 v[134:135], v242 offset:4224
    v_add_f32_dpp v214, v213, v204 wave_ror:1 row_mask:0xf bank_mask:0xf bound_ctrl:0
    v_mfma_f32_16x16x32_bf16 v[220:223], v[24:27], v[68:71], v[220:223]
    ds_read_b128 v[136:139], v241 offset:8656
    v_add_f32_dpp v204, v205, v204 wave_shr:1 row_mask:0xf bank_mask:0xf bound_ctrl:0
    v_mfma_f32_16x16x32_bf16 v[220:223], v[80:83], v[12:15], v[220:223]
    buffer_load_dwordx4 a[96:99], v252, s[40:43], s67 offen offset:0 sc1
    v_mfma_f32_16x16x32_bf16 v[220:223], v[16:19], v[76:79], v[220:223]
    ds_read_b64_tr_b16 v[140:141], v242 offset:4512
    v_sub_f32 v205, v214, v204
    s_waitcnt lgkmcnt(15)
    v_mfma_f32_16x16x32_bf16 v[220:223], v[88:91], v[4:7], v[220:223]
    ds_write_addtid_b32 v204 offset:2560
    v_mfma_f32_16x16x32_bf16 v[220:223], v[8:11], v[84:87], v[220:223]
    ds_write_addtid_b32 v205 offset:18944
    v_add_f32_dpp v212, v211, v210 wave_ror:1 row_mask:0xf bank_mask:0xf bound_ctrl:0
    v_mfma_f32_16x16x32_bf16 v[224:227], v[64:67], v[52:55], 0
    ds_read_b64_tr_b16 v[142:143], v242 offset:4480
    v_add_f32_dpp v210, v211, v210 wave_shr:1 row_mask:0xf bank_mask:0xf bound_ctrl:0
    v_mfma_f32_16x16x32_bf16 v[224:227], v[56:59], v[60:63], v[224:227]
    buffer_load_dwordx4 a[100:103], v252, s[40:43], s67 offen offset:1024 sc1
    v_mfma_f32_16x16x32_bf16 v[224:227], v[72:75], v[44:47], v[224:227]
    ds_read_b128 v[144:147], v241 offset:9168
    v_add_f32_dpp v213, v212, v209 wave_ror:1 row_mask:0xf bank_mask:0xf bound_ctrl:0
    v_mfma_f32_16x16x32_bf16 v[224:227], v[48:51], v[68:71], v[224:227]
    ds_read_b64_tr_b16 v[148:149], v242 offset:4768
    v_add_f32_dpp v209, v210, v209 wave_shr:1 row_mask:0xf bank_mask:0xf bound_ctrl:0
    v_mfma_f32_16x16x32_bf16 v[224:227], v[80:83], v[36:39], v[224:227]
    ds_read_b64_tr_b16 v[150:151], v242 offset:4736
    v_add_f32_dpp v214, v213, v208 wave_ror:1 row_mask:0xf bank_mask:0xf bound_ctrl:0
    v_mfma_f32_16x16x32_bf16 v[224:227], v[40:43], v[76:79], v[224:227]
    ds_read_b128 v[152:155], v241 offset:9680
    v_add_f32_dpp v208, v209, v208 wave_shr:1 row_mask:0xf bank_mask:0xf bound_ctrl:0
    v_mfma_f32_16x16x32_bf16 v[224:227], v[88:91], v[28:31], v[224:227]
    buffer_load_dwordx4 a[104:107], v252, s[40:43], s67 offen offset:2048 sc1
    v_mfma_f32_16x16x32_bf16 v[224:227], v[32:35], v[84:87], v[224:227]
    ds_read_b64_tr_b16 v[156:157], v242 offset:5024
    v_sub_f32 v209, v214, v208
    v_mfma_f32_16x16x32_bf16 v[224:227], v[96:99], v[20:23], v[224:227]
    ds_write_addtid_b32 v208 offset:3072
    v_mfma_f32_16x16x32_bf16 v[224:227], v[24:27], v[92:95], v[224:227]
    ds_write_addtid_b32 v209 offset:19456
    v_add_f32_dpp v212, v219, v218 wave_ror:1 row_mask:0xf bank_mask:0xf bound_ctrl:0
    s_waitcnt lgkmcnt(15)
    v_mfma_f32_16x16x32_bf16 v[224:227], v[104:107], v[12:15], v[224:227]
    ds_read_b64_tr_b16 v[158:159], v242 offset:4992
    v_add_f32_dpp v218, v219, v218 wave_shr:1 row_mask:0xf bank_mask:0xf bound_ctrl:0
    v_mfma_f32_16x16x32_bf16 v[224:227], v[16:19], v[100:103], v[224:227]
    buffer_load_dwordx4 a[108:111], v252, s[40:43], s67 offen offset:3072 sc1
    v_mfma_f32_16x16x32_bf16 v[224:227], v[112:115], v[4:7], v[224:227]
    ds_read_b128 v[160:163], v241 offset:10192
    s_add_u32 s67, s67, 4096
    v_mfma_f32_16x16x32_bf16 v[224:227], v[8:11], v[108:111], v[224:227]
    ds_read_b64_tr_b16 v[164:165], v242 offset:5280
    v_add_f32_dpp v213, v212, v217 wave_ror:1 row_mask:0xf bank_mask:0xf bound_ctrl:0
    v_mfma_f32_16x16x32_bf16 v[196:199], v[64:67], v[60:63], 0
    ds_read_b64_tr_b16 v[166:167], v242 offset:5248
    v_add_f32_dpp v217, v218, v217 wave_shr:1 row_mask:0xf bank_mask:0xf bound_ctrl:0
    v_mfma_f32_16x16x32_bf16 v[196:199], v[72:75], v[52:55], v[196:199]
    ds_read_b128 v[168:171], v241 offset:10704
    v_add_f32_dpp v214, v213, v216 wave_ror:1 row_mask:0xf bank_mask:0xf bound_ctrl:0
    v_mfma_f32_16x16x32_bf16 v[196:199], v[56:59], v[68:71], v[196:199]
    buffer_load_dwordx4 a[112:115], v252, s[40:43], s67 offen offset:0 sc1
    v_mfma_f32_16x16x32_bf16 v[196:199], v[80:83], v[44:47], v[196:199]
    ds_read_b64_tr_b16 v[172:173], v242 offset:5536
    v_add_f32_dpp v216, v217, v216 wave_shr:1 row_mask:0xf bank_mask:0xf bound_ctrl:0
    v_mfma_f32_16x16x32_bf16 v[196:199], v[48:51], v[76:79], v[196:199]
    ds_read_b64_tr_b16 v[174:175], v242 offset:5504
    v_sub_f32 v217, v214, v216
    v_mfma_f32_16x16x32_bf16 v[196:199], v[88:91], v[36:39], v[196:199]
    ds_write_addtid_b32 v216 offset:4608
    v_mfma_f32_16x16x32_bf16 v[196:199], v[40:43], v[84:87], v[196:199]
    ds_write_addtid_b32 v217 offset:20992
    v_add_f32_dpp v212, v223, v222 wave_ror:1 row_mask:0xf bank_mask:0xf bound_ctrl:0
    v_mfma_f32_16x16x32_bf16 v[196:199], v[96:99], v[28:31], v[196:199]
    buffer_load_dwordx4 a[116:119], v252, s[40:43], s67 offen offset:1024 sc1
    v_mfma_f32_16x16x32_bf16 v[196:199], v[32:35], v[92:95], v[196:199]
    ds_read_b128 v[176:179], v241 offset:11216
    v_add_f32_dpp v222, v223, v222 wave_shr:1 row_mask:0xf bank_mask:0xf bound_ctrl:0
    v_mfma_f32_16x16x32_bf16 v[196:199], v[104:107], v[20:23], v[196:199]
    ds_read_b64_tr_b16 v[180:181], v242 offset:5792
    v_add_f32_dpp v213, v212, v221 wave_ror:1 row_mask:0xf bank_mask:0xf bound_ctrl:0
    v_mfma_f32_16x16x32_bf16 v[196:199], v[24:27], v[100:103], v[196:199]
    ds_read_b64_tr_b16 v[182:183], v242 offset:5760
    v_add_f32_dpp v221, v222, v221 wave_shr:1 row_mask:0xf bank_mask:0xf bound_ctrl:0
    v_mfma_f32_16x16x32_bf16 v[196:199], v[112:115], v[12:15], v[196:199]
    ds_read_b128 v[184:187], v241 offset:11728
    v_add_f32_dpp v214, v213, v220 wave_ror:1 row_mask:0xf bank_mask:0xf bound_ctrl:0
    v_mfma_f32_16x16x32_bf16 v[196:199], v[16:19], v[108:111], v[196:199]
    buffer_load_dwordx4 a[120:123], v252, s[40:43], s67 offen offset:2048 sc1
    s_waitcnt lgkmcnt(15)
    v_mfma_f32_16x16x32_bf16 v[196:199], v[120:123], v[4:7], v[196:199]
    ds_read_b64_tr_b16 v[188:189], v242 offset:6048
    v_add_f32_dpp v220, v221, v220 wave_shr:1 row_mask:0xf bank_mask:0xf bound_ctrl:0
    v_mfma_f32_16x16x32_bf16 v[196:199], v[8:11], v[116:119], v[196:199]
    ds_read_b64_tr_b16 v[190:191], v242 offset:6016
    v_sub_f32 v221, v214, v220
    ds_read_b128 v[192:195], v241 offset:12240
    v_mfma_f32_16x16x32_bf16 v[200:203], v[144:147], v[132:135], 0
    ds_write_addtid_b32 v220 offset:5120
    v_mfma_f32_16x16x32_bf16 v[200:203], v[136:139], v[140:143], v[200:203]
    ds_write_addtid_b32 v221 offset:21504
    v_add_f32_dpp v212, v227, v226 wave_ror:1 row_mask:0xf bank_mask:0xf bound_ctrl:0
    v_mfma_f32_16x16x32_bf16 v[204:207], v[144:147], v[140:143], 0
    buffer_load_dwordx4 a[124:127], v252, s[40:43], s67 offen offset:3072 sc1
    v_mfma_f32_16x16x32_bf16 v[204:207], v[152:155], v[132:135], v[204:207]
    ds_read_b64_tr_b16 v[4:5], v242 offset:6304
    s_add_u32 s67, s67, 4096
    v_mfma_f32_16x16x32_bf16 v[204:207], v[136:139], v[148:151], v[204:207]
    ds_read_b64_tr_b16 v[6:7], v242 offset:6272
    v_add_f32_dpp v226, v227, v226 wave_shr:1 row_mask:0xf bank_mask:0xf bound_ctrl:0
    s_waitcnt lgkmcnt(10)
    v_mfma_f32_16x16x32_bf16 v[208:211], v[160:163], v[148:151], 0
    ds_read_b128 v[8:11], v241 offset:12752
    v_add_f32_dpp v213, v212, v225 wave_ror:1 row_mask:0xf bank_mask:0xf bound_ctrl:0
    v_mfma_f32_16x16x32_bf16 v[208:211], v[152:155], v[156:159], v[208:211]
    ds_read_b64_tr_b16 v[12:13], v242 offset:6560
    v_add_f32_dpp v225, v226, v225 wave_shr:1 row_mask:0xf bank_mask:0xf bound_ctrl:0
    v_mfma_f32_16x16x32_bf16 v[208:211], v[168:171], v[140:143], v[208:211]
    buffer_load_dwordx4 a[128:131], v252, s[40:43], s67 offen offset:0 sc1
    v_mfma_f32_16x16x32_bf16 v[208:211], v[144:147], v[164:167], v[208:211]
    ds_read_b64_tr_b16 v[14:15], v242 offset:6528
    v_add_f32_dpp v214, v213, v224 wave_ror:1 row_mask:0xf bank_mask:0xf bound_ctrl:0
    v_mfma_f32_16x16x32_bf16 v[208:211], v[176:179], v[132:135], v[208:211]
    ds_read_b128 v[16:19], v241 offset:13264
    v_add_f32_dpp v224, v225, v224 wave_shr:1 row_mask:0xf bank_mask:0xf bound_ctrl:0
    v_mfma_f32_16x16x32_bf16 v[208:211], v[136:139], v[172:175], v[208:211]
    ds_read_b64_tr_b16 v[20:21], v242 offset:6816
    v_sub_f32 v225, v214, v224
    s_waitcnt lgkmcnt(12)
    v_mfma_f32_16x16x32_bf16 v[216:219], v[160:163], v[156:159], 0
    ds_write_addtid_b32 v224 offset:6656
    v_mfma_f32_16x16x32_bf16 v[216:219], v[168:171], v[148:151], v[216:219]
    buffer_load_dwordx4 a[132:135], v252, s[40:43], s67 offen offset:1024 sc1
    v_mfma_f32_16x16x32_bf16 v[216:219], v[152:155], v[164:167], v[216:219]
    ds_write_addtid_b32 v225 offset:23040
    v_add_f32_dpp v212, v199, v198 wave_ror:1 row_mask:0xf bank_mask:0xf bound_ctrl:0
    v_mfma_f32_16x16x32_bf16 v[216:219], v[176:179], v[140:143], v[216:219]
    ds_read_b64_tr_b16 v[22:23], v242 offset:6784
    v_add_f32_dpp v198, v199, v198 wave_shr:1 row_mask:0xf bank_mask:0xf bound_ctrl:0
    v_mfma_f32_16x16x32_bf16 v[216:219], v[144:147], v[172:175], v[216:219]
    ds_read_b128 v[24:27], v241 offset:13776
    v_add_f32_dpp v213, v212, v197 wave_ror:1 row_mask:0xf bank_mask:0xf bound_ctrl:0
    v_mfma_f32_16x16x32_bf16 v[216:219], v[184:187], v[132:135], v[216:219]
    ds_read_b64_tr_b16 v[28:29], v242 offset:7072
    v_add_f32_dpp v197, v198, v197 wave_shr:1 row_mask:0xf bank_mask:0xf bound_ctrl:0
    v_mfma_f32_16x16x32_bf16 v[216:219], v[136:139], v[180:183], v[216:219]
    buffer_load_dwordx4 a[136:139], v252, s[40:43], s67 offen offset:2048 sc1
    s_waitcnt lgkmcnt(14)
    v_mfma_f32_16x16x32_bf16 v[220:223], v[176:179], v[164:167], 0
    ds_read_b64_tr_b16 v[30:31], v242 offset:7040
    v_add_f32_dpp v214, v213, v196 wave_ror:1 row_mask:0xf bank_mask:0xf bound_ctrl:0
    v_mfma_f32_16x16x32_bf16 v[220:223], v[168:171], v[172:175], v[220:223]
    ds_read_b128 v[32:35], v241 offset:14288
    v_add_f32_dpp v196, v197, v196 wave_shr:1 row_mask:0xf bank_mask:0xf bound_ctrl:0
    v_mfma_f32_16x16x32_bf16 v[220:223], v[184:187], v[156:159], v[220:223]
    ds_read_b64_tr_b16 v[36:37], v242 offset:7328
    v_sub_f32 v197, v214, v196
    v_mfma_f32_16x16x32_bf16 v[220:223], v[160:163], v[180:183], v[220:223]
    ds_write_addtid_b32 v196 offset:7168
    v_mfma_f32_16x16x32_bf16 v[220:223], v[192:195], v[148:151], v[220:223]
    buffer_load_dwordx4 a[140:143], v252, s[40:43], s67 offen offset:3072 sc1
    v_mfma_f32_16x16x32_bf16 v[220:223], v[152:155], v[188:191], v[220:223]
    ds_write_addtid_b32 v197 offset:23552
    s_add_u32 s67, s67, 4096
    s_waitcnt lgkmcnt(14)
    v_mfma_f32_16x16x32_bf16 v[220:223], v[8:11], v[140:143], v[220:223]
    ds_read_b64_tr_b16 v[38:39], v242 offset:7296
    v_add_f32_dpp v212, v203, v202 wave_ror:1 row_mask:0xf bank_mask:0xf bound_ctrl:0
    v_mfma_f32_16x16x32_bf16 v[220:223], v[144:147], v[4:7], v[220:223]
    ds_read_b128 v[40:43], v241 offset:14800
    v_add_f32_dpp v202, v203, v202 wave_shr:1 row_mask:0xf bank_mask:0xf bound_ctrl:0
    s_waitcnt lgkmcnt(13)
    v_mfma_f32_16x16x32_bf16 v[220:223], v[16:19], v[132:135], v[220:223]
    ds_read_b64_tr_b16 v[44:45], v242 offset:7584
    v_add_f32_dpp v213, v212, v201 wave_ror:1 row_mask:0xf bank_mask:0xf bound_ctrl:0
    v_mfma_f32_16x16x32_bf16 v[220:223], v[136:139], v[12:15], v[220:223]
    buffer_load_dwordx4 a[144:147], v252, s[40:43], s67 offen offset:0 sc1
    v_mfma_f32_16x16x32_bf16 v[224:227], v[176:179], v[172:175], 0
    ds_read_b64_tr_b16 v[46:47], v242 offset:7552
    v_add_f32_dpp v201, v202, v201 wave_shr:1 row_mask:0xf bank_mask:0xf bound_ctrl:0
    v_mfma_f32_16x16x32_bf16 v[224:227], v[184:187], v[164:167], v[224:227]
    ds_read_b128 v[48:51], v241 offset:15312
    v_add_f32_dpp v214, v213, v200 wave_ror:1 row_mask:0xf bank_mask:0xf bound_ctrl:0
    v_mfma_f32_16x16x32_bf16 v[224:227], v[168:171], v[180:183], v[224:227]
    ds_read_b64_tr_b16 v[52:53], v242 offset:7840
    v_add_f32_dpp v200, v201, v200 wave_shr:1 row_mask:0xf bank_mask:0xf bound_ctrl:0
    v_mfma_f32_16x16x32_bf16 v[224:227], v[192:195], v[156:159], v[224:227]
    ds_read_b64_tr_b16 v[54:55], v242 offset:7808
    v_sub_f32 v201, v214, v200
    v_mfma_f32_16x16x32_bf16 v[224:227], v[160:163], v[188:191], v[224:227]
    buffer_load_dwordx4 a[148:151], v252, s[40:43], s67 offen offset:1024 sc1
    v_mfma_f32_16x16x32_bf16 v[224:227], v[8:11], v[148:151], v[224:227]
    ds_write_addtid_b32 v200 offset:8704
    v_mfma_f32_16x16x32_bf16 v[224:227], v[152:155], v[4:7], v[224:227]
    ds_write_addtid_b32 v201 offset:25088
    v_add_f32_dpp v212, v207, v206 wave_ror:1 row_mask:0xf bank_mask:0xf bound_ctrl:0
    v_mfma_f32_16x16x32_bf16 v[224:227], v[16:19], v[140:143], v[224:227]
    ds_read_b128 v[56:59], v241 offset:15824
    v_add_f32_dpp v206, v207, v206 wave_shr:1 row_mask:0xf bank_mask:0xf bound_ctrl:0
    v_mfma_f32_16x16x32_bf16 v[224:227], v[144:147], v[12:15], v[224:227]
    v_add_f32_dpp v213, v212, v205 wave_ror:1 row_mask:0xf bank_mask:0xf bound_ctrl:0
    v_add_f32_dpp v205, v206, v205 wave_shr:1 row_mask:0xf bank_mask:0xf bound_ctrl:0
    s_waitcnt lgkmcnt(15)
    v_mfma_f32_16x16x32_bf16 v[224:227], v[24:27], v[132:135], v[224:227]
    buffer_load_dwordx4 a[152:155], v252, s[40:43], s67 offen offset:2048 sc1
    v_mfma_f32_16x16x32_bf16 v[224:227], v[136:139], v[20:23], v[224:227]
    v_add_f32_dpp v214, v213, v204 wave_ror:1 row_mask:0xf bank_mask:0xf bound_ctrl:0
    v_add_f32_dpp v204, v205, v204 wave_shr:1 row_mask:0xf bank_mask:0xf bound_ctrl:0
    v_mfma_f32_16x16x32_bf16 v[196:199], v[192:195], v[180:183], 0
    v_sub_f32 v205, v214, v204
    v_mfma_f32_16x16x32_bf16 v[196:199], v[184:187], v[188:191], v[196:199]
    ds_write_addtid_b32 v204 offset:9216
    v_mfma_f32_16x16x32_bf16 v[196:199], v[8:11], v[172:175], v[196:199]
    ds_write_addtid_b32 v205 offset:25600
    v_add_f32_dpp v212, v211, v210 wave_ror:1 row_mask:0xf bank_mask:0xf bound_ctrl:0
    v_mfma_f32_16x16x32_bf16 v[196:199], v[176:179], v[4:7], v[196:199]
    buffer_load_dwordx4 a[156:159], v252, s[40:43], s67 offen offset:3072 sc1
    v_mfma_f32_16x16x32_bf16 v[196:199], v[16:19], v[164:167], v[196:199]
    s_add_u32 s67, s67, 4096
    v_add_f32_dpp v210, v211, v210 wave_shr:1 row_mask:0xf bank_mask:0xf bound_ctrl:0
    v_mfma_f32_16x16x32_bf16 v[196:199], v[168:171], v[12:15], v[196:199]
    v_add_f32_dpp v213, v212, v209 wave_ror:1 row_mask:0xf bank_mask:0xf bound_ctrl:0
    v_add_f32_dpp v209, v210, v209 wave_shr:1 row_mask:0xf bank_mask:0xf bound_ctrl:0
    v_mfma_f32_16x16x32_bf16 v[196:199], v[24:27], v[156:159], v[196:199]
    v_add_f32_dpp v214, v213, v208 wave_ror:1 row_mask:0xf bank_mask:0xf bound_ctrl:0
    v_add_f32_dpp v208, v209, v208 wave_shr:1 row_mask:0xf bank_mask:0xf bound_ctrl:0
    v_mfma_f32_16x16x32_bf16 v[196:199], v[160:163], v[20:23], v[196:199]
    v_sub_f32 v209, v214, v208
    s_waitcnt lgkmcnt(15)
    v_mfma_f32_16x16x32_bf16 v[196:199], v[32:35], v[148:151], v[196:199]
    buffer_load_dwordx4 a[160:163], v252, s[40:43], s67 offen offset:0 sc1
    v_mfma_f32_16x16x32_bf16 v[196:199], v[152:155], v[28:31], v[196:199]
    ds_write_addtid_b32 v208 offset:10752
    s_waitcnt lgkmcnt(11)
    v_mfma_f32_16x16x32_bf16 v[196:199], v[40:43], v[140:143], v[196:199]
    ds_write_addtid_b32 v209 offset:27136
    v_add_f32_dpp v212, v219, v218 wave_ror:1 row_mask:0xf bank_mask:0xf bound_ctrl:0
    v_mfma_f32_16x16x32_bf16 v[196:199], v[144:147], v[36:39], v[196:199]
    v_add_f32_dpp v218, v219, v218 wave_shr:1 row_mask:0xf bank_mask:0xf bound_ctrl:0
    v_add_f32_dpp v213, v212, v217 wave_ror:1 row_mask:0xf bank_mask:0xf bound_ctrl:0
    s_waitcnt lgkmcnt(9)
    v_mfma_f32_16x16x32_bf16 v[196:199], v[48:51], v[132:135], v[196:199]
    v_add_f32_dpp v217, v218, v217 wave_shr:1 row_mask:0xf bank_mask:0xf bound_ctrl:0
    v_add_f32_dpp v214, v213, v216 wave_ror:1 row_mask:0xf bank_mask:0xf bound_ctrl:0
    v_mfma_f32_16x16x32_bf16 v[196:199], v[136:139], v[44:47], v[196:199]
    v_add_f32_dpp v216, v217, v216 wave_shr:1 row_mask:0xf bank_mask:0xf bound_ctrl:0
    v_sub_f32 v217, v214, v216
    v_mfma_f32_16x16x32_bf16 v[200:203], v[192:195], v[188:191], 0
    ds_write_addtid_b32 v216 offset:11264
    v_mfma_f32_16x16x32_bf16 v[200:203], v[8:11], v[180:183], v[200:203]
    ds_write_addtid_b32 v217 offset:27648
    v_add_f32_dpp v212, v223, v222 wave_ror:1 row_mask:0xf bank_mask:0xf bound_ctrl:0
    v_mfma_f32_16x16x32_bf16 v[200:203], v[184:187], v[4:7], v[200:203]
    v_add_f32_dpp v222, v223, v222 wave_shr:1 row_mask:0xf bank_mask:0xf bound_ctrl:0
    v_add_f32_dpp v213, v212, v221 wave_ror:1 row_mask:0xf bank_mask:0xf bound_ctrl:0
    v_mfma_f32_16x16x32_bf16 v[200:203], v[16:19], v[172:175], v[200:203]
    v_add_f32_dpp v221, v222, v221 wave_shr:1 row_mask:0xf bank_mask:0xf bound_ctrl:0
    v_add_f32_dpp v214, v213, v220 wave_ror:1 row_mask:0xf bank_mask:0xf bound_ctrl:0
    v_mfma_f32_16x16x32_bf16 v[200:203], v[176:179], v[12:15], v[200:203]
    v_add_f32_dpp v220, v221, v220 wave_shr:1 row_mask:0xf bank_mask:0xf bound_ctrl:0
    v_sub_f32 v221, v214, v220
    v_mfma_f32_16x16x32_bf16 v[200:203], v[24:27], v[164:167], v[200:203]
    ds_write_addtid_b32 v220 offset:12800
    v_mfma_f32_16x16x32_bf16 v[200:203], v[168:171], v[20:23], v[200:203]
    ds_write_addtid_b32 v221 offset:29184
    v_add_f32_dpp v212, v227, v226 wave_ror:1 row_mask:0xf bank_mask:0xf bound_ctrl:0
    v_mfma_f32_16x16x32_bf16 v[200:203], v[32:35], v[156:159], v[200:203]
    v_add_f32_dpp v226, v227, v226 wave_shr:1 row_mask:0xf bank_mask:0xf bound_ctrl:0
    v_add_f32_dpp v213, v212, v225 wave_ror:1 row_mask:0xf bank_mask:0xf bound_ctrl:0
    v_mfma_f32_16x16x32_bf16 v[200:203], v[160:163], v[28:31], v[200:203]
    v_add_f32_dpp v225, v226, v225 wave_shr:1 row_mask:0xf bank_mask:0xf bound_ctrl:0
    v_add_f32_dpp v214, v213, v224 wave_ror:1 row_mask:0xf bank_mask:0xf bound_ctrl:0
    v_mfma_f32_16x16x32_bf16 v[200:203], v[40:43], v[148:151], v[200:203]
    v_add_f32_dpp v224, v225, v224 wave_shr:1 row_mask:0xf bank_mask:0xf bound_ctrl:0
    v_sub_f32 v225, v214, v224
    v_mfma_f32_16x16x32_bf16 v[200:203], v[152:155], v[36:39], v[200:203]
    ds_write_addtid_b32 v224 offset:13312
    v_mfma_f32_16x16x32_bf16 v[200:203], v[48:51], v[140:143], v[200:203]
    ds_write_addtid_b32 v225 offset:29696
    v_add_f32_dpp v212, v199, v198 wave_ror:1 row_mask:0xf bank_mask:0xf bound_ctrl:0
    v_mfma_f32_16x16x32_bf16 v[200:203], v[144:147], v[44:47], v[200:203]
    v_add_f32_dpp v198, v199, v198 wave_shr:1 row_mask:0xf bank_mask:0xf bound_ctrl:0
    v_add_f32_dpp v213, v212, v197 wave_ror:1 row_mask:0xf bank_mask:0xf bound_ctrl:0
    s_waitcnt lgkmcnt(10)
    v_mfma_f32_16x16x32_bf16 v[200:203], v[56:59], v[132:135], v[200:203]
    v_add_f32_dpp v197, v198, v197 wave_shr:1 row_mask:0xf bank_mask:0xf bound_ctrl:0
    v_add_f32_dpp v214, v213, v196 wave_ror:1 row_mask:0xf bank_mask:0xf bound_ctrl:0
    v_mfma_f32_16x16x32_bf16 v[200:203], v[136:139], v[52:55], v[200:203]
    v_add_f32_dpp v196, v197, v196 wave_shr:1 row_mask:0xf bank_mask:0xf bound_ctrl:0
    v_sub_f32 v197, v214, v196
    ds_write_addtid_b32 v196 offset:14848
    ds_write_addtid_b32 v197 offset:31232
    s_nop 3
    v_add_f32_dpp v212, v203, v202 wave_ror:1 row_mask:0xf bank_mask:0xf bound_ctrl:0
    v_add_f32_dpp v202, v203, v202 wave_shr:1 row_mask:0xf bank_mask:0xf bound_ctrl:0
    s_nop 0
    v_add_f32_dpp v213, v212, v201 wave_ror:1 row_mask:0xf bank_mask:0xf bound_ctrl:0
    v_add_f32_dpp v201, v202, v201 wave_shr:1 row_mask:0xf bank_mask:0xf bound_ctrl:0
    s_nop 0
    v_add_f32_dpp v214, v213, v200 wave_ror:1 row_mask:0xf bank_mask:0xf bound_ctrl:0
    v_add_f32_dpp v200, v201, v200 wave_shr:1 row_mask:0xf bank_mask:0xf bound_ctrl:0
    v_sub_f32 v201, v214, v200
    ds_write_addtid_b32 v200 offset:15360
    ds_write_addtid_b32 v201 offset:31744
    s_waitcnt lgkmcnt(0)
L_cvEh:
    s_barrier
    v_add_u32 v242, 63488, v242
    v_add_u32 v241, 63488, v241
    ds_read_b128 v[132:135], v235 offset:0
    ds_read_b128 v[148:151], v236 offset:0
    ds_read_b128 v[136:139], v235 offset:16
    ds_read_b128 v[140:143], v235 offset:8192
    ds_read_b128 v[152:155], v236 offset:8192
    ds_read_b128 v[144:147], v235 offset:8208
    s_lshl_b32 s57, s63, 7
    s_nop 0
    s_add_u32 s57, s57, 6291456
    ds_read_b64_tr_b16 v[4:5], v242 offset:32
    ds_read_b64_tr_b16 v[6:7], v242 offset:0
    ds_read_b128 v[8:11], v241 offset:0
    ds_read_b64_tr_b16 v[12:13], v242 offset:288
    ds_read_b64_tr_b16 v[14:15], v242 offset:256
    ds_read_b128 v[16:19], v241 offset:512
    ds_read_b64_tr_b16 v[20:21], v242 offset:544
    ds_read_b64_tr_b16 v[22:23], v242 offset:512
    ds_read_b128 v[24:27], v241 offset:1024
    ds_read_b64_tr_b16 v[28:29], v242 offset:800
    ds_read_b64_tr_b16 v[30:31], v242 offset:768
    ds_read_b128 v[32:35], v241 offset:1536
    ds_read_b64_tr_b16 v[36:37], v242 offset:1056
    ds_read_b64_tr_b16 v[38:39], v242 offset:1024
    ds_read_b128 v[40:43], v241 offset:2048
    ds_read_b64_tr_b16 v[44:45], v242 offset:1312
    ds_read_b64_tr_b16 v[46:47], v242 offset:1280
    ds_read_b128 v[48:51], v241 offset:2560
    ds_read_b64_tr_b16 v[52:53], v242 offset:1568
    ds_read_b64_tr_b16 v[54:55], v242 offset:1536
    ds_read_b128 v[56:59], v241 offset:3072
    ds_read_b64_tr_b16 v[60:61], v242 offset:1824
L_padH5:
    s_cmp_lg_u32 s3, 0
    s_cbranch_scc1 L_padT2
    ds_read_b64_tr_b16 v[62:63], v242 offset:1792
    ds_read_b128 v[64:67], v241 offset:3584
    buffer_store_dword v243, v243, s[40:43], s68 offen
    buffer_store_dword v243, v243, s[40:43], s68 offen
    buffer_store_dword v243, v243, s[40:43], s68 offen
    buffer_store_dword v243, v243, s[40:43], s68 offen
    buffer_store_dword v243, v243, s[40:43], s68 offen
    buffer_store_dword v243, v243, s[40:43], s68 offen
    s_waitcnt lgkmcnt(15)
    v_add_f32 v132, v132, v148
    v_add_f32 v133, v133, v149
    v_add_f32 v134, v134, v150
    v_cvt_pk_bf16_f32 v156, v132, v133
    v_cvt_pk_bf16_f32 v157, v134, v135
    v_cvt_pk_bf16_f32 v158, v136, v137
    v_cvt_pk_bf16_f32 v159, v138, v139
    buffer_store_dwordx4 v[156:159], v237, s[40:43], s57 offen offset:0 sc1
    v_add_f32 v140, v140, v152
    v_add_f32 v141, v141, v153
    v_add_f32_e64 v142, v142, v154
    v_cvt_pk_bf16_f32 v160, v140, v141
    v_cvt_pk_bf16_f32 v161, v142, v143
    v_cvt_pk_bf16_f32 v162, v144, v145
    v_cvt_pk_bf16_f32 v163, v146, v147
    buffer_store_dwordx4 v[160:163], v237, s[40:43], s57 offen offset:128 sc1
    s_add_u32 s63, s63, 2
    s_waitcnt lgkmcnt(0)
    s_barrier
    s_branch L_tail
L_code_end:
.section .rodata,"a"
.p2align 6
.amdhsa_kernel recurrent_scan__ssm_conv_s4__geglu_ffn__prompt_kernel
  .amdhsa_next_free_vgpr 512
  .amdhsa_next_free_sgpr 102
  .amdhsa_accum_offset 256
  .amdhsa_group_segment_fixed_size 0
  .amdhsa_kernarg_size 128
  .amdhsa_user_sgpr_count 2
  .amdhsa_user_sgpr_kernarg_segment_ptr 1
  .amdhsa_system_sgpr_workgroup_id_x 1
.end_amdhsa_kernel
```
